```python
import torch

def _softmax(x, axis=-1):
    return torch.softmax(x, dim=axis)
def _gelu(x):
    return torch.nn.functional.gelu(x, approximate="tanh")
def _silu(x):
    return torch.nn.functional.silu(x)
def _sigmoid(x):
    return torch.sigmoid(x)
def _layernorm(x, axis=-1, eps=1e-5):
    m = x.mean(dim=axis, keepdim=True)
    v = x.var(dim=axis, keepdim=True, unbiased=False)
    return (x - m) / torch.sqrt(v + eps)
def _scatter_add(tgt, idx, src, axis=0):
    return tgt.clone().index_add_(axis, idx, src)
def _segment_sum(src, seg, n):
    out = torch.zeros((n,) + src.shape[1:], dtype=src.dtype)
    return out.index_add_(0, seg, src)
def _pad(x, pw):
    flat = tuple(v for pair in reversed(pw) for v in pair)
    return torch.nn.functional.pad(x, flat)

kernel_name = 'interleave_layers__ssm_conv_h3__mixer_channel_mlp__prompt'

def setup_inputs():

    _w = (lambda a: (lambda t: t.to(torch.bfloat16) if t.is_floating_point() else t)(torch.as_tensor(a)))
    def _A_setup():
        B, S, D = 1, 2048, 640
        ks = 4
        return {
            "q": _w((lambda *s: torch.randn(*s, dtype=torch.bfloat16) * 0.05)(B, S, D)),
            "k": _w((lambda *s: torch.randn(*s, dtype=torch.bfloat16) * 0.2)(B, S, D)),
            "v": _w((lambda *s: torch.randn(*s, dtype=torch.bfloat16) * 0.2)(B, S, D)),
            "shift_k": _w((lambda *s: torch.randn(*s, dtype=torch.bfloat16) * 0.2)(D, ks) * 0.5),
            "ssm_k": _w((lambda *s: torch.randn(*s, dtype=torch.bfloat16) * 0.4)(D, S) * (1.0 / S ** 0.5)),
            "ssm_D": _w((lambda *s: torch.randn(*s, dtype=torch.bfloat16) * 0.2)(D)),
        }
    _A_in = _A_setup()

    def _B_setup():
        B, S, D, F = 1, 2048, 640, 1728
        return {
            "x": _w((lambda *s: torch.randn(*s, dtype=torch.bfloat16) * 0.05)(B, S, D)),
            "w1": _w((lambda *s: torch.randn(*s, dtype=torch.bfloat16) * 0.8)(D, F) * (D ** -0.5)),
            "b1": _w((lambda *s: torch.randn(*s, dtype=torch.bfloat16) * 0.4)(F)),
            "w2": _w((lambda *s: torch.randn(*s, dtype=torch.bfloat16) * 0.05)(F, D) * (F ** -0.5)),
            "b2": _w((lambda *s: torch.randn(*s, dtype=torch.bfloat16) * 0.05)(D)),
        }
    _B_in = _B_setup()

    return {
        "A_q": _A_in["q"],
        "A_k": _A_in["k"],
        "A_v": _A_in["v"],
        "A_shift_k": _A_in["shift_k"],
        "A_ssm_k": _A_in["ssm_k"],
        "A_ssm_D": _A_in["ssm_D"],
        "B_x": _B_in["x"],
        "B_w1": _B_in["w1"],
        "B_b1": _B_in["b1"],
        "B_w2": _B_in["w2"],
        "B_b2": _B_in["b2"],
    }

def reference(A_q, A_k, A_v, A_shift_k, A_ssm_k, A_ssm_D, B_x, B_w1, B_b1, B_w2, B_b2):
    def _A_ref(q, k, v, shift_k, ssm_k, ssm_D):
        B, S, D = q.shape
        ks = shift_k.shape[-1]
        k_pad = _pad(k, ((0, 0), (ks - 1, 0), (0, 0)))
        k_shift = torch.zeros_like(k)
        for t in range(ks):
            k_shift = k_shift + k_pad[:, t:t + S, :] * shift_k[:, ks - 1 - t][None, None, :]
        kv = k_shift * v
        L = 2 * S
        kv_pad = _pad(kv, ((0, 0), (0, S), (0, 0)))
        kf_pad = _pad(ssm_k, ((0, 0), (0, S)))
        kv_f = (lambda x, axes=(-2,-1): torch.fft.rfft2(x.float(), dim=axes))(kv_pad[:, None, :, :], axes=(1, 2))
        kf_f = (lambda x, axes=(-2,-1): torch.fft.rfft2(x.float(), dim=axes))(kf_pad[:, None, :], axes=(1, 2))
        kf_f = (lambda x, *d: x.permute(*d))(kf_f, 1, 2, 0)
        y_f = kv_f * kf_f[None, :, :, :]
        y = (lambda x, s, axes=(-2,-1): torch.fft.irfft2(x, s=s, dim=axes).to(torch.bfloat16))(y_f, (1, L), axes=(1, 2))[:, 0, :S, :]
        y = y + kv * ssm_D[None, None, :]
        return q * y

    def _B_ref(x, w1, b1, w2, b2):
        y = _layernorm(x, axis=-1)
        h = _gelu(torch.einsum("bsd,df->bsf", y, w1) + b1)
        return torch.einsum("bsf,fd->bsd", h, w2) + b2

    x = A_q
    x = x + _A_ref(_layernorm(x, axis=-1), A_k, A_v, A_shift_k, A_ssm_k, A_ssm_D)
    x = x + _B_ref(_layernorm(x, axis=-1), B_w1, B_b1, B_w2, B_b2)
    x = x + _A_ref(_layernorm(x, axis=-1), A_k, A_v, A_shift_k, A_ssm_k, A_ssm_D)
    x = x + _B_ref(_layernorm(x, axis=-1), B_w1, B_b1, B_w2, B_b2)
    return x
```

```asm
; @launch grid=(256,1,1) block=(256,1,1) lds=163840
.amdgcn_target "amdgcn-amd-amdhsa--gfx950"
.text
.globl interleave_layers__ssm_conv_h3__mixer_channel_mlp__prompt_kernel
.p2align 8
.type interleave_layers__ssm_conv_h3__mixer_channel_mlp__prompt_kernel,@function
interleave_layers__ssm_conv_h3__mixer_channel_mlp__prompt_kernel:
s_load_dwordx16 s[16:31], s[0:1], 0
s_load_dwordx8 s[32:39], s[0:1], 64
s_load_dwordx4 s[40:43], s[0:1], 96
s_cmp_ge_u32 s2, 256
s_cbranch_scc1 L_END
s_and_b32 s3, s2, 7
s_lshr_b32 s4, s2, 3
s_lshr_b32 s8, s4, 4
s_lshl_b32 s64, s3, 1
s_add_u32 s64, s64, s8
s_and_b32 s65, s4, 15
s_lshr_b32 s66, s65, 3
s_and_b32 s67, s65, 7
v_lshrrev_b32 v1, 6, v0
s_nop 0
v_readfirstlane_b32 s5, v1
s_getpc_b64 s[62:63]
L_pc:
v_and_b32 v20, 63, v0
s_lshl_b32 s61, s4, 2
v_lshl_add_u32 v21, v20, 7, v1
v_add_u32 v21, s61, v21
v_lshlrev_b32 v21, 6, v21
v_min_u32 v21, L_END-L_pc, v21
s_mov_b32 exec_lo, 0x7f
s_mov_b32 exec_hi, 0x0
global_load_dword v255, v21, s[62:63]
s_mov_b64 exec, -1
v_and_b32 v1, 63, v0
v_mul_u32_u24 v6, 205, v0
v_lshrrev_b32 v6, 11, v6
v_mul_u32_u24 v7, 10, v6
v_sub_u32 v7, v0, v7
s_mul_i32 s8, s4, 81920
s_mul_i32 s9, s3, 160
s_add_u32 s8, s8, s9
s_sub_u32 s8, s8, 5120
v_mul_u32_u24 v8, 3840, v6
v_lshl_add_u32 v8, v7, 4, v8
v_add_u32 v8, s8, v8
v_add_u32 v9, 1280, v8
v_add_u32 v10, 2560, v8
v_add_u32 v11, 3840, v8
v_add_u32 v12, 5120, v8
v_add_u32 v13, 6400, v8
v_lshlrev_b32 v14, 6, v7
s_mul_i32 s9, s3, 640
v_mul_u32_u24 v15, 528, v6
v_lshl_add_u32 v15, v7, 4, v15
v_lshlrev_b32 v3, 4, v1
v_cmp_gt_u32 vcc, 220, v0
s_mov_b32 s98, 0x40000
s_mov_b32 s14, 0xffff0000
s_waitcnt lgkmcnt(0)
s_load_dword s6, s[42:43], 0
s_mov_b32 s48, s18
s_mov_b32 s49, s19
s_mov_b32 s50, 0x280000
s_mov_b32 s51, 0x20000
s_and_b64 exec, exec, vcc
buffer_load_dwordx4 v[32:35], v8, s[48:51], 0 offen
buffer_load_dwordx4 v[36:39], v9, s[48:51], 0 offen
buffer_load_dwordx4 v[40:43], v10, s[48:51], 0 offen
s_mov_b32 s56, s22
s_mov_b32 s57, s23
s_mov_b32 s58, 0x1400
s_mov_b32 s59, 0x20000
buffer_load_dwordx4 v[68:71], v14, s[56:59], s9 offen offset:0
buffer_load_dwordx4 v[72:75], v14, s[56:59], s9 offen offset:16
buffer_load_dwordx4 v[76:79], v14, s[56:59], s9 offen offset:32
buffer_load_dwordx4 v[80:83], v14, s[56:59], s9 offen offset:48
buffer_load_dwordx4 v[44:47], v11, s[48:51], 0 offen
buffer_load_dwordx4 v[48:51], v12, s[48:51], 0 offen
buffer_load_dwordx4 v[52:55], v13, s[48:51], 0 offen
s_mov_b32 s52, s20
s_mov_b32 s53, s21
s_mov_b32 s54, 0x280000
s_mov_b32 s55, 0x20000
buffer_load_dwordx4 v[56:59], v11, s[52:55], 0 offen
buffer_load_dwordx4 v[60:63], v12, s[52:55], 0 offen
buffer_load_dwordx4 v[64:67], v13, s[52:55], 0 offen
s_mov_b32 s44, s42
s_mov_b32 s45, s43
s_mov_b32 s46, 0x2040000
s_mov_b32 s47, 0x20000
v_lshlrev_b32 v19, 7, v1
s_lshl_b32 s8, s3, 9
s_add_u32 s8, s8, 0x2000
s_mov_b64 exec, 15
buffer_load_dword v255, v19, s[44:47], s8 offen sc1
s_sub_u32 s8, s8, 0x1000
buffer_load_dword v255, v19, s[44:47], s8 offen sc1
v_lshlrev_b32 v20, 15, v1
s_mov_b32 s52, s38
s_mov_b32 s53, s39
s_mov_b32 s54, 0x280000
s_mov_b32 s55, 0x20000
s_mov_b32 exec_lo, 0xffffffff
s_mov_b32 exec_hi, 0xffffffff
buffer_load_dword v255, v20, s[52:55], 0 offen
s_mov_b32 exec_lo, 0xffff
s_mov_b32 exec_hi, 0x0
s_mov_b32 s8, 2097152
buffer_load_dword v255, v20, s[52:55], s8 offen
s_lshl_b32 s8, s2, 2
s_add_u32 s8, s8, s5
s_mul_i32 s8, s8, 17*128
v_add_u32 v14, s8, v19
s_mov_b64 exec, -1
s_mul_i32 s69, s3, 20
s_cmp_ge_u32 s4, 20
s_cbranch_scc1 hC_1
s_add_u32 s69, s69, s4
s_lshl_b32 s8, s69, 2
s_add_u32 s8, s8, s5
s_lshr_b32 s9, s8, 1
s_lshl_b32 s9, s9, 2
s_load_dword s100, s[26:27], s9
s_branch hdone_3
hidle_2:
s_branch hdone_3
hC_1:
s_cmp_ge_u32 s4, 30
s_cbranch_scc1 hidle_2
s_sub_u32 s8, s4, 20
s_lshl_b32 s8, s8, 1
s_add_u32 s69, s69, s8
s_lshl_b32 s8, s69, 2
s_add_u32 s8, s8, s5
s_lshr_b32 s9, s8, 1
s_lshl_b32 s9, s9, 2
s_load_dword s100, s[26:27], s9
s_add_u32 s9, s9, 8
s_load_dword s101, s[26:27], s9
hdone_3:
s_lshl_b32 s8, s64, 1
s_add_u32 s8, s8, s66
s_lshl_b32 s8, s8, 2
s_add_u32 s8, s8, s5
s_lshl_b32 s8, s8, 11
s_add_u32 s12, s8, 0x20000
s_lshl_b32 s9, s67, 8
s_add_u32 s9, s9, s12
v_mov_b32 v22, s9
s_add_u32 s9, s9, 128
v_writelane_b32 v22, s9, 1
s_add_u32 s9, s9, 0x60000
v_writelane_b32 v22, s9, 10
s_sub_u32 s9, s9, 128
v_writelane_b32 v22, s9, 11
s_add_u32 s9, s9, 0x1480000
v_writelane_b32 v22, s9, 12
s_add_u32 s9, s9, 128
v_writelane_b32 v22, s9, 13
s_lshl_b32 s8, s64, 8
s_lshl_b32 s9, s65, 2
s_add_u32 s8, s8, s9
s_lshl_b32 s8, s8, 2
s_add_u32 s9, s8, 0x6000
v_writelane_b32 v22, s9, 2
s_add_u32 s9, s8, 0x6100
v_writelane_b32 v22, s9, 3
s_add_u32 s9, s8, 0x6200
v_writelane_b32 v22, s9, 4
s_add_u32 s9, s8, 0xa000
v_writelane_b32 v22, s9, 5
s_add_u32 s9, s8, 0xa100
v_writelane_b32 v22, s9, 6
s_add_u32 s9, s8, 0xa200
v_writelane_b32 v22, s9, 7
s_lshl_b32 s8, s64, 1
s_add_u32 s8, s8, s66
s_lshl_b32 s8, s8, 1
s_lshr_b32 s9, s5, 1
s_add_u32 s8, s8, s9
s_lshl_b32 s8, s8, 3
s_add_u32 s8, s8, s67
s_lshl_b32 s8, s8, 1
s_and_b32 s9, s5, 1
s_add_u32 s8, s8, s9
s_lshl_b32 s8, s8, 2
s_add_u32 s13, s8, 0xe000
v_writelane_b32 v22, s13, 8
s_mov_b64 exec, 0xdff
buffer_load_dword v255, v22, s[44:47], 0 offen sc1
s_mov_b64 exec, -1
s_waitcnt lgkmcnt(0)
s_mul_i32 s6, s6, 0x9E3779B1
s_add_u32 s6, s6, 0x7F4A7C15
s_getreg_b32 s68, hwreg(HW_REG_XCC_ID, 0, 4)
v_mov_b32 v2, s6
v_mov_b32 v4, s68
v_mov_b32 v5, s6
s_lshl_b32 s8, s3, 5
s_add_u32 s8, s8, s4
s_lshl_b32 s8, s8, 6
s_add_u32 s8, s8, 0x10000
s_mov_b64 exec, 0x1
s_cmp_lg_u32 s5, 3
s_cbranch_scc1 L_nopub
buffer_store_dwordx2 v[4:5], off, s[44:47], s8 sc1
s_branch L_pubdone
L_nopub:
buffer_load_dword v255, off, s[44:47], 0
L_pubdone:
s_mov_b64 exec, -1
v_lshrrev_b32 v5, 4, v1
v_bfe_u32 v6, v1, 1, 1
v_lshl_add_u32 v5, v5, 1, v6
v_lshlrev_b32 v5, 3, v5
v_bfe_u32 v6, v1, 2, 2
v_sub_u32 v5, v5, v6
s_mov_b32 s9, s5
v_add_u32 v5, 4, v5
v_mul_u32_u24 v5, 176, v5
v_and_b32 v6, 1, v1
v_lshl_add_u32 v5, v6, 3, v5
s_lshl_b32 s10, s9, 4
s_add_u32 s10, s10, 57344
v_add_u32 v5, s10, v5
v_and_b32 v6, 3, v1
v_lshlrev_b32 v6, 4, v6
v_lshrrev_b32 v7, 3, v1
v_lshl_add_u32 v6, v7, 6, v6
v_bfe_u32 v7, v1, 2, 1
v_lshl_add_u32 v6, v7, 14, v6
s_mul_i32 s10, s3, 10
s_add_u32 s10, s10, s9
s_lshl_b32 s10, s10, 15
s_lshl_b32 s11, s4, 9
s_add_u32 s10, s10, s11
s_add_u32 s10, s10, 0x100000
v_and_b32 v9, 31, v1
v_lshlrev_b32 v9, 6, v9
s_lshl_b32 s12, s3, 11
s_add_u32 s12, s12, 0x10000
s_lshl_b32 s8, s2, 3
s_lshl_b32 s9, s5, 1
s_add_u32 s8, s8, s9
s_mul_i32 s15, s8, 1280
v_lshrrev_b32 v16, 5, v1
v_mul_u32_u24 v16, 1280, v16
v_and_b32 v17, 31, v1
v_lshl_add_u32 v18, v17, 3, v16
v_lshl_add_u32 v16, v17, 4, v16
s_mov_b32 s56, s16
s_mov_b32 s57, s17
s_mov_b32 s58, 0x280000
s_mov_b32 s59, 0x20000
v_and_b32 v26, 127, v0
v_lshlrev_b32 v26, 1, v26
v_lshlrev_b32 v27, 2, v1
s_mov_b32 s99, s10
s_mov_b32 s48, s24
s_mov_b32 s49, s25
s_mov_b32 s50, 0x280000
s_mov_b32 s51, 0x20000
s_cmp_ge_u32 s4, 20
s_cbranch_scc1 hC_4
s_lshl_b32 s8, s69, 2
s_add_u32 s8, s8, s5
s_lshl_b32 s8, s8, 12
s_mul_i32 s9, s5, 8448
s_add_u32 m0, s9, 71740
s_nop 0
buffer_load_dwordx4 v3, s[48:51], s8 offen offset:0 lds
buffer_load_dwordx4 v3, s[48:51], s8 offen offset:1024 lds
buffer_load_dwordx4 v3, s[48:51], s8 offen offset:2048 lds
buffer_load_dwordx4 v3, s[48:51], s8 offen offset:3072 lds
s_mov_b64 exec, 1
buffer_load_dword v255, off, s[44:47], 0
buffer_load_dword v255, off, s[44:47], 0
s_mov_b64 exec, -1
s_branch hdone_6
hidle_5:
s_mov_b64 exec, 1
buffer_load_dword v255, off, s[44:47], 0
buffer_load_dword v255, off, s[44:47], 0
buffer_load_dword v255, off, s[44:47], 0
buffer_load_dword v255, off, s[44:47], 0
buffer_load_dword v255, off, s[44:47], 0
buffer_load_dword v255, off, s[44:47], 0
s_mov_b64 exec, -1
s_branch hdone_6
hC_4:
s_cmp_ge_u32 s4, 30
s_cbranch_scc1 hidle_5
s_lshl_b32 s8, s69, 2
s_add_u32 s8, s8, s5
s_lshl_b32 s8, s8, 12
s_mul_i32 s9, s5, 5376
s_add_u32 s10, s8, 0
s_add_u32 m0, s9, 71740
s_nop 0
buffer_load_dwordx4 v3, s[48:51], s10 offen offset:0 lds
buffer_load_dwordx4 v3, s[48:51], s10 offen offset:1024 lds
s_add_u32 s10, s8, 16384
s_add_u32 m0, s9, 93244
s_nop 0
buffer_load_dwordx4 v3, s[48:51], s10 offen offset:0 lds
buffer_load_dwordx4 v3, s[48:51], s10 offen offset:1024 lds
s_mov_b32 exec_lo, 0xffffffff
s_mov_b32 exec_hi, 0x0
s_add_u32 s10, s8, 0
s_add_u32 m0, s9, 71740
s_nop 0
buffer_load_dwordx4 v3, s[48:51], s10 offen offset:2048 lds
s_add_u32 s10, s8, 16384
s_add_u32 m0, s9, 93244
s_nop 0
buffer_load_dwordx4 v3, s[48:51], s10 offen offset:2048 lds
s_mov_b64 exec, -1
hdone_6:
s_mov_b32 s10, s99
s_waitcnt vmcnt(24)
v_lshlrev_b32 v142, 16, v32
v_and_b32 v143, s14, v32
v_lshlrev_b32 v144, 16, v33
v_and_b32 v145, s14, v33
v_lshlrev_b32 v146, 16, v34
v_and_b32 v147, s14, v34
v_lshlrev_b32 v148, 16, v35
v_and_b32 v149, s14, v35
s_waitcnt vmcnt(23)
v_lshlrev_b32 v150, 16, v36
v_and_b32 v151, s14, v36
v_lshlrev_b32 v152, 16, v37
v_and_b32 v153, s14, v37
v_lshlrev_b32 v154, 16, v38
v_and_b32 v155, s14, v38
v_lshlrev_b32 v156, 16, v39
v_and_b32 v157, s14, v39
s_waitcnt vmcnt(22)
v_lshlrev_b32 v158, 16, v40
v_and_b32 v159, s14, v40
v_lshlrev_b32 v160, 16, v41
v_and_b32 v161, s14, v41
v_lshlrev_b32 v162, 16, v42
v_and_b32 v163, s14, v42
v_lshlrev_b32 v164, 16, v43
v_and_b32 v165, s14, v43
s_waitcnt vmcnt(18)
v_lshlrev_b32 v110, 16, v68
v_and_b32 v118, s14, v68
v_lshlrev_b32 v126, 16, v69
v_and_b32 v134, s14, v69
v_lshlrev_b32 v111, 16, v70
v_and_b32 v119, s14, v70
v_lshlrev_b32 v127, 16, v71
v_and_b32 v135, s14, v71
v_lshlrev_b32 v112, 16, v72
v_and_b32 v120, s14, v72
v_lshlrev_b32 v128, 16, v73
v_and_b32 v136, s14, v73
v_lshlrev_b32 v113, 16, v74
v_and_b32 v121, s14, v74
v_lshlrev_b32 v129, 16, v75
v_and_b32 v137, s14, v75
v_lshlrev_b32 v114, 16, v76
v_and_b32 v122, s14, v76
v_lshlrev_b32 v130, 16, v77
v_and_b32 v138, s14, v77
v_lshlrev_b32 v115, 16, v78
v_and_b32 v123, s14, v78
v_lshlrev_b32 v131, 16, v79
v_and_b32 v139, s14, v79
v_lshlrev_b32 v116, 16, v80
v_and_b32 v124, s14, v80
v_lshlrev_b32 v132, 16, v81
v_and_b32 v140, s14, v81
v_lshlrev_b32 v117, 16, v82
v_and_b32 v125, s14, v82
v_lshlrev_b32 v133, 16, v83
v_and_b32 v141, s14, v83
s_waitcnt vmcnt(17)
v_lshlrev_b32 v166, 16, v44
v_and_b32 v167, s14, v44
v_lshlrev_b32 v168, 16, v45
v_and_b32 v169, s14, v45
v_lshlrev_b32 v170, 16, v46
v_and_b32 v171, s14, v46
v_lshlrev_b32 v172, 16, v47
v_and_b32 v173, s14, v47
v_pk_mul_f32 v[214:215], v[142:143], v[134:135]
v_pk_mul_f32 v[216:217], v[144:145], v[136:137]
v_pk_mul_f32 v[218:219], v[146:147], v[138:139]
v_pk_mul_f32 v[220:221], v[148:149], v[140:141]
v_pk_fma_f32 v[214:215], v[150:151], v[126:127], v[214:215]
v_pk_fma_f32 v[216:217], v[152:153], v[128:129], v[216:217]
v_pk_fma_f32 v[218:219], v[154:155], v[130:131], v[218:219]
v_pk_fma_f32 v[220:221], v[156:157], v[132:133], v[220:221]
v_pk_fma_f32 v[214:215], v[158:159], v[118:119], v[214:215]
v_pk_fma_f32 v[216:217], v[160:161], v[120:121], v[216:217]
v_pk_fma_f32 v[218:219], v[162:163], v[122:123], v[218:219]
v_pk_fma_f32 v[220:221], v[164:165], v[124:125], v[220:221]
v_pk_fma_f32 v[214:215], v[166:167], v[110:111], v[214:215]
v_pk_fma_f32 v[216:217], v[168:169], v[112:113], v[216:217]
v_pk_fma_f32 v[218:219], v[170:171], v[114:115], v[218:219]
v_pk_fma_f32 v[220:221], v[172:173], v[116:117], v[220:221]
s_waitcnt vmcnt(16)
v_lshlrev_b32 v174, 16, v48
v_and_b32 v175, s14, v48
v_lshlrev_b32 v176, 16, v49
v_and_b32 v177, s14, v49
v_lshlrev_b32 v178, 16, v50
v_and_b32 v179, s14, v50
v_lshlrev_b32 v180, 16, v51
v_and_b32 v181, s14, v51
v_pk_mul_f32 v[222:223], v[150:151], v[134:135]
v_pk_mul_f32 v[224:225], v[152:153], v[136:137]
v_pk_mul_f32 v[226:227], v[154:155], v[138:139]
v_pk_mul_f32 v[228:229], v[156:157], v[140:141]
v_pk_fma_f32 v[222:223], v[158:159], v[126:127], v[222:223]
v_pk_fma_f32 v[224:225], v[160:161], v[128:129], v[224:225]
v_pk_fma_f32 v[226:227], v[162:163], v[130:131], v[226:227]
v_pk_fma_f32 v[228:229], v[164:165], v[132:133], v[228:229]
v_pk_fma_f32 v[222:223], v[166:167], v[118:119], v[222:223]
v_pk_fma_f32 v[224:225], v[168:169], v[120:121], v[224:225]
v_pk_fma_f32 v[226:227], v[170:171], v[122:123], v[226:227]
v_pk_fma_f32 v[228:229], v[172:173], v[124:125], v[228:229]
v_pk_fma_f32 v[222:223], v[174:175], v[110:111], v[222:223]
v_pk_fma_f32 v[224:225], v[176:177], v[112:113], v[224:225]
v_pk_fma_f32 v[226:227], v[178:179], v[114:115], v[226:227]
v_pk_fma_f32 v[228:229], v[180:181], v[116:117], v[228:229]
s_waitcnt vmcnt(15)
v_lshlrev_b32 v182, 16, v52
v_and_b32 v183, s14, v52
v_lshlrev_b32 v184, 16, v53
v_and_b32 v185, s14, v53
v_lshlrev_b32 v186, 16, v54
v_and_b32 v187, s14, v54
v_lshlrev_b32 v188, 16, v55
v_and_b32 v189, s14, v55
v_pk_mul_f32 v[230:231], v[158:159], v[134:135]
v_pk_mul_f32 v[232:233], v[160:161], v[136:137]
v_pk_mul_f32 v[234:235], v[162:163], v[138:139]
v_pk_mul_f32 v[236:237], v[164:165], v[140:141]
v_pk_fma_f32 v[230:231], v[166:167], v[126:127], v[230:231]
v_pk_fma_f32 v[232:233], v[168:169], v[128:129], v[232:233]
v_pk_fma_f32 v[234:235], v[170:171], v[130:131], v[234:235]
v_pk_fma_f32 v[236:237], v[172:173], v[132:133], v[236:237]
v_pk_fma_f32 v[230:231], v[174:175], v[118:119], v[230:231]
v_pk_fma_f32 v[232:233], v[176:177], v[120:121], v[232:233]
v_pk_fma_f32 v[234:235], v[178:179], v[122:123], v[234:235]
v_pk_fma_f32 v[236:237], v[180:181], v[124:125], v[236:237]
v_pk_fma_f32 v[230:231], v[182:183], v[110:111], v[230:231]
v_pk_fma_f32 v[232:233], v[184:185], v[112:113], v[232:233]
v_pk_fma_f32 v[234:235], v[186:187], v[114:115], v[234:235]
v_pk_fma_f32 v[236:237], v[188:189], v[116:117], v[236:237]
v_add_u32 v4, 57344, v15
v_cmp_gt_u32 vcc, 220, v0
s_waitcnt vmcnt(14)
v_lshlrev_b32 v190, 16, v56
v_and_b32 v191, s14, v56
v_lshlrev_b32 v192, 16, v57
v_and_b32 v193, s14, v57
v_lshlrev_b32 v194, 16, v58
v_and_b32 v195, s14, v58
v_lshlrev_b32 v196, 16, v59
v_and_b32 v197, s14, v59
v_pk_mul_f32 v[214:215], v[214:215], v[190:191]
v_pk_mul_f32 v[216:217], v[216:217], v[192:193]
v_pk_mul_f32 v[218:219], v[218:219], v[194:195]
v_pk_mul_f32 v[220:221], v[220:221], v[196:197]
v_cvt_pk_bf16_f32 v32, v214, v215
v_cvt_pk_bf16_f32 v33, v216, v217
v_cvt_pk_bf16_f32 v34, v218, v219
v_cvt_pk_bf16_f32 v35, v220, v221
s_waitcnt vmcnt(13)
v_lshlrev_b32 v198, 16, v60
v_and_b32 v199, s14, v60
v_lshlrev_b32 v200, 16, v61
v_and_b32 v201, s14, v61
v_lshlrev_b32 v202, 16, v62
v_and_b32 v203, s14, v62
v_lshlrev_b32 v204, 16, v63
v_and_b32 v205, s14, v63
v_pk_mul_f32 v[222:223], v[222:223], v[198:199]
v_pk_mul_f32 v[224:225], v[224:225], v[200:201]
v_pk_mul_f32 v[226:227], v[226:227], v[202:203]
v_pk_mul_f32 v[228:229], v[228:229], v[204:205]
v_cvt_pk_bf16_f32 v36, v222, v223
v_cvt_pk_bf16_f32 v37, v224, v225
v_cvt_pk_bf16_f32 v38, v226, v227
v_cvt_pk_bf16_f32 v39, v228, v229
s_waitcnt vmcnt(12)
v_lshlrev_b32 v206, 16, v64
v_and_b32 v207, s14, v64
v_lshlrev_b32 v208, 16, v65
v_and_b32 v209, s14, v65
v_lshlrev_b32 v210, 16, v66
v_and_b32 v211, s14, v66
v_lshlrev_b32 v212, 16, v67
v_and_b32 v213, s14, v67
v_pk_mul_f32 v[230:231], v[230:231], v[206:207]
v_pk_mul_f32 v[232:233], v[232:233], v[208:209]
v_pk_mul_f32 v[234:235], v[234:235], v[210:211]
v_pk_mul_f32 v[236:237], v[236:237], v[212:213]
v_cvt_pk_bf16_f32 v40, v230, v231
v_cvt_pk_bf16_f32 v41, v232, v233
v_cvt_pk_bf16_f32 v42, v234, v235
v_cvt_pk_bf16_f32 v43, v236, v237
s_and_b64 exec, exec, vcc
ds_write_b128 v4, v[32:35] offset:0
ds_write_b128 v4, v[36:39] offset:176
ds_write_b128 v4, v[40:43] offset:352
s_mov_b64 exec, -1
s_waitcnt lgkmcnt(0)
s_barrier
ds_read_b64_tr_b16 v[32:33], v5 offset:704
ds_read_b64_tr_b16 v[34:35], v5 offset:0
ds_read_b64_tr_b16 v[36:37], v5 offset:768
ds_read_b64_tr_b16 v[38:39], v5 offset:64
ds_read_b64_tr_b16 v[40:41], v5 offset:832
ds_read_b64_tr_b16 v[42:43], v5 offset:128
s_waitcnt lgkmcnt(4)
buffer_store_dwordx4 v[32:35], v6, s[44:47], s10 offen sc1
s_add_u32 s10, s10, 0x20000
s_waitcnt lgkmcnt(2)
buffer_store_dwordx4 v[36:39], v6, s[44:47], s10 offen sc1
s_add_u32 s10, s10, 0x20000
s_cmp_lt_u32 s5, 2
s_cselect_b32 s10, s10, 0x70000000
s_waitcnt lgkmcnt(0)
buffer_store_dwordx4 v[40:43], v6, s[44:47], s10 offen sc1
buffer_load_dwordx2 v[22:23], v9, s[44:47], s12 offen sc1
v_mov_b32 v84, -1
v_mov_b32 v85, -1
v_mov_b32 v86, -1
v_mov_b32 v87, -1
s_mov_b32 s99, s12
v_cmp_gt_u32 vcc, 220, v0
s_nop 3
s_and_b64 exec, exec, vcc
buffer_load_dwordx4 a[0:3], v11, s[56:59], 0 offen
buffer_load_dwordx4 a[4:7], v12, s[56:59], 0 offen
buffer_load_dwordx4 a[8:11], v13, s[56:59], 0 offen
s_mov_b64 exec, -1
buffer_load_dwordx4 v[238:241], v16, s[56:59], s15 offen
buffer_load_dwordx4 v[242:245], v16, s[56:59], s15 offen offset:512
buffer_load_dwordx2 v[246:247], v18, s[56:59], s15 offen offset:1024
s_mul_i32 s24, s65, 216
s_and_b32 s8, s64, 1
s_mul_i32 s8, s8, 1105920
s_sub_u32 s25, s24, s8
s_add_u32 s24, s24, s8
s_movk_i32 s12, 3456
s_mov_b32 s60, s30
s_mov_b32 s61, s31
s_mov_b32 s62, 0x21c000
s_mov_b32 s63, 0x20000
v_add_u32 v224, 0, v1
v_mul_u32_u24 v4, 586, v224
v_lshrrev_b32 v4, 13, v4
v_mul_u32_u24 v5, 14, v4
v_sub_u32 v224, v224, v5
v_lshlrev_b32 v224, 4, v224
v_mad_u32_u24 v224, v4, s12, v224
v_add_u32 v225, 64, v1
v_mul_u32_u24 v4, 586, v225
v_lshrrev_b32 v4, 13, v4
v_mul_u32_u24 v5, 14, v4
v_sub_u32 v225, v225, v5
v_lshlrev_b32 v225, 4, v225
v_mad_u32_u24 v225, v4, s12, v225
v_subrev_u32 v225, 1024, v225
v_add_u32 v226, 128, v1
v_mul_u32_u24 v4, 586, v226
v_lshrrev_b32 v4, 13, v4
v_mul_u32_u24 v5, 14, v4
v_sub_u32 v226, v226, v5
v_lshlrev_b32 v226, 4, v226
v_mad_u32_u24 v226, v4, s12, v226
v_subrev_u32 v226, 2048, v226
v_add_u32 v227, 192, v1
v_mul_u32_u24 v4, 586, v227
v_lshrrev_b32 v4, 13, v4
v_mul_u32_u24 v5, 14, v4
v_sub_u32 v227, v227, v5
v_lshlrev_b32 v227, 4, v227
v_mad_u32_u24 v227, v4, s12, v227
v_subrev_u32 v227, 3072, v227
v_add_u32 v228, 256, v1
v_mul_u32_u24 v4, 586, v228
v_lshrrev_b32 v4, 13, v4
v_mul_u32_u24 v5, 14, v4
v_sub_u32 v228, v228, v5
v_lshlrev_b32 v228, 4, v228
v_mad_u32_u24 v228, v4, s12, v228
v_add_u32 v229, 320, v1
v_mul_u32_u24 v4, 586, v229
v_lshrrev_b32 v4, 13, v4
v_mul_u32_u24 v5, 14, v4
v_sub_u32 v229, v229, v5
v_lshlrev_b32 v229, 4, v229
v_mad_u32_u24 v229, v4, s12, v229
v_subrev_u32 v229, 1024, v229
v_add_u32 v230, 384, v1
v_mul_u32_u24 v4, 586, v230
v_lshrrev_b32 v4, 13, v4
v_mul_u32_u24 v5, 14, v4
v_sub_u32 v230, v230, v5
v_lshlrev_b32 v230, 4, v230
v_mad_u32_u24 v230, v4, s12, v230
v_subrev_u32 v230, 2048, v230
s_mov_b32 s12, s99
s_lshl_b32 s8, s3, 5
s_add_u32 s8, s8, s4
s_lshl_b32 s8, s8, 2
s_add_u32 s8, s8, s5
s_lshl_b32 s8, s8, 2
s_add_u32 s13, s8, 0x2000
s_waitcnt vmcnt(6)
v_cmp_eq_u32 vcc, s6, v23
s_nop 3
s_cmp_eq_u64 vcc, -1
s_cbranch_scc1 L_xccok
poll_7:
buffer_load_dwordx2 v[22:23], v9, s[44:47], s12 offen sc1
s_waitcnt vmcnt(0)
v_cmp_eq_u32 vcc, s6, v23
s_nop 3
s_cmp_eq_u64 vcc, -1
s_cbranch_scc1 pollok_8
s_sub_u32 s98, s98, 1
s_cbranch_scc0 poll_7
s_mov_b32 s98, 0
pollok_8:
L_xccok:
v_cmp_eq_u32 vcc, s68, v22
s_nop 3
s_cmp_eq_u64 vcc, -1
s_cselect_b32 s7, 0, 1
s_mov_b64 exec, 1
s_cmp_lg_u32 s7, 0
s_cbranch_scc1 L_uslow
buffer_store_dword v2, off, s[44:47], s13
s_branch L_udone
L_uslow:
buffer_store_dword v2, off, s[44:47], s13 sc1
L_udone:
s_mov_b64 exec, -1
s_cmp_ge_u32 s4, 20
s_cbranch_scc1 hC_9
s_lshl_b32 s8, s69, 2
s_add_u32 s8, s8, s5
s_lshl_b32 s8, s8, 12
s_mul_i32 s9, s5, 8448
s_add_u32 m0, s9, 75968
s_nop 0
buffer_load_dwordx4 v3, s[48:51], s8 offen offset:0 lds
buffer_load_dwordx4 v3, s[48:51], s8 offen offset:1024 lds
buffer_load_dwordx4 v3, s[48:51], s8 offen offset:2048 lds
buffer_load_dwordx4 v3, s[48:51], s8 offen offset:3072 lds
s_mov_b64 exec, 1
buffer_load_dword v255, off, s[44:47], 0
buffer_load_dword v255, off, s[44:47], 0
s_mov_b64 exec, -1
s_branch hdone_11
hidle_10:
s_mov_b64 exec, 1
buffer_load_dword v255, off, s[44:47], 0
buffer_load_dword v255, off, s[44:47], 0
buffer_load_dword v255, off, s[44:47], 0
buffer_load_dword v255, off, s[44:47], 0
buffer_load_dword v255, off, s[44:47], 0
buffer_load_dword v255, off, s[44:47], 0
s_mov_b64 exec, -1
s_branch hdone_11
hC_9:
s_cmp_ge_u32 s4, 30
s_cbranch_scc1 hidle_10
s_lshl_b32 s8, s69, 2
s_add_u32 s8, s8, s5
s_lshl_b32 s8, s8, 12
s_mul_i32 s9, s5, 5376
s_add_u32 s10, s8, 0
s_add_u32 m0, s9, 74432
s_nop 0
buffer_load_dwordx4 v3, s[48:51], s10 offen offset:0 lds
buffer_load_dwordx4 v3, s[48:51], s10 offen offset:1024 lds
s_add_u32 s10, s8, 16384
s_add_u32 m0, s9, 95936
s_nop 0
buffer_load_dwordx4 v3, s[48:51], s10 offen offset:0 lds
buffer_load_dwordx4 v3, s[48:51], s10 offen offset:1024 lds
s_mov_b32 exec_lo, 0xffffffff
s_mov_b32 exec_hi, 0x0
s_add_u32 s10, s8, 0
s_add_u32 m0, s9, 74432
s_nop 0
buffer_load_dwordx4 v3, s[48:51], s10 offen offset:2048 lds
s_add_u32 s10, s8, 16384
s_add_u32 m0, s9, 95936
s_nop 0
buffer_load_dwordx4 v3, s[48:51], s10 offen offset:2048 lds
s_mov_b64 exec, -1
hdone_11:
s_cmp_ge_u32 s4, 30
s_cbranch_scc1 L_cidle
s_cmp_ge_u32 s4, 20
s_cbranch_scc1 L_convC
v_mov_b32 v232, 0
v_mov_b32 v233, 0
v_mov_b32 v234, 0
v_mov_b32 v235, 0
s_mul_i32 s8, s5, 8448
s_add_u32 s8, s8, 71680
s_lshr_b32 s9, s5, 1
s_mul_i32 s9, s9, 18304
s_add_u32 s9, s9, 114688
v_and_b32 v6, 15, v1
v_lshlrev_b32 v6, 2, v6
v_bfe_u32 v7, v1, 4, 1
v_sub_u32 v7, 1, v7
v_mul_u32_u24 v7, 4224, v7
v_add3_u32 v6, v6, v7, s8
s_mov_b32 exec_lo, 0x7fffffff
s_mov_b32 exec_hi, 0x0
ds_write_b32 v6, v232 offset:0
s_mov_b64 exec, -1
v_add_u32 v6, s9, v3
s_and_b32 s10, s5, 1
s_mul_i32 s11, s10, 896
v_add_u32 v6, s11, v6
s_lshl_b32 s10, s10, 13
s_add_u32 s9, s9, s10
s_mov_b32 exec_lo, 0xffffffff
s_mov_b32 exec_hi, 0xffffff
ds_write_b128 v6, v[232:235] offset:0
s_mov_b64 exec, -1
v_and_b32 v4, 1, v1
v_mul_u32_u24 v5, 18304, v4
v_mul_u32_u24 v4, 4228, v4
v_and_b32 v7, 15, v1
v_lshl_add_u32 v4, v7, 2, v4
v_and_b32 v6, 48, v1
v_add3_u32 v4, v4, v6, s8
v_lshrrev_b32 v7, 1, v7
v_lshl_add_u32 v5, v7, 8, v5
v_lshlrev_b32 v249, 2, v6
v_sub_u32 v5, v5, v249
v_add_u32 v5, 114880, v5
v_and_b32 v7, 15, v1
v_lshrrev_b32 v6, 2, v6
v_add_u32 v7, v7, v6
s_bitcmp1_b32 s5, 0
s_cselect_b32 s10, 16, 0
s_lshr_b32 s11, s100, s10
s_and_b32 s11, s11, 0xffff
v_mov_b32 v6, s11
v_cmp_eq_u32 vcc, 15, v7
s_nop 1
v_cndmask_b32 v156, 0, v6, vcc
v_cmp_eq_u32 vcc, 14, v7
s_nop 1
v_cndmask_b32 v157, 0, v6, vcc
v_cmp_eq_u32 vcc, 13, v7
s_nop 1
v_cndmask_b32 v158, 0, v6, vcc
v_cmp_eq_u32 vcc, 12, v7
s_nop 1
v_cndmask_b32 v159, 0, v6, vcc
s_lshl_b32 s10, s5, 6
v_lshrrev_b32 v53, 2, v1
v_mad_u32_u24 v53, v53, 5, s10
v_and_b32 v54, 3, v1
v_lshlrev_b32 v62, 6, v53
v_lshl_add_u32 v62, v54, 4, v62
v_subrev_u32 v63, 64, v62
v_cmp_eq_u32 vcc, 0, v53
v_mov_b32 v55, 0x70000000
s_nop 0
v_cndmask_b32 v63, v63, v55, vcc
s_mov_b32 s10, 116480
v_lshl_add_u32 v55, v54, 2, v53
v_and_b32 v55, 12, v55
v_lshl_add_u32 v57, v53, 4, v55
v_lshl_add_u32 v57, v57, 2, s10
v_add_u32 v53, 1, v53
v_lshl_add_u32 v55, v54, 2, v53
v_and_b32 v55, 12, v55
v_lshl_add_u32 v58, v53, 4, v55
v_lshl_add_u32 v58, v58, 2, s10
v_add_u32 v53, 1, v53
v_lshl_add_u32 v55, v54, 2, v53
v_and_b32 v55, 12, v55
v_lshl_add_u32 v59, v53, 4, v55
v_lshl_add_u32 v59, v59, 2, s10
v_add_u32 v53, 1, v53
v_lshl_add_u32 v55, v54, 2, v53
v_and_b32 v55, 12, v55
v_lshl_add_u32 v60, v53, 4, v55
v_lshl_add_u32 v60, v60, 2, s10
v_add_u32 v53, 1, v53
v_lshl_add_u32 v55, v54, 2, v53
v_and_b32 v55, 12, v55
v_lshl_add_u32 v61, v53, 4, v55
v_lshl_add_u32 v61, v61, 2, s10
s_waitcnt lgkmcnt(0)
v_add_u32 v22, 57344, v15
v_cmp_gt_u32 vcc, 220, v0
s_and_b32 s20, s5, 1
s_lshr_b32 s21, s5, 1
v_and_b32 v7, 15, v1
v_mul_u32_u24 v7, 352, v7
v_lshrrev_b32 v19, 4, v1
v_lshl_add_u32 v7, v19, 3, v7
s_add_u32 s11, s3, s21
s_and_b32 s11, s11, 1
s_mul_i32 s12, s20, 5632
s_mul_i32 s13, s21, 96
s_add_u32 s12, s12, s13
s_add_u32 s12, s12, 57520
s_mul_i32 s13, s11, 176
s_add_u32 s15, s12, s13
s_sub_u32 s12, s12, s13
s_add_u32 s12, s12, 176
v_add_u32 v19, s12, v7
v_add_u32 v20, s15, v7
s_lshl_b32 s11, s4, 1
s_add_u32 s11, s11, s20
s_mul_i32 s11, s11, 160
s_mul_i32 s12, s3, 20
s_add_u32 s11, s11, s12
s_mul_i32 s12, s21, 12
s_add_u32 s11, s11, s12
s_lshl_b32 s11, s11, 8
s_add_u32 s15, s11, 0xfc0000
v_mov_b32 v21, 0x3f803f80
v_mov_b32 v28, 0
v_mov_b32 v29, 0
s_waitcnt vmcnt(7)
s_barrier
s_and_b64 exec, exec, vcc
ds_write_b128 v22, a[0:3] offset:0
ds_write_b128 v22, a[4:7] offset:176
ds_write_b128 v22, a[8:11] offset:352
s_mov_b64 exec, -1
v_dot2c_f32_bf16 v28, v238, v21
v_dot2c_f32_bf16 v29, v238, v238
v_dot2c_f32_bf16 v28, v239, v21
v_dot2c_f32_bf16 v29, v239, v239
v_dot2c_f32_bf16 v28, v240, v21
v_dot2c_f32_bf16 v29, v240, v240
v_dot2c_f32_bf16 v28, v241, v21
v_dot2c_f32_bf16 v29, v241, v241
v_dot2c_f32_bf16 v28, v242, v21
v_dot2c_f32_bf16 v29, v242, v242
v_dot2c_f32_bf16 v28, v243, v21
v_dot2c_f32_bf16 v29, v243, v243
v_dot2c_f32_bf16 v28, v244, v21
v_dot2c_f32_bf16 v29, v244, v244
v_dot2c_f32_bf16 v28, v245, v21
v_dot2c_f32_bf16 v29, v245, v245
v_dot2c_f32_bf16 v28, v246, v21
v_dot2c_f32_bf16 v29, v246, v246
v_dot2c_f32_bf16 v28, v247, v21
v_dot2c_f32_bf16 v29, v247, v247
s_waitcnt lgkmcnt(0)
s_barrier
ds_read_b64 a[12:13], v20 offset:0
ds_read_b64 a[14:15], v19 offset:0
ds_read_b64 a[16:17], v19 offset:32
ds_read_b64 a[18:19], v20 offset:32
ds_read_b64 a[20:21], v20 offset:64
ds_read_b64 a[22:23], v19 offset:64
v_add_f32_dpp v28, v28, v28 row_ror:8 row_mask:0xf bank_mask:0xf
v_add_f32_dpp v29, v29, v29 row_ror:8 row_mask:0xf bank_mask:0xf
s_nop 0
v_add_f32_dpp v28, v28, v28 row_ror:4 row_mask:0xf bank_mask:0xf
v_add_f32_dpp v29, v29, v29 row_ror:4 row_mask:0xf bank_mask:0xf
s_nop 0
v_add_f32_dpp v28, v28, v28 row_ror:2 row_mask:0xf bank_mask:0xf
v_add_f32_dpp v29, v29, v29 row_ror:2 row_mask:0xf bank_mask:0xf
s_nop 0
v_add_f32_dpp v28, v28, v28 row_ror:1 row_mask:0xf bank_mask:0xf
v_add_f32_dpp v29, v29, v29 row_ror:1 row_mask:0xf bank_mask:0xf
v_mov_b32 v30, v28
v_mov_b32 v31, v29
s_nop 0
v_permlane16_swap_b32 v28, v30
v_permlane16_swap_b32 v29, v31
v_add_f32 v28, v28, v30
v_add_f32 v29, v29, v31
v_mul_f32 v28, 0x3acccccd, v28
v_mul_f32 v29, 0x3acccccd, v29
v_fma_f32 v29, -v28, v28, v29
v_max_f32 v29, 0, v29
v_add_f32 v29, 0x3727c5ac, v29
v_rsq_f32 v30, v29
s_nop 0
v_mul_f32 v29, v28, v30
v_sub_f32 v29, 0, v29
v_mov_b32 v28, v30
v_mov_b32 v30, s6
v_mov_b32 v31, s6
s_waitcnt lgkmcnt(0)
v_lshlrev_b32 v6, 3, v1
s_lshl_b32 s12, s3, 9
s_add_u32 s12, s12, 0x2000
poll_12:
buffer_load_dwordx2 v[236:237], v6, s[44:47], s12 offen sc1
s_waitcnt vmcnt(0)
v_cmp_eq_u32 vcc, s6, v236
v_cmp_eq_u32 s[10:11], s6, v237
s_nop 3
s_and_b64 vcc, vcc, s[10:11]
s_cmp_eq_u64 vcc, -1
s_cbranch_scc1 pollok_13
s_sub_u32 s98, s98, 1
s_cbranch_scc0 poll_12
s_mov_b32 s98, 0
pollok_13:
s_lshl_b32 s12, s69, 14
s_add_u32 s12, s12, 0x100000
s_mov_b32 exec_hi, 0xfffff
buffer_load_dword v52, v63, s[44:47], s12 offen sc1
buffer_load_dwordx4 v[32:35], v62, s[44:47], s12 offen offset:0 sc1
buffer_load_dwordx4 v[36:39], v62, s[44:47], s12 offen offset:64 sc1
buffer_load_dwordx4 v[40:43], v62, s[44:47], s12 offen offset:128 sc1
buffer_load_dwordx4 v[44:47], v62, s[44:47], s12 offen offset:192 sc1
s_mov_b32 exec_hi, 0xffff
buffer_load_dwordx4 v[48:51], v62, s[44:47], s12 offen offset:256 sc1
s_mov_b32 exec_hi, -1
s_lshl_b32 s8, s2, 3
s_lshl_b32 s10, s5, 1
s_add_u32 s8, s8, s10
s_lshl_b32 s8, s8, 4
s_add_u32 s8, s8, 0x60000
v_lshrrev_b32 v7, 5, v1
v_lshlrev_b32 v7, 4, v7
s_mov_b32 exec_lo, 0x1
s_mov_b32 exec_hi, 0x1
buffer_store_dwordx4 v[28:31], v7, s[44:47], s8 offen sc1
s_mov_b64 exec, -1
buffer_store_dwordx4 a[12:15], v3, s[44:47], s15 offen offset:0 sc1
buffer_store_dwordx4 a[16:19], v3, s[44:47], s15 offen offset:1024 sc1
s_cmp_lt_u32 s5, 2
s_cbranch_scc0 q3_14
buffer_store_dwordx4 a[20:23], v3, s[44:47], s15 offen offset:2048 sc1
s_branch q3d_15
q3_14:
s_mov_b64 exec, 1
buffer_load_dword v255, off, s[44:47], 0
s_mov_b64 exec, -1
q3d_15:
s_barrier
s_cmp_ge_u32 s5, 2
s_cbranch_scc1 xpad_17
s_lshl_b32 s8, s5, 8
s_add_u32 s8, s8, s2
s_cmp_ge_u32 s8, 448
s_cbranch_scc1 xpad_17
s_mov_b32 s52, s34
s_mov_b32 s53, s35
s_mov_b32 s54, 0x21c000
s_mov_b32 s55, 0x20000
s_and_b32 s22, s8, 7
s_lshr_b32 s10, s8, 3
s_mul_i32 s11, s10, 37
s_lshr_b32 s11, s11, 9
s_mul_i32 s12, s11, 14
s_sub_u32 s12, s10, s12
s_mul_i32 s11, s11, 432
s_mul_i32 s13, s12, 11
s_lshr_b32 s13, s13, 5
s_mul_i32 s28, s13, 12
s_lshl_b32 s29, s12, 5
s_add_u32 s28, s28, s29
s_sub_u32 s29, s12, 12
s_mul_i32 s29, s29, 216
s_add_u32 s29, s29, 96
s_cmp_ge_u32 s12, 12
s_cselect_b32 s28, s29, s28
s_cselect_b32 s29, 117760, 0
s_add_u32 s28, s28, s11
s_mul_i32 s28, s28, 1280
s_mul_i32 s22, s22, 160
s_add_u32 s28, s28, s22
s_add_u32 s22, s28, s29
v_add_u32 v19, 0, v1
v_mul_u32_u24 v24, 205, v19
v_lshrrev_b32 v24, 11, v24
v_mul_u32_u24 v25, 10, v24
v_sub_u32 v19, v19, v25
v_lshlrev_b32 v19, 4, v19
v_mul_u32_u24 v24, 1280, v24
v_add_u32 v19, v19, v24
v_add_u32 v20, 64, v1
v_mul_u32_u24 v24, 205, v20
v_lshrrev_b32 v24, 11, v24
v_mul_u32_u24 v25, 10, v24
v_sub_u32 v20, v20, v25
v_lshlrev_b32 v20, 4, v20
v_mul_u32_u24 v24, 1280, v24
v_add_u32 v20, v20, v24
v_subrev_u32 v20, 1024, v20
v_add_u32 v21, 128, v1
v_mul_u32_u24 v24, 205, v21
v_lshrrev_b32 v24, 11, v24
v_mul_u32_u24 v25, 10, v24
v_sub_u32 v21, v21, v25
v_lshlrev_b32 v21, 4, v21
v_mul_u32_u24 v24, 1280, v24
v_add_u32 v21, v21, v24
v_subrev_u32 v21, 2048, v21
v_add_u32 v22, 192, v1
v_mul_u32_u24 v24, 205, v22
v_lshrrev_b32 v24, 11, v24
v_mul_u32_u24 v25, 10, v24
v_sub_u32 v22, v22, v25
v_lshlrev_b32 v22, 4, v22
v_mul_u32_u24 v24, 1280, v24
v_add_u32 v22, v22, v24
v_subrev_u32 v22, 3072, v22
v_add_u32 v23, 256, v1
v_mul_u32_u24 v24, 205, v23
v_lshrrev_b32 v24, 11, v24
v_mul_u32_u24 v25, 10, v24
v_sub_u32 v23, v23, v25
v_lshlrev_b32 v23, 4, v23
v_mul_u32_u24 v24, 1280, v24
v_add_u32 v23, v23, v24
v_lshrrev_b32 v24, 5, v1
v_mul_i32_i24 v24, s29, v24
v_add_u32 v21, v21, v24
s_mul_i32 s10, s5, 5120
s_add_u32 m0, s10, 57344
s_nop 0
buffer_load_dwordx4 v19, s[52:55], s28 offen offset:0 lds
buffer_load_dwordx4 v20, s[52:55], s28 offen offset:1024 lds
buffer_load_dwordx4 v21, s[52:55], s28 offen offset:2048 lds
buffer_load_dwordx4 v22, s[52:55], s22 offen offset:3072 lds
s_add_u32 m0, s10, 61440
s_nop 0
buffer_load_dwordx4 v23, s[52:55], s22 offen lds
s_branch xdone_18
xpad_17:
s_mov_b64 exec, 1
buffer_load_dword v255, off, s[44:47], 0
buffer_load_dword v255, off, s[44:47], 0
buffer_load_dword v255, off, s[44:47], 0
buffer_load_dword v255, off, s[44:47], 0
buffer_load_dword v255, off, s[44:47], 0
s_mov_b64 exec, -1
xdone_18:
s_mov_b32 s52, s32
s_mov_b32 s53, s33
s_mov_b32 s54, 0xd80
s_mov_b32 s55, 0x20000
s_mov_b32 s56, s36
s_mov_b32 s57, s37
s_mov_b32 s58, 0x500
s_mov_b32 s59, 0x20000
s_and_b32 s8, s4, 15
s_mul_i32 s8, s8, 216
buffer_load_ushort v250, v26, s[52:55], s8 offen
s_and_b32 s8, s4, 7
s_mul_i32 s8, s8, 160
buffer_load_dword v251, v27, s[56:59], s8 offen
s_mov_b32 s52, s30
s_mov_b32 s53, s31
s_mov_b32 s54, 0x21c000
s_mov_b32 s55, 0x20000
s_mov_b64 exec, 0x1ffff
buffer_load_dword v255, v14, s[52:55], 0 offen
s_mov_b64 exec, -1
ds_read_b64 v[64:65], v4 offset:0
ds_read_b64 v[66:67], v4 offset:8
ds_read_b64 v[68:69], v4 offset:512
ds_read_b64 v[70:71], v4 offset:520
ds_read_b64 v[72:73], v4 offset:1024
ds_read_b64 v[74:75], v4 offset:1032
ds_read_b64 v[76:77], v4 offset:1536
ds_read_b64 v[78:79], v4 offset:1544
ds_read_b64 v[80:81], v4 offset:2048
ds_read_b64 v[82:83], v4 offset:2056
ds_read_b64 v[84:85], v4 offset:2560
ds_read_b64 v[86:87], v4 offset:2568
ds_read_b64 v[88:89], v4 offset:3072
ds_read_b64 v[90:91], v4 offset:3080
ds_read_b64 v[92:93], v4 offset:3584
ds_read_b64 v[94:95], v4 offset:3592
s_lshl_b32 s8, s5, 8
s_add_u32 s8, s8, s2
v_lshrrev_b32 v252, 2, v1
v_mul_u32_u24 v252, 160, v252
v_and_b32 v254, 3, v1
s_and_b32 s10, s5, 1
s_mul_i32 s10, s10, 5120
s_add_u32 s10, s10, 57344
v_add_u32 v252, s10, v252
v_lshl_add_u32 v253, v254, 3, v252
v_lshl_add_u32 v252, v254, 4, v252
s_lshr_b32 s10, s8, 3
s_mul_i32 s11, s10, 37
s_lshr_b32 s11, s11, 9
s_mul_i32 s11, s11, 14
s_sub_u32 s12, s10, s11
s_mul_i32 s13, s12, 11
s_lshr_b32 s13, s13, 5
s_lshl_b32 s22, s12, 2
s_mul_i32 s13, s13, 11
s_sub_u32 s13, s22, s13
s_add_u32 s13, s13, s11
s_cmp_ge_u32 s12, 12
s_cselect_b32 s10, s10, s13
s_and_b32 s12, s8, 7
s_mul_i32 s12, s12, 56
s_add_u32 s12, s12, s10
s_mul_i32 s12, s12, 5120
s_add_u32 s12, s12, 0x600000
s_cmp_lt_u32 s8, 448
s_cselect_b32 s12, s12, 0x70000000
v_add_u32 v254, s12, v3
s_sub_u32 s16, 7, s5
s_cmp_eq_u32 s5, 3
s_cselect_b32 s16, 2, s16
s_bfe_u32 s17, s69, 0x10002
s_mul_i32 s18, s16, 1280
s_add_u32 s18, s18, s69
s_lshl_b32 s18, s18, 8
s_lshl_b32 s19, s16, 12
s_add_u32 s19, s19, 0x60000
v_lshrrev_b32 v7, 4, v1
v_and_b32 v6, 15, v1
s_mov_b32 s8, 40960
v_mul_u32_u24 v231, s8, v7
v_lshl_add_u32 v231, v6, 4, v231
v_lshlrev_b32 v248, 5, v1
s_lshl_b32 s8, s17, 4
s_sub_u32 s10, 16, s8
v_add_u32 v249, s10, v248
v_add_u32 v248, s8, v248
s_lshl_b32 s23, s3, 3
s_add_u32 s23, s23, s16
s_lshl_b32 s23, s23, 6
s_add_u32 s23, s23, 0x1000
v_and_b32 v31, 15, v1
v_lshlrev_b32 v31, 2, v31
v_mov_b32 v6, v5
v_bfe_u32 v7, v1, 1, 3
v_add_lshl_u32 v7, v7, s5, 4
v_and_or_b32 v5, v7, 48, v6
s_mov_b32 exec_hi, 0xfffff
s_waitcnt vmcnt(16)
ds_write_b128 v57, v[32:35] offset:18304
v_alignbyte_b32 v96, v33, v32, 2
v_alignbyte_b32 v97, v34, v33, 2
v_alignbyte_b32 v98, v35, v34, 2
v_alignbyte_b32 v99, v52, v35, 2
ds_write_b128 v57, v[96:99]
s_waitcnt vmcnt(15)
ds_write_b128 v58, v[36:39] offset:18304
v_alignbyte_b32 v100, v37, v36, 2
v_alignbyte_b32 v101, v38, v37, 2
v_alignbyte_b32 v102, v39, v38, 2
v_alignbyte_b32 v103, v32, v39, 2
ds_write_b128 v58, v[100:103]
s_waitcnt vmcnt(14)
ds_write_b128 v59, v[40:43] offset:18304
v_alignbyte_b32 v104, v41, v40, 2
v_alignbyte_b32 v105, v42, v41, 2
v_alignbyte_b32 v106, v43, v42, 2
v_alignbyte_b32 v107, v36, v43, 2
ds_write_b128 v59, v[104:107]
s_waitcnt vmcnt(13)
ds_write_b128 v60, v[44:47] offset:18304
v_alignbyte_b32 v108, v45, v44, 2
v_alignbyte_b32 v109, v46, v45, 2
v_alignbyte_b32 v110, v47, v46, 2
v_alignbyte_b32 v111, v40, v47, 2
ds_write_b128 v60, v[108:111]
s_mov_b32 exec_hi, 0xffff
s_waitcnt vmcnt(12)
ds_write_b128 v61, v[48:51] offset:18304
v_alignbyte_b32 v112, v49, v48, 2
v_alignbyte_b32 v113, v50, v49, 2
v_alignbyte_b32 v114, v51, v50, 2
v_alignbyte_b32 v115, v44, v51, 2
ds_write_b128 v61, v[112:115]
s_mov_b32 exec_hi, -1
s_waitcnt lgkmcnt(0)
s_barrier
ds_read_b128 v[124:127], v5 offset:16128
ds_read_b128 v[120:123], v5 offset:14080
ds_read_b128 v[116:119], v5 offset:12032
ds_read_b128 v[104:107], v5 offset:5888
ds_read_b128 v[112:115], v5 offset:9984
ds_read_b128 v[100:103], v5 offset:3840
ds_read_b128 v[108:111], v5 offset:7936
ds_read_b128 v[96:99], v5 offset:1792
v_subrev_u32 v7, 16, v7
v_and_or_b32 v5, v7, 48, v6
s_waitcnt lgkmcnt(7)
v_mfma_f32_16x16x32_bf16 v[32:35], v[156:159], v[124:127], 0
s_waitcnt lgkmcnt(6)
v_mfma_f32_16x16x32_bf16 v[36:39], v[156:159], v[120:123], 0
s_add_u32 s8, s5, 0
s_mul_i32 s28, s8, 7168
s_mul_i32 s29, s8, 110592
s_cmp_lt_u32 s8, 10
s_cselect_b32 s8, s24, s25
s_add_u32 s29, s29, s8
s_mov_b32 m0, s28
s_nop 0
buffer_load_dwordx4 v224, s[60:63], s29 offen offset:0 lds
s_waitcnt lgkmcnt(5)
v_mfma_f32_16x16x32_bf16 v[40:43], v[156:159], v[116:119], 0
s_waitcnt lgkmcnt(4)
v_mfma_f32_16x16x32_bf16 v[44:47], v[156:159], v[104:107], 0
v_mfma_f32_16x16x32_bf16 v[32:35], v[64:67], v[124:127], v[32:35]
ds_read_b64 v[128:129], v4 offset:64
buffer_load_dwordx4 v225, s[60:63], s29 offen offset:1024 lds
v_mfma_f32_16x16x32_bf16 v[36:39], v[64:67], v[120:123], v[36:39]
ds_read_b64 v[130:131], v4 offset:72
v_mfma_f32_16x16x32_bf16 v[40:43], v[64:67], v[116:119], v[40:43]
ds_read_b128 v[188:191], v5 offset:15872
v_mfma_f32_16x16x32_bf16 v[44:47], v[64:67], v[104:107], v[44:47]
ds_read_b128 v[184:187], v5 offset:13824
buffer_load_dwordx4 v226, s[60:63], s29 offen offset:2048 lds
v_mfma_f32_16x16x32_bf16 v[32:35], v[68:71], v[120:123], v[32:35]
ds_read_b128 v[180:183], v5 offset:11776
v_mfma_f32_16x16x32_bf16 v[36:39], v[68:71], v[116:119], v[36:39]
ds_read_b128 v[168:171], v5 offset:5632
s_waitcnt lgkmcnt(9)
v_mfma_f32_16x16x32_bf16 v[40:43], v[68:71], v[112:115], v[40:43]
ds_read_b64 v[132:133], v4 offset:576
s_waitcnt lgkmcnt(9)
v_mfma_f32_16x16x32_bf16 v[44:47], v[68:71], v[100:103], v[44:47]
ds_read_b64 v[134:135], v4 offset:584
v_mfma_f32_16x16x32_bf16 v[32:35], v[72:75], v[116:119], v[32:35]
ds_read_b128 v[176:179], v5 offset:9728
v_mfma_f32_16x16x32_bf16 v[36:39], v[72:75], v[112:115], v[36:39]
ds_read_b128 v[164:167], v5 offset:3584
s_waitcnt lgkmcnt(11)
v_mfma_f32_16x16x32_bf16 v[40:43], v[72:75], v[108:111], v[40:43]
ds_read_b64 v[136:137], v4 offset:1088
s_waitcnt lgkmcnt(11)
v_mfma_f32_16x16x32_bf16 v[44:47], v[72:75], v[96:99], v[44:47]
ds_read_b64 v[138:139], v4 offset:1096
v_mfma_f32_16x16x32_bf16 v[32:35], v[76:79], v[112:115], v[32:35]
ds_read_b128 v[172:175], v5 offset:7680
v_mfma_f32_16x16x32_bf16 v[36:39], v[76:79], v[108:111], v[36:39]
ds_read_b128 v[160:163], v5 offset:1536
v_mfma_f32_16x16x32_bf16 v[40:43], v[76:79], v[104:107], v[40:43]
ds_read_b64 v[140:141], v4 offset:1600
v_mfma_f32_16x16x32_bf16 v[32:35], v[80:83], v[108:111], v[32:35]
ds_read_b64 v[142:143], v4 offset:1608
v_mfma_f32_16x16x32_bf16 v[36:39], v[80:83], v[104:107], v[36:39]
ds_read_b64 v[144:145], v4 offset:2112
v_mfma_f32_16x16x32_bf16 v[40:43], v[80:83], v[100:103], v[40:43]
ds_read_b64 v[146:147], v4 offset:2120
v_mfma_f32_16x16x32_bf16 v[32:35], v[84:87], v[104:107], v[32:35]
ds_read_b64 v[148:149], v4 offset:2624
v_mfma_f32_16x16x32_bf16 v[36:39], v[84:87], v[100:103], v[36:39]
ds_read_b64 v[150:151], v4 offset:2632
v_mfma_f32_16x16x32_bf16 v[40:43], v[84:87], v[96:99], v[40:43]
ds_read_b64 v[152:153], v4 offset:3136
v_mfma_f32_16x16x32_bf16 v[32:35], v[88:91], v[100:103], v[32:35]
ds_read_b64 v[154:155], v4 offset:3144
v_mfma_f32_16x16x32_bf16 v[36:39], v[88:91], v[96:99], v[36:39]
ds_read_b64 v[156:157], v4 offset:3648
v_mfma_f32_16x16x32_bf16 v[32:35], v[92:95], v[96:99], v[32:35]
ds_read_b64 v[158:159], v4 offset:3656
v_subrev_u32 v7, 16, v7
v_and_or_b32 v5, v7, 48, v6
s_waitcnt lgkmcnt(15)
v_mfma_f32_16x16x32_bf16 v[32:35], v[128:131], v[188:191], v[32:35]
ds_read_b64 v[64:65], v4 offset:128
v_mfma_f32_16x16x32_bf16 v[36:39], v[128:131], v[184:187], v[36:39]
ds_read_b64 v[66:67], v4 offset:136
s_waitcnt vmcnt(11)
s_lshl_b32 s8, s3, 5
s_add_u32 s8, s8, s4
s_lshl_b32 s8, s8, 2
s_add_u32 s8, s8, s5
s_lshl_b32 s8, s8, 2
s_add_u32 s8, s8, 0x1000
s_cmp_lg_u32 s7, 0
s_cbranch_scc1 qfc_19
buffer_store_dword v2, off, s[44:47], s8
qfb_20:
v_mfma_f32_16x16x32_bf16 v[40:43], v[128:131], v[180:183], v[40:43]
ds_read_b128 v[124:127], v5 offset:15616
v_mfma_f32_16x16x32_bf16 v[44:47], v[128:131], v[168:171], v[44:47]
ds_read_b128 v[120:123], v5 offset:13568
v_mfma_f32_16x16x32_bf16 v[32:35], v[132:135], v[184:187], v[32:35]
ds_read_b128 v[116:119], v5 offset:11520
buffer_load_dwordx4 v227, s[60:63], s29 offen offset:3072 lds
v_mfma_f32_16x16x32_bf16 v[36:39], v[132:135], v[180:183], v[36:39]
ds_read_b128 v[104:107], v5 offset:5376
v_mfma_f32_16x16x32_bf16 v[40:43], v[132:135], v[176:179], v[40:43]
ds_read_b64 v[68:69], v4 offset:640
s_waitcnt lgkmcnt(15)
v_mfma_f32_16x16x32_bf16 v[44:47], v[132:135], v[164:167], v[44:47]
ds_read_b64 v[70:71], v4 offset:648
s_add_u32 m0, s28, 4096
s_nop 0
buffer_load_dwordx4 v228, s[60:63], s29 offen offset:0 lds
v_mfma_f32_16x16x32_bf16 v[32:35], v[136:139], v[180:183], v[32:35]
ds_read_b128 v[112:115], v5 offset:9472
v_mfma_f32_16x16x32_bf16 v[36:39], v[136:139], v[176:179], v[36:39]
ds_read_b128 v[100:103], v5 offset:3328
v_mfma_f32_16x16x32_bf16 v[40:43], v[136:139], v[172:175], v[40:43]
ds_read_b64 v[72:73], v4 offset:1152
buffer_load_dwordx4 v229, s[60:63], s29 offen offset:1024 lds
v_mfma_f32_16x16x32_bf16 v[44:47], v[136:139], v[160:163], v[44:47]
ds_read_b64 v[74:75], v4 offset:1160
v_mfma_f32_16x16x32_bf16 v[32:35], v[140:143], v[176:179], v[32:35]
ds_read_b128 v[108:111], v5 offset:7424
v_mfma_f32_16x16x32_bf16 v[36:39], v[140:143], v[172:175], v[36:39]
ds_read_b128 v[96:99], v5 offset:1280
v_mfma_f32_16x16x32_bf16 v[40:43], v[140:143], v[168:171], v[40:43]
ds_read_b64 v[76:77], v4 offset:1664
s_waitcnt lgkmcnt(15)
v_mfma_f32_16x16x32_bf16 v[32:35], v[144:147], v[172:175], v[32:35]
ds_read_b64 v[78:79], v4 offset:1672
v_mfma_f32_16x16x32_bf16 v[36:39], v[144:147], v[168:171], v[36:39]
ds_read_b64 v[80:81], v4 offset:2176
v_mfma_f32_16x16x32_bf16 v[40:43], v[144:147], v[164:167], v[40:43]
ds_read_b64 v[82:83], v4 offset:2184
v_mfma_f32_16x16x32_bf16 v[32:35], v[148:151], v[168:171], v[32:35]
ds_read_b64 v[84:85], v4 offset:2688
v_mfma_f32_16x16x32_bf16 v[36:39], v[148:151], v[164:167], v[36:39]
ds_read_b64 v[86:87], v4 offset:2696
v_mfma_f32_16x16x32_bf16 v[40:43], v[148:151], v[160:163], v[40:43]
ds_read_b64 v[88:89], v4 offset:3200
v_mfma_f32_16x16x32_bf16 v[32:35], v[152:155], v[164:167], v[32:35]
ds_read_b64 v[90:91], v4 offset:3208
v_mfma_f32_16x16x32_bf16 v[36:39], v[152:155], v[160:163], v[36:39]
ds_read_b64 v[92:93], v4 offset:3712
v_mfma_f32_16x16x32_bf16 v[32:35], v[156:159], v[160:163], v[32:35]
ds_read_b64 v[94:95], v4 offset:3720
v_subrev_u32 v7, 16, v7
v_and_or_b32 v5, v7, 48, v6
s_waitcnt lgkmcnt(15)
v_mfma_f32_16x16x32_bf16 v[32:35], v[64:67], v[124:127], v[32:35]
ds_read_b64 v[128:129], v4 offset:192
v_mfma_f32_16x16x32_bf16 v[36:39], v[64:67], v[120:123], v[36:39]
ds_read_b64 v[130:131], v4 offset:200
buffer_load_dwordx4 v230, s[60:63], s29 offen offset:2048 lds
v_mfma_f32_16x16x32_bf16 v[40:43], v[64:67], v[116:119], v[40:43]
ds_read_b128 v[188:191], v5 offset:15360
v_mfma_f32_16x16x32_bf16 v[44:47], v[64:67], v[104:107], v[44:47]
ds_read_b128 v[184:187], v5 offset:13312
v_mfma_f32_16x16x32_bf16 v[32:35], v[68:71], v[120:123], v[32:35]
ds_read_b128 v[180:183], v5 offset:11264
s_add_u32 s8, s5, 4
s_mul_i32 s28, s8, 7168
s_mul_i32 s29, s8, 110592
s_cmp_lt_u32 s8, 10
s_cselect_b32 s8, s24, s25
s_add_u32 s29, s29, s8
s_mov_b32 m0, s28
s_nop 0
buffer_load_dwordx4 v224, s[60:63], s29 offen offset:0 lds
v_mfma_f32_16x16x32_bf16 v[36:39], v[68:71], v[116:119], v[36:39]
ds_read_b128 v[168:171], v5 offset:5120
v_mfma_f32_16x16x32_bf16 v[40:43], v[68:71], v[112:115], v[40:43]
ds_read_b64 v[132:133], v4 offset:704
s_waitcnt lgkmcnt(15)
v_mfma_f32_16x16x32_bf16 v[44:47], v[68:71], v[100:103], v[44:47]
ds_read_b64 v[134:135], v4 offset:712
buffer_load_dwordx4 v225, s[60:63], s29 offen offset:1024 lds
v_mfma_f32_16x16x32_bf16 v[32:35], v[72:75], v[116:119], v[32:35]
ds_read_b128 v[176:179], v5 offset:9216
v_mfma_f32_16x16x32_bf16 v[36:39], v[72:75], v[112:115], v[36:39]
ds_read_b128 v[164:167], v5 offset:3072
v_mfma_f32_16x16x32_bf16 v[40:43], v[72:75], v[108:111], v[40:43]
ds_read_b64 v[136:137], v4 offset:1216
v_mfma_f32_16x16x32_bf16 v[44:47], v[72:75], v[96:99], v[44:47]
ds_read_b64 v[138:139], v4 offset:1224
v_mfma_f32_16x16x32_bf16 v[32:35], v[76:79], v[112:115], v[32:35]
ds_read_b128 v[172:175], v5 offset:7168
v_mfma_f32_16x16x32_bf16 v[36:39], v[76:79], v[108:111], v[36:39]
ds_read_b128 v[160:163], v5 offset:1024
v_mfma_f32_16x16x32_bf16 v[40:43], v[76:79], v[104:107], v[40:43]
ds_read_b64 v[140:141], v4 offset:1728
s_waitcnt lgkmcnt(15)
v_mfma_f32_16x16x32_bf16 v[32:35], v[80:83], v[108:111], v[32:35]
ds_read_b64 v[142:143], v4 offset:1736
v_mfma_f32_16x16x32_bf16 v[36:39], v[80:83], v[104:107], v[36:39]
ds_read_b64 v[144:145], v4 offset:2240
v_mfma_f32_16x16x32_bf16 v[40:43], v[80:83], v[100:103], v[40:43]
ds_read_b64 v[146:147], v4 offset:2248
v_mfma_f32_16x16x32_bf16 v[32:35], v[84:87], v[104:107], v[32:35]
ds_read_b64 v[148:149], v4 offset:2752
v_mfma_f32_16x16x32_bf16 v[36:39], v[84:87], v[100:103], v[36:39]
ds_read_b64 v[150:151], v4 offset:2760
v_mfma_f32_16x16x32_bf16 v[40:43], v[84:87], v[96:99], v[40:43]
ds_read_b64 v[152:153], v4 offset:3264
v_mfma_f32_16x16x32_bf16 v[32:35], v[88:91], v[100:103], v[32:35]
ds_read_b64 v[154:155], v4 offset:3272
v_mfma_f32_16x16x32_bf16 v[36:39], v[88:91], v[96:99], v[36:39]
ds_read_b64 v[156:157], v4 offset:3776
v_mfma_f32_16x16x32_bf16 v[32:35], v[92:95], v[96:99], v[32:35]
ds_read_b64 v[158:159], v4 offset:3784
v_subrev_u32 v7, 16, v7
v_and_or_b32 v5, v7, 48, v6
s_waitcnt lgkmcnt(15)
v_mfma_f32_16x16x32_bf16 v[32:35], v[128:131], v[188:191], v[32:35]
ds_read_b64 v[64:65], v4 offset:256
v_mfma_f32_16x16x32_bf16 v[36:39], v[128:131], v[184:187], v[36:39]
ds_read_b64 v[66:67], v4 offset:264
buffer_load_dword v30, v31, s[44:47], s23 offen sc1
v_mfma_f32_16x16x32_bf16 v[40:43], v[128:131], v[180:183], v[40:43]
ds_read_b128 v[124:127], v5 offset:15104
v_mfma_f32_16x16x32_bf16 v[44:47], v[128:131], v[168:171], v[44:47]
ds_read_b128 v[120:123], v5 offset:13056
v_mfma_f32_16x16x32_bf16 v[32:35], v[132:135], v[184:187], v[32:35]
ds_read_b128 v[116:119], v5 offset:11008
buffer_load_dwordx4 v226, s[60:63], s29 offen offset:2048 lds
v_mfma_f32_16x16x32_bf16 v[36:39], v[132:135], v[180:183], v[36:39]
ds_read_b128 v[104:107], v5 offset:4864
v_mfma_f32_16x16x32_bf16 v[40:43], v[132:135], v[176:179], v[40:43]
ds_read_b64 v[68:69], v4 offset:768
s_waitcnt lgkmcnt(15)
v_mfma_f32_16x16x32_bf16 v[44:47], v[132:135], v[164:167], v[44:47]
ds_read_b64 v[70:71], v4 offset:776
buffer_load_dwordx4 v227, s[60:63], s29 offen offset:3072 lds
v_mfma_f32_16x16x32_bf16 v[32:35], v[136:139], v[180:183], v[32:35]
ds_read_b128 v[112:115], v5 offset:8960
v_mfma_f32_16x16x32_bf16 v[36:39], v[136:139], v[176:179], v[36:39]
ds_read_b128 v[100:103], v5 offset:2816
v_mfma_f32_16x16x32_bf16 v[40:43], v[136:139], v[172:175], v[40:43]
ds_read_b64 v[72:73], v4 offset:1280
s_add_u32 m0, s28, 4096
s_nop 0
buffer_load_dwordx4 v228, s[60:63], s29 offen offset:0 lds
v_mfma_f32_16x16x32_bf16 v[44:47], v[136:139], v[160:163], v[44:47]
ds_read_b64 v[74:75], v4 offset:1288
v_mfma_f32_16x16x32_bf16 v[32:35], v[140:143], v[176:179], v[32:35]
ds_read_b128 v[108:111], v5 offset:6912
v_mfma_f32_16x16x32_bf16 v[36:39], v[140:143], v[172:175], v[36:39]
ds_read_b128 v[96:99], v5 offset:768
v_mfma_f32_16x16x32_bf16 v[40:43], v[140:143], v[168:171], v[40:43]
ds_read_b64 v[76:77], v4 offset:1792
s_waitcnt lgkmcnt(15)
v_mfma_f32_16x16x32_bf16 v[32:35], v[144:147], v[172:175], v[32:35]
ds_read_b64 v[78:79], v4 offset:1800
v_mfma_f32_16x16x32_bf16 v[36:39], v[144:147], v[168:171], v[36:39]
ds_read_b64 v[80:81], v4 offset:2304
v_mfma_f32_16x16x32_bf16 v[40:43], v[144:147], v[164:167], v[40:43]
ds_read_b64 v[82:83], v4 offset:2312
v_mfma_f32_16x16x32_bf16 v[32:35], v[148:151], v[168:171], v[32:35]
ds_read_b64 v[84:85], v4 offset:2816
v_mfma_f32_16x16x32_bf16 v[36:39], v[148:151], v[164:167], v[36:39]
ds_read_b64 v[86:87], v4 offset:2824
v_mfma_f32_16x16x32_bf16 v[40:43], v[148:151], v[160:163], v[40:43]
ds_read_b64 v[88:89], v4 offset:3328
v_mfma_f32_16x16x32_bf16 v[32:35], v[152:155], v[164:167], v[32:35]
ds_read_b64 v[90:91], v4 offset:3336
v_mfma_f32_16x16x32_bf16 v[36:39], v[152:155], v[160:163], v[36:39]
ds_read_b64 v[92:93], v4 offset:3840
v_mfma_f32_16x16x32_bf16 v[32:35], v[156:159], v[160:163], v[32:35]
ds_read_b64 v[94:95], v4 offset:3848
v_subrev_u32 v7, 16, v7
v_and_or_b32 v5, v7, 48, v6
s_waitcnt lgkmcnt(15)
v_mfma_f32_16x16x32_bf16 v[32:35], v[64:67], v[124:127], v[32:35]
ds_read_b64 v[128:129], v4 offset:320
v_mfma_f32_16x16x32_bf16 v[36:39], v[64:67], v[120:123], v[36:39]
ds_read_b64 v[130:131], v4 offset:328
s_waitcnt vmcnt(17)
ds_read_b64_tr_b16 a[24:25], v252 offset:0
ds_read_b64_tr_b16 a[26:27], v252 offset:2560
v_mfma_f32_16x16x32_bf16 v[40:43], v[64:67], v[116:119], v[40:43]
ds_read_b128 v[188:191], v5 offset:14848
v_mfma_f32_16x16x32_bf16 v[44:47], v[64:67], v[104:107], v[44:47]
ds_read_b128 v[184:187], v5 offset:12800
v_mfma_f32_16x16x32_bf16 v[32:35], v[68:71], v[120:123], v[32:35]
ds_read_b128 v[180:183], v5 offset:10752
ds_read_b64_tr_b16 a[28:29], v252 offset:8
ds_read_b64_tr_b16 a[30:31], v252 offset:2568
v_mfma_f32_16x16x32_bf16 v[36:39], v[68:71], v[116:119], v[36:39]
ds_read_b128 v[168:171], v5 offset:4608
v_mfma_f32_16x16x32_bf16 v[40:43], v[68:71], v[112:115], v[40:43]
ds_read_b64 v[132:133], v4 offset:832
s_waitcnt lgkmcnt(15)
v_mfma_f32_16x16x32_bf16 v[44:47], v[68:71], v[100:103], v[44:47]
ds_read_b64 v[134:135], v4 offset:840
ds_read_b64_tr_b16 a[32:33], v252 offset:64
ds_read_b64_tr_b16 a[34:35], v252 offset:2624
v_mfma_f32_16x16x32_bf16 v[32:35], v[72:75], v[116:119], v[32:35]
ds_read_b128 v[176:179], v5 offset:8704
v_mfma_f32_16x16x32_bf16 v[36:39], v[72:75], v[112:115], v[36:39]
ds_read_b128 v[164:167], v5 offset:2560
v_mfma_f32_16x16x32_bf16 v[40:43], v[72:75], v[108:111], v[40:43]
ds_read_b64 v[136:137], v4 offset:1344
ds_read_b64_tr_b16 a[36:37], v252 offset:72
ds_read_b64_tr_b16 a[38:39], v252 offset:2632
v_mfma_f32_16x16x32_bf16 v[44:47], v[72:75], v[96:99], v[44:47]
ds_read_b64 v[138:139], v4 offset:1352
v_mfma_f32_16x16x32_bf16 v[32:35], v[76:79], v[112:115], v[32:35]
ds_read_b128 v[172:175], v5 offset:6656
v_mfma_f32_16x16x32_bf16 v[36:39], v[76:79], v[108:111], v[36:39]
ds_read_b128 v[160:163], v5 offset:512
ds_read_b64_tr_b16 a[40:41], v253 offset:128
ds_read_b64_tr_b16 a[42:43], v253 offset:2688
v_mfma_f32_16x16x32_bf16 v[40:43], v[76:79], v[104:107], v[40:43]
ds_read_b64 v[140:141], v4 offset:1856
v_mfma_f32_16x16x32_bf16 v[32:35], v[80:83], v[108:111], v[32:35]
ds_read_b64 v[142:143], v4 offset:1864
v_mfma_f32_16x16x32_bf16 v[36:39], v[80:83], v[104:107], v[36:39]
ds_read_b64 v[144:145], v4 offset:2368
buffer_load_dwordx4 v229, s[60:63], s29 offen offset:1024 lds
v_mfma_f32_16x16x32_bf16 v[40:43], v[80:83], v[100:103], v[40:43]
ds_read_b64 v[146:147], v4 offset:2376
v_mfma_f32_16x16x32_bf16 v[32:35], v[84:87], v[104:107], v[32:35]
ds_read_b64 v[148:149], v4 offset:2880
v_mfma_f32_16x16x32_bf16 v[36:39], v[84:87], v[100:103], v[36:39]
ds_read_b64 v[150:151], v4 offset:2888
buffer_load_dwordx4 v230, s[60:63], s29 offen offset:2048 lds
v_mfma_f32_16x16x32_bf16 v[40:43], v[84:87], v[96:99], v[40:43]
ds_read_b64 v[152:153], v4 offset:3392
s_waitcnt lgkmcnt(15)
v_mfma_f32_16x16x32_bf16 v[32:35], v[88:91], v[100:103], v[32:35]
ds_read_b64 v[154:155], v4 offset:3400
v_mfma_f32_16x16x32_bf16 v[36:39], v[88:91], v[96:99], v[36:39]
ds_read_b64 v[156:157], v4 offset:3904
v_mfma_f32_16x16x32_bf16 v[32:35], v[92:95], v[96:99], v[32:35]
ds_read_b64 v[158:159], v4 offset:3912
v_subrev_u32 v7, 16, v7
v_and_or_b32 v5, v7, 48, v6
v_mfma_f32_16x16x32_bf16 v[32:35], v[128:131], v[188:191], v[32:35]
ds_read_b64 v[64:65], v4 offset:384
v_mfma_f32_16x16x32_bf16 v[36:39], v[128:131], v[184:187], v[36:39]
ds_read_b64 v[66:67], v4 offset:392
buffer_load_dwordx4 v[232:235], v248, s[44:47], s19 offen offset:0 sc1
buffer_load_dwordx4 v[236:239], v249, s[44:47], s19 offen offset:0 sc1
buffer_load_dwordx4 v[240:243], v248, s[44:47], s19 offen offset:2048 sc1
buffer_load_dwordx4 v[244:247], v249, s[44:47], s19 offen offset:2048 sc1
v_mfma_f32_16x16x32_bf16 v[40:43], v[128:131], v[180:183], v[40:43]
ds_read_b128 v[124:127], v5 offset:14592
v_mfma_f32_16x16x32_bf16 v[44:47], v[128:131], v[168:171], v[44:47]
ds_read_b128 v[120:123], v5 offset:12544
v_mfma_f32_16x16x32_bf16 v[32:35], v[132:135], v[184:187], v[32:35]
ds_read_b128 v[116:119], v5 offset:10496
v_mfma_f32_16x16x32_bf16 v[36:39], v[132:135], v[180:183], v[36:39]
ds_read_b128 v[104:107], v5 offset:4352
v_mfma_f32_16x16x32_bf16 v[40:43], v[132:135], v[176:179], v[40:43]
ds_read_b64 v[68:69], v4 offset:896
v_mfma_f32_16x16x32_bf16 v[44:47], v[132:135], v[164:167], v[44:47]
ds_read_b64 v[70:71], v4 offset:904
s_waitcnt lgkmcnt(15)
v_mfma_f32_16x16x32_bf16 v[32:35], v[136:139], v[180:183], v[32:35]
ds_read_b128 v[112:115], v5 offset:8448
v_mfma_f32_16x16x32_bf16 v[36:39], v[136:139], v[176:179], v[36:39]
ds_read_b128 v[100:103], v5 offset:2304
v_mfma_f32_16x16x32_bf16 v[40:43], v[136:139], v[172:175], v[40:43]
ds_read_b64 v[72:73], v4 offset:1408
v_mfma_f32_16x16x32_bf16 v[44:47], v[136:139], v[160:163], v[44:47]
ds_read_b64 v[74:75], v4 offset:1416
v_mfma_f32_16x16x32_bf16 v[32:35], v[140:143], v[176:179], v[32:35]
ds_read_b128 v[108:111], v5 offset:6400
v_mfma_f32_16x16x32_bf16 v[36:39], v[140:143], v[172:175], v[36:39]
ds_read_b128 v[96:99], v5 offset:256
v_mfma_f32_16x16x32_bf16 v[40:43], v[140:143], v[168:171], v[40:43]
ds_read_b64 v[76:77], v4 offset:1920
s_waitcnt lgkmcnt(15)
v_mfma_f32_16x16x32_bf16 v[32:35], v[144:147], v[172:175], v[32:35]
ds_read_b64 v[78:79], v4 offset:1928
v_mfma_f32_16x16x32_bf16 v[36:39], v[144:147], v[168:171], v[36:39]
ds_read_b64 v[80:81], v4 offset:2432
v_mfma_f32_16x16x32_bf16 v[40:43], v[144:147], v[164:167], v[40:43]
ds_read_b64 v[82:83], v4 offset:2440
v_mfma_f32_16x16x32_bf16 v[32:35], v[148:151], v[168:171], v[32:35]
ds_read_b64 v[84:85], v4 offset:2944
v_mfma_f32_16x16x32_bf16 v[36:39], v[148:151], v[164:167], v[36:39]
ds_read_b64 v[86:87], v4 offset:2952
v_mfma_f32_16x16x32_bf16 v[40:43], v[148:151], v[160:163], v[40:43]
ds_read_b64 v[88:89], v4 offset:3456
v_mfma_f32_16x16x32_bf16 v[32:35], v[152:155], v[164:167], v[32:35]
ds_read_b64 v[90:91], v4 offset:3464
v_mfma_f32_16x16x32_bf16 v[36:39], v[152:155], v[160:163], v[36:39]
ds_read_b64 v[92:93], v4 offset:3968
v_mfma_f32_16x16x32_bf16 v[32:35], v[156:159], v[160:163], v[32:35]
ds_read_b64 v[94:95], v4 offset:3976
v_subrev_u32 v7, 16, v7
v_and_or_b32 v5, v7, 48, v6
s_waitcnt lgkmcnt(15)
v_mfma_f32_16x16x32_bf16 v[32:35], v[64:67], v[124:127], v[32:35]
ds_read_b64 v[128:129], v4 offset:448
v_mfma_f32_16x16x32_bf16 v[36:39], v[64:67], v[120:123], v[36:39]
ds_read_b64 v[130:131], v4 offset:456
s_waitcnt vmcnt(9)
v_cmp_ne_u32 vcc, s6, v30
s_nop 3
s_cbranch_vccz qok_21
poll_22:
buffer_load_dword v30, v31, s[44:47], s23 offen sc1
s_waitcnt vmcnt(0)
v_cmp_eq_u32 vcc, s6, v30
s_nop 3
s_cmp_eq_u64 vcc, -1
s_cbranch_scc1 pollok_23
s_sub_u32 s98, s98, 1
s_cbranch_scc0 poll_22
s_mov_b32 s98, 0
pollok_23:
qok_21:
s_add_u32 s8, s18, 0xfc0000
buffer_load_dwordx4 v[8:11], v231, s[44:47], s8 offen offset:0 sc1
s_add_u32 s8, s18, 0xfe8000
buffer_load_dwordx4 v[12:15], v231, s[44:47], s8 offen offset:0 sc1
v_mfma_f32_16x16x32_bf16 v[40:43], v[64:67], v[116:119], v[40:43]
ds_read_b128 v[188:191], v5 offset:14336
v_mfma_f32_16x16x32_bf16 v[44:47], v[64:67], v[104:107], v[44:47]
ds_read_b128 v[184:187], v5 offset:12288
v_mfma_f32_16x16x32_bf16 v[32:35], v[68:71], v[120:123], v[32:35]
ds_read_b128 v[180:183], v5 offset:10240
v_mfma_f32_16x16x32_bf16 v[36:39], v[68:71], v[116:119], v[36:39]
ds_read_b128 v[168:171], v5 offset:4096
v_mfma_f32_16x16x32_bf16 v[40:43], v[68:71], v[112:115], v[40:43]
ds_read_b64 v[132:133], v4 offset:960
s_waitcnt lgkmcnt(15)
v_mfma_f32_16x16x32_bf16 v[44:47], v[68:71], v[100:103], v[44:47]
ds_read_b64 v[134:135], v4 offset:968
v_mfma_f32_16x16x32_bf16 v[32:35], v[72:75], v[116:119], v[32:35]
ds_read_b128 v[176:179], v5 offset:8192
v_mfma_f32_16x16x32_bf16 v[36:39], v[72:75], v[112:115], v[36:39]
ds_read_b128 v[164:167], v5 offset:2048
v_mfma_f32_16x16x32_bf16 v[40:43], v[72:75], v[108:111], v[40:43]
ds_read_b64 v[136:137], v4 offset:1472
v_mfma_f32_16x16x32_bf16 v[44:47], v[72:75], v[96:99], v[44:47]
ds_read_b64 v[138:139], v4 offset:1480
v_mfma_f32_16x16x32_bf16 v[32:35], v[76:79], v[112:115], v[32:35]
ds_read_b128 v[172:175], v5 offset:6144
v_mfma_f32_16x16x32_bf16 v[36:39], v[76:79], v[108:111], v[36:39]
ds_read_b128 v[160:163], v5 offset:0
v_mfma_f32_16x16x32_bf16 v[40:43], v[76:79], v[104:107], v[40:43]
ds_read_b64 v[140:141], v4 offset:1984
s_waitcnt lgkmcnt(15)
v_mfma_f32_16x16x32_bf16 v[32:35], v[80:83], v[108:111], v[32:35]
ds_read_b64 v[142:143], v4 offset:1992
v_mfma_f32_16x16x32_bf16 v[36:39], v[80:83], v[104:107], v[36:39]
ds_read_b64 v[144:145], v4 offset:2496
v_mfma_f32_16x16x32_bf16 v[40:43], v[80:83], v[100:103], v[40:43]
ds_read_b64 v[146:147], v4 offset:2504
v_mfma_f32_16x16x32_bf16 v[32:35], v[84:87], v[104:107], v[32:35]
ds_read_b64 v[148:149], v4 offset:3008
v_mfma_f32_16x16x32_bf16 v[36:39], v[84:87], v[100:103], v[36:39]
ds_read_b64 v[150:151], v4 offset:3016
v_mfma_f32_16x16x32_bf16 v[40:43], v[84:87], v[96:99], v[40:43]
ds_read_b64 v[152:153], v4 offset:3520
v_mfma_f32_16x16x32_bf16 v[32:35], v[88:91], v[100:103], v[32:35]
ds_read_b64 v[154:155], v4 offset:3528
v_mfma_f32_16x16x32_bf16 v[36:39], v[88:91], v[96:99], v[36:39]
ds_read_b64 v[156:157], v4 offset:4032
v_mfma_f32_16x16x32_bf16 v[32:35], v[92:95], v[96:99], v[32:35]
ds_read_b64 v[158:159], v4 offset:4040
s_waitcnt lgkmcnt(15)
v_mfma_f32_16x16x32_bf16 v[32:35], v[128:131], v[188:191], v[32:35]
v_mfma_f32_16x16x32_bf16 v[36:39], v[128:131], v[184:187], v[36:39]
v_mfma_f32_16x16x32_bf16 v[40:43], v[128:131], v[180:183], v[40:43]
v_mfma_f32_16x16x32_bf16 v[44:47], v[128:131], v[168:171], v[44:47]
v_mfma_f32_16x16x32_bf16 v[32:35], v[132:135], v[184:187], v[32:35]
v_mfma_f32_16x16x32_bf16 v[36:39], v[132:135], v[180:183], v[36:39]
v_mfma_f32_16x16x32_bf16 v[40:43], v[132:135], v[176:179], v[40:43]
s_waitcnt lgkmcnt(14)
v_mfma_f32_16x16x32_bf16 v[44:47], v[132:135], v[164:167], v[44:47]
s_waitcnt lgkmcnt(12)
v_mfma_f32_16x16x32_bf16 v[32:35], v[136:139], v[180:183], v[32:35]
v_mfma_f32_16x16x32_bf16 v[36:39], v[136:139], v[176:179], v[36:39]
s_waitcnt lgkmcnt(11)
v_mfma_f32_16x16x32_bf16 v[40:43], v[136:139], v[172:175], v[40:43]
s_waitcnt lgkmcnt(10)
v_mfma_f32_16x16x32_bf16 v[44:47], v[136:139], v[160:163], v[44:47]
s_waitcnt lgkmcnt(8)
v_mfma_f32_16x16x32_bf16 v[32:35], v[140:143], v[176:179], v[32:35]
v_mfma_f32_16x16x32_bf16 v[36:39], v[140:143], v[172:175], v[36:39]
v_mfma_f32_16x16x32_bf16 v[40:43], v[140:143], v[168:171], v[40:43]
s_waitcnt lgkmcnt(6)
v_mfma_f32_16x16x32_bf16 v[32:35], v[144:147], v[172:175], v[32:35]
v_mfma_f32_16x16x32_bf16 v[36:39], v[144:147], v[168:171], v[36:39]
v_mfma_f32_16x16x32_bf16 v[40:43], v[144:147], v[164:167], v[40:43]
s_waitcnt lgkmcnt(4)
v_mfma_f32_16x16x32_bf16 v[32:35], v[148:151], v[168:171], v[32:35]
v_mfma_f32_16x16x32_bf16 v[36:39], v[148:151], v[164:167], v[36:39]
v_mfma_f32_16x16x32_bf16 v[40:43], v[148:151], v[160:163], v[40:43]
s_waitcnt lgkmcnt(2)
v_mfma_f32_16x16x32_bf16 v[32:35], v[152:155], v[164:167], v[32:35]
v_mfma_f32_16x16x32_bf16 v[36:39], v[152:155], v[160:163], v[36:39]
s_waitcnt lgkmcnt(0)
v_mfma_f32_16x16x32_bf16 v[32:35], v[156:159], v[160:163], v[32:35]
s_barrier
s_mul_i32 s8, s5, 2080
s_add_u32 s8, s8, 143360
v_lshlrev_b32 v6, 3, v1
v_add_u32 v6, s8, v6
s_nop 2
v_cvt_pk_bf16_f32 v64, v32, v33
v_cvt_pk_bf16_f32 v65, v34, v35
ds_write_b64 v6, v[64:65] offset:0
v_cvt_pk_bf16_f32 v66, v36, v37
v_cvt_pk_bf16_f32 v67, v38, v39
ds_write_b64 v6, v[66:67] offset:512
v_cvt_pk_bf16_f32 v68, v40, v41
v_cvt_pk_bf16_f32 v69, v42, v43
ds_write_b64 v6, v[68:69] offset:1024
v_cvt_pk_bf16_f32 v70, v44, v45
v_cvt_pk_bf16_f32 v71, v46, v47
ds_write_b64 v6, v[70:71] offset:1536
v_bfe_u32 v7, v1, 2, 2
v_mul_u32_u24 v7, 2080, v7
v_and_b32 v4, 3, v1
v_lshl_add_u32 v7, v4, 7, v7
v_and_b32 v4, 48, v1
s_lshl_b32 s8, s5, 9
s_add_u32 s8, s8, 143360
v_add3_u32 v7, v7, v4, s8
s_lshl_b32 s8, s17, 3
s_sub_u32 s10, 8, s8
v_add_u32 v4, s8, v7
v_add_u32 v5, s10, v7
s_waitcnt lgkmcnt(0)
s_barrier
ds_read_b64_tr_b16 v[64:65], v4 offset:0
ds_read_b64_tr_b16 v[66:67], v5 offset:0
ds_read_b64_tr_b16 v[68:69], v4 offset:64
ds_read_b64_tr_b16 v[70:71], v5 offset:64
s_waitcnt vmcnt(0)
v_cmp_eq_u32 vcc, s6, v234
v_cmp_eq_u32 s[10:11], s6, v238
s_nop 3
s_and_b64 vcc, vcc, s[10:11]
v_cmp_eq_u32 s[10:11], s6, v242
s_nop 3
s_and_b64 vcc, vcc, s[10:11]
v_cmp_eq_u32 s[10:11], s6, v246
s_nop 3
s_and_b64 vcc, vcc, s[10:11]
s_cmp_eq_u64 vcc, -1
s_cbranch_scc1 stok_24
poll_25:
buffer_load_dwordx4 v[232:235], v248, s[44:47], s19 offen offset:0 sc1
buffer_load_dwordx4 v[236:239], v249, s[44:47], s19 offen offset:0 sc1
buffer_load_dwordx4 v[240:243], v248, s[44:47], s19 offen offset:2048 sc1
buffer_load_dwordx4 v[244:247], v249, s[44:47], s19 offen offset:2048 sc1
s_waitcnt vmcnt(0)
v_cmp_eq_u32 vcc, s6, v234
v_cmp_eq_u32 s[10:11], s6, v238
s_nop 3
s_and_b64 vcc, vcc, s[10:11]
v_cmp_eq_u32 s[10:11], s6, v242
s_nop 3
s_and_b64 vcc, vcc, s[10:11]
v_cmp_eq_u32 s[10:11], s6, v246
s_nop 3
s_and_b64 vcc, vcc, s[10:11]
s_cmp_eq_u64 vcc, -1
s_cbranch_scc1 pollok_26
s_sub_u32 s98, s98, 1
s_cbranch_scc0 poll_25
s_mov_b32 s98, 0
pollok_26:
stok_24:
s_add_u32 s20, s18, 0x840000
s_add_u32 s21, s18, 0xac0000
s_waitcnt lgkmcnt(2)
v_lshlrev_b32 v128, 16, v8
v_and_b32 v129, s14, v8
v_lshlrev_b32 v136, 16, v64
v_and_b32 v137, s14, v64
v_lshlrev_b32 v130, 16, v9
v_and_b32 v131, s14, v9
v_lshlrev_b32 v138, 16, v65
v_and_b32 v139, s14, v65
v_lshlrev_b32 v132, 16, v10
v_and_b32 v133, s14, v10
v_lshlrev_b32 v140, 16, v66
v_and_b32 v141, s14, v66
v_lshlrev_b32 v134, 16, v11
v_and_b32 v135, s14, v11
v_lshlrev_b32 v142, 16, v67
v_and_b32 v143, s14, v67
v_pk_fma_f32 v[144:145], v[128:129], v[232:233], v[232:233] op_sel:[0,0,1] op_sel_hi:[1,0,1]
v_pk_fma_f32 v[146:147], v[130:131], v[232:233], v[232:233] op_sel:[0,0,1] op_sel_hi:[1,0,1]
v_pk_fma_f32 v[148:149], v[132:133], v[236:237], v[236:237] op_sel:[0,0,1] op_sel_hi:[1,0,1]
v_pk_fma_f32 v[150:151], v[134:135], v[236:237], v[236:237] op_sel:[0,0,1] op_sel_hi:[1,0,1]
v_pk_fma_f32 v[144:145], v[144:145], v[136:137], v[128:129]
v_pk_fma_f32 v[146:147], v[146:147], v[138:139], v[130:131]
v_pk_fma_f32 v[148:149], v[148:149], v[140:141], v[132:133]
v_pk_fma_f32 v[150:151], v[150:151], v[142:143], v[134:135]
v_cvt_pk_bf16_f32 v112, v144, v145
v_cvt_pk_bf16_f32 v113, v146, v147
v_cvt_pk_bf16_f32 v114, v148, v149
v_cvt_pk_bf16_f32 v115, v150, v151
buffer_store_dwordx4 v[112:115], v231, s[44:47], s21 offen offset:0 sc1
s_add_u32 s20, s18, 0x868000
s_add_u32 s21, s18, 0xae8000
s_waitcnt lgkmcnt(0)
v_lshlrev_b32 v128, 16, v12
v_and_b32 v129, s14, v12
v_lshlrev_b32 v136, 16, v68
v_and_b32 v137, s14, v68
v_lshlrev_b32 v130, 16, v13
v_and_b32 v131, s14, v13
v_lshlrev_b32 v138, 16, v69
v_and_b32 v139, s14, v69
v_lshlrev_b32 v132, 16, v14
v_and_b32 v133, s14, v14
v_lshlrev_b32 v140, 16, v70
v_and_b32 v141, s14, v70
v_lshlrev_b32 v134, 16, v15
v_and_b32 v135, s14, v15
v_lshlrev_b32 v142, 16, v71
v_and_b32 v143, s14, v71
v_pk_fma_f32 v[144:145], v[128:129], v[240:241], v[240:241] op_sel:[0,0,1] op_sel_hi:[1,0,1]
v_pk_fma_f32 v[146:147], v[130:131], v[240:241], v[240:241] op_sel:[0,0,1] op_sel_hi:[1,0,1]
v_pk_fma_f32 v[148:149], v[132:133], v[244:245], v[244:245] op_sel:[0,0,1] op_sel_hi:[1,0,1]
v_pk_fma_f32 v[150:151], v[134:135], v[244:245], v[244:245] op_sel:[0,0,1] op_sel_hi:[1,0,1]
v_pk_fma_f32 v[144:145], v[144:145], v[136:137], v[128:129]
v_pk_fma_f32 v[146:147], v[146:147], v[138:139], v[130:131]
v_pk_fma_f32 v[148:149], v[148:149], v[140:141], v[132:133]
v_pk_fma_f32 v[150:151], v[150:151], v[142:143], v[134:135]
v_cvt_pk_bf16_f32 v116, v144, v145
v_cvt_pk_bf16_f32 v117, v146, v147
v_cvt_pk_bf16_f32 v118, v148, v149
v_cvt_pk_bf16_f32 v119, v150, v151
buffer_store_dwordx4 v[116:119], v231, s[44:47], s21 offen offset:0 sc1
buffer_store_dwordx4 a[24:27], v254, s[44:47], 0 offen offset:0 sc1
buffer_store_dwordx4 a[28:31], v254, s[44:47], 0 offen offset:1024 sc1
buffer_store_dwordx4 a[32:35], v254, s[44:47], 0 offen offset:2048 sc1
buffer_store_dwordx4 a[36:39], v254, s[44:47], 0 offen offset:3072 sc1
s_movk_i32 s8, 0x1000
buffer_store_dwordx4 a[40:43], v254, s[44:47], s8 offen sc1
s_add_u32 s8, s5, 8
s_mul_i32 s28, s8, 7168
s_mul_i32 s29, s8, 110592
s_cmp_lt_u32 s8, 10
s_cselect_b32 s8, s24, s25
s_add_u32 s29, s29, s8
s_mov_b32 m0, s28
s_nop 0
buffer_load_dwordx4 v224, s[60:63], s29 offen offset:0 lds
buffer_load_dwordx4 v225, s[60:63], s29 offen offset:1024 lds
buffer_load_dwordx4 v226, s[60:63], s29 offen offset:2048 lds
buffer_load_dwordx4 v227, s[60:63], s29 offen offset:3072 lds
s_add_u32 m0, s28, 4096
s_nop 0
buffer_load_dwordx4 v228, s[60:63], s29 offen offset:0 lds
s_mul_i32 s8, s5, 7168
v_lshrrev_b32 v4, 2, v1
v_mul_u32_u24 v4, 224, v4
v_and_b32 v5, 3, v1
v_lshl_add_u32 v4, v5, 3, v4
v_add_u32 v4, s8, v4
v_add_u32 v5, 0x15000, v4
v_mov_b32 v80, 0x3f803f80
v_mov_b32 v81, 0x3f803f80
v_mov_b32 v82, 0x3f803f80
v_mov_b32 v83, 0x3f803f80
ds_read_b64_tr_b16 v[96:97], v4 offset:0
ds_read_b64_tr_b16 v[98:99], v4 offset:3584
ds_read_b64_tr_b16 v[100:101], v4 offset:32
ds_read_b64_tr_b16 v[102:103], v4 offset:3616
ds_read_b64_tr_b16 v[104:105], v4 offset:64
ds_read_b64_tr_b16 v[106:107], v4 offset:3648
ds_read_b64_tr_b16 v[108:109], v4 offset:96
ds_read_b64_tr_b16 v[110:111], v4 offset:3680
ds_read_b64_tr_b16 v[112:113], v4 offset:128
ds_read_b64_tr_b16 v[114:115], v4 offset:3712
ds_read_b64_tr_b16 v[116:117], v4 offset:160
ds_read_b64_tr_b16 v[118:119], v4 offset:3744
ds_read_b64_tr_b16 v[120:121], v4 offset:192
ds_read_b64_tr_b16 v[122:123], v4 offset:3776
s_waitcnt lgkmcnt(12)
v_mfma_f32_16x16x32_bf16 v[32:35], v[96:99], v[80:83], 0
ds_read_b64_tr_b16 v[124:125], v4 offset:28672
ds_read_b64_tr_b16 v[126:127], v4 offset:32256
s_waitcnt lgkmcnt(12)
v_mfma_f32_16x16x32_bf16 v[36:39], v[100:103], v[80:83], 0
ds_read_b64_tr_b16 v[128:129], v4 offset:28704
ds_read_b64_tr_b16 v[130:131], v4 offset:32288
s_waitcnt lgkmcnt(12)
v_mfma_f32_16x16x32_bf16 v[40:43], v[104:107], v[80:83], 0
ds_read_b64_tr_b16 v[132:133], v4 offset:28736
ds_read_b64_tr_b16 v[134:135], v4 offset:32320
s_waitcnt lgkmcnt(12)
v_mfma_f32_16x16x32_bf16 v[44:47], v[108:111], v[80:83], 0
ds_read_b64_tr_b16 v[136:137], v4 offset:28768
ds_read_b64_tr_b16 v[138:139], v4 offset:32352
s_waitcnt lgkmcnt(12)
v_mfma_f32_16x16x32_bf16 v[48:51], v[112:115], v[80:83], 0
ds_read_b64_tr_b16 v[140:141], v4 offset:28800
ds_read_b64_tr_b16 v[142:143], v4 offset:32384
s_waitcnt lgkmcnt(12)
v_mfma_f32_16x16x32_bf16 v[52:55], v[116:119], v[80:83], 0
ds_read_b64_tr_b16 v[144:145], v4 offset:28832
ds_read_b64_tr_b16 v[146:147], v4 offset:32416
s_waitcnt lgkmcnt(12)
v_mfma_f32_16x16x32_bf16 v[56:59], v[120:123], v[80:83], 0
ds_read_b64_tr_b16 v[148:149], v4 offset:28864
ds_read_b64_tr_b16 v[150:151], v4 offset:32448
s_waitcnt lgkmcnt(12)
v_mfma_f32_16x16x32_bf16 v[32:35], v[124:127], v[80:83], v[32:35]
s_waitcnt lgkmcnt(10)
v_mfma_f32_16x16x32_bf16 v[36:39], v[128:131], v[80:83], v[36:39]
s_waitcnt lgkmcnt(8)
v_mfma_f32_16x16x32_bf16 v[40:43], v[132:135], v[80:83], v[40:43]
s_waitcnt lgkmcnt(6)
v_mfma_f32_16x16x32_bf16 v[44:47], v[136:139], v[80:83], v[44:47]
s_waitcnt lgkmcnt(4)
v_mfma_f32_16x16x32_bf16 v[48:51], v[140:143], v[80:83], v[48:51]
s_waitcnt lgkmcnt(2)
v_mfma_f32_16x16x32_bf16 v[52:55], v[144:147], v[80:83], v[52:55]
s_waitcnt lgkmcnt(0)
v_mfma_f32_16x16x32_bf16 v[56:59], v[148:151], v[80:83], v[56:59]
s_lshl_b32 s8, s16, 10
s_lshl_b32 s9, s69, 2
s_add_u32 s8, s8, s9
s_add_u32 s8, s8, 0x4000
v_mov_b32 v6, s6
v_mov_b32 v7, s6
s_waitcnt vmcnt(5)
s_mov_b64 exec, 1
buffer_store_dword v6, off, s[44:47], s8 sc1
s_mov_b64 exec, -1
s_add_u32 s100, s8, 0x14000
s_mov_b64 s[22:23], 1
s_lshl_b32 s8, s5, 8
s_add_u32 s8, s8, s2
s_cmp_ge_u32 s8, 448
s_cbranch_scc1 nopf_27
s_and_b32 s9, s8, 7
s_lshr_b32 s10, s8, 3
s_lshl_b32 s9, s9, 6
s_add_u32 s9, s9, s10
s_lshl_b32 s9, s9, 2
s_add_u32 s9, s9, 0x3000
s_mov_b64 exec, 1
buffer_store_dword v2, off, s[44:47], s9 sc1
s_mov_b64 exec, -1
nopf_27:
buffer_load_dwordx4 v229, s[60:63], s29 offen offset:1024 lds
v_min_u32 v22, 55, v1
v_lshlrev_b32 v22, 2, v22
s_lshl_b32 s10, s67, 8
s_add_u32 s12, s10, 0x3000
v_min_u32 v12, 39, v1
v_lshlrev_b32 v12, 4, v12
buffer_load_dwordx4 v230, s[60:63], s29 offen offset:2048 lds
s_lshl_b32 s30, s3, 10
s_add_u32 s30, s30, 0x4000
s_lshr_b32 s10, 0xe4, s3
s_bitcmp1_b32 s10, 0
s_cselect_b32 s31, 0, 7168
s_cselect_b32 s11, 80, 0
s_add_u32 s31, s31, 0x4000
v_lshrrev_b32 v26, 5, v1
s_add_u32 s8, s5, 12
s_mul_i32 s28, s8, 7168
s_mul_i32 s29, s8, 110592
s_cmp_lt_u32 s8, 10
s_cselect_b32 s8, s24, s25
s_add_u32 s29, s29, s8
s_mov_b32 m0, s28
s_nop 0
buffer_load_dwordx4 v224, s[60:63], s29 offen offset:0 lds
v_lshlrev_b32 v26, 7, v26
v_and_b32 v27, 31, v1
v_add_u32 v26, v26, v27
v_mul_u32_u24 v26, 224, v26
s_mul_i32 s11, s5, 7168
s_add_u32 s11, s11, 216
buffer_load_dwordx4 v225, s[60:63], s29 offen offset:1024 lds
v_add_u32 v24, s11, v26
v_add_u32 v7, 0x1c000, v24
v_mov_b32 v25, 0x3f80
v_lshlrev_b32 v220, 16, v250
v_mul_f32 v220, 0x3eeff558, v220
v_lshrrev_b32 v20, 4, v1
buffer_load_dwordx4 v226, s[60:63], s29 offen offset:2048 lds
v_lshlrev_b32 v20, 4, v20
s_mul_i32 s10, s5, 448
s_add_u32 s10, s10, 160000
v_add_u32 v20, s10, v20
v_and_b32 v21, 127, v0
v_lshlrev_b32 v222, 2, v21
buffer_load_dwordx4 v227, s[60:63], s29 offen offset:3072 lds
v_add_u32 v222, 160000, v222
s_lshr_b32 s10, s5, 1
s_mul_i32 s10, s10, 112
v_add_u32 v221, s10, v21
v_mul_u32_u24 v221, 224, v221
v_mov_b32 v26, 162048
s_add_u32 m0, s28, 4096
s_nop 0
buffer_load_dwordx4 v228, s[60:63], s29 offen offset:0 lds
v_cmp_gt_u32 vcc, 112, v21
s_nop 1
v_cndmask_b32 v221, v26, v221, vcc
s_cmp_lt_u32 s5, 2
s_cselect_b64 s[68:69], -1, 0
s_mov_b64 s[0:1], s[22:23]
v_lshlrev_b32 v223, 2, v1
s_mul_i32 s32, s67, 56
s_mul_i32 s10, s5, 14
buffer_load_dwordx4 v229, s[60:63], s29 offen offset:1024 lds
s_add_u32 s32, s32, s10
s_mul_i32 s32, s32, 5120
s_add_u32 s32, s32, 0x600000
s_mov_b32 s48, 0x100001
s_mov_b32 s49, 0x10000100
s_mov_b32 s50, 0x200002
buffer_load_dwordx4 v230, s[60:63], s29 offen offset:2048 lds
s_mov_b32 s51, 0x20000200
s_mov_b32 s52, 0x400004
s_mov_b32 s53, 0x40000400
s_mov_b32 s54, 0x800008
s_mov_b32 s55, 0x80000800
s_mov_b32 s56, 0x3eeff558
s_add_u32 s8, s5, 16
s_mul_i32 s28, s8, 7168
s_mul_i32 s29, s8, 110592
s_cmp_lt_u32 s8, 10
s_cselect_b32 s8, s24, s25
s_add_u32 s29, s29, s8
s_mov_b32 m0, s28
s_nop 0
buffer_load_dwordx4 v224, s[60:63], s29 offen offset:0 lds
s_mov_b32 s57, 0x3eeff558
s_mov_b32 s58, -1
s_mov_b32 s59, 0xffff
s_add_u32 s10, s5, s67
s_and_b32 s10, s10, 1
s_lshl_b32 s10, s10, 3
buffer_load_dwordx4 v225, s[60:63], s29 offen offset:1024 lds
v_and_b32 v16, 15, v1
v_lshlrev_b32 v16, 4, v16
v_lshrrev_b32 v17, 4, v1
v_lshl_add_u32 v28, v17, 9, v16
v_lshrrev_b32 v18, 5, v1
v_lshlrev_b32 v18, 3, v18
buffer_load_dwordx4 v226, s[60:63], s29 offen offset:2048 lds
v_xor_b32 v18, s10, v18
v_add_u32 v28, v28, v18
s_add_u32 s10, s10, 4096
v_add_u32 v29, s10, v3
s_not_b32 s10, s6
s_cmp_eq_u32 s7, 0
s_cselect_b32 s99, s6, s10
buffer_load_dwordx4 v227, s[60:63], s29 offen offset:3072 lds
v_mov_b32 v18, v12
v_mov_b32 v19, v12
s_add_u32 s101, s30, 0x14000
s_add_u32 s31, s31, 0x14000
s_lshl_b32 s10, s64, 1
s_add_u32 s10, s10, s66
s_add_u32 m0, s28, 4096
s_nop 0
buffer_load_dwordx4 v228, s[60:63], s29 offen offset:0 lds
s_lshl_b32 s10, s10, 1
s_lshr_b32 s11, s5, 1
s_add_u32 s10, s10, s11
s_mul_i32 s10, s10, 160
s_mul_i32 s11, s67, 20
s_add_u32 s10, s10, s11
buffer_load_dwordx4 v229, s[60:63], s29 offen offset:1024 lds
s_lshl_b32 s25, s10, 8
s_mov_b32 s15, 0
s_lshl_b32 s10, s64, 2
s_add_u32 s10, s10, s5
s_mul_i32 s16, s10, 40960
s_add_u32 s16, s16, 0xac0000
buffer_load_dwordx4 v230, s[60:63], s29 offen offset:2048 lds
s_and_b32 s10, s64, 1
s_mul_i32 s10, s10, 20480
s_sub_u32 s24, s16, s10
s_add_u32 s16, s16, s10
s_lshl_b32 s19, s64, 10
s_add_u32 s19, s19, 0x6000
s_add_u32 s20, s18, 0x840000
buffer_store_dwordx4 v[64:67], v231, s[44:47], s20 offen offset:0 sc1
s_add_u32 s20, s18, 0x868000
buffer_store_dwordx4 v[68:71], v231, s[44:47], s20 offen offset:0 sc1
s_mov_b32 s18, 0x1240000
s_branch L_convdone
L_convC:
v_mov_b32 v232, 0
v_mov_b32 v233, 0
v_mov_b32 v234, 0
v_mov_b32 v235, 0
s_mul_i32 s8, s5, 5376
s_add_u32 s8, s8, 71680
s_mul_i32 s9, s5, 12160
s_add_u32 s9, s9, 114688
v_and_b32 v6, 15, v1
v_lshlrev_b32 v6, 2, v6
v_bfe_u32 v7, v1, 4, 1
v_sub_u32 v7, 1, v7
v_mul_u32_u24 v7, 2688, v7
v_add3_u32 v6, v6, v7, s8
s_mov_b32 exec_lo, 0x7fffffff
s_mov_b32 exec_hi, 0x0
ds_write_b32 v6, v232 offset:0
ds_write_b32 v6, v232 offset:21504
s_mov_b64 exec, -1
v_add_u32 v6, s9, v3
s_mov_b32 exec_lo, 0xffffffff
s_mov_b32 exec_hi, 0xffffff
ds_write_b128 v6, v[232:235] offset:0
ds_write_b128 v6, v[232:235] offset:896
s_mov_b64 exec, -1
v_and_b32 v4, 1, v1
v_mul_u32_u24 v5, 12160, v4
v_mul_u32_u24 v4, 2692, v4
v_and_b32 v7, 15, v1
v_lshl_add_u32 v4, v7, 2, v4
v_and_b32 v6, 48, v1
v_add3_u32 v4, v4, v6, s8
v_lshrrev_b32 v7, 1, v7
v_lshl_add_u32 v5, v7, 8, v5
v_lshlrev_b32 v249, 2, v6
v_sub_u32 v5, v5, v249
v_add_u32 v5, 114880, v5
v_and_b32 v7, 15, v1
v_lshrrev_b32 v6, 2, v6
v_add_u32 v7, v7, v6
s_bitcmp1_b32 s5, 0
s_cselect_b32 s10, 16, 0
s_lshr_b32 s11, s100, s10
s_and_b32 s11, s11, 0xffff
v_mov_b32 v6, s11
v_cmp_eq_u32 vcc, 15, v7
s_nop 1
v_cndmask_b32 v160, 0, v6, vcc
v_cmp_eq_u32 vcc, 14, v7
s_nop 1
v_cndmask_b32 v161, 0, v6, vcc
v_cmp_eq_u32 vcc, 13, v7
s_nop 1
v_cndmask_b32 v162, 0, v6, vcc
v_cmp_eq_u32 vcc, 12, v7
s_nop 1
v_cndmask_b32 v163, 0, v6, vcc
s_lshr_b32 s11, s101, s10
s_and_b32 s11, s11, 0xffff
v_mov_b32 v6, s11
v_cmp_eq_u32 vcc, 15, v7
s_nop 1
v_cndmask_b32 v200, 0, v6, vcc
v_cmp_eq_u32 vcc, 14, v7
s_nop 1
v_cndmask_b32 v201, 0, v6, vcc
v_cmp_eq_u32 vcc, 13, v7
s_nop 1
v_cndmask_b32 v202, 0, v6, vcc
v_cmp_eq_u32 vcc, 12, v7
s_nop 1
v_cndmask_b32 v203, 0, v6, vcc
s_and_b32 s10, s5, 1
s_mul_i32 s10, s10, 80
v_lshrrev_b32 v53, 2, v1
v_mad_u32_u24 v53, v53, 5, s10
v_and_b32 v54, 3, v1
v_lshlrev_b32 v62, 6, v53
v_lshl_add_u32 v62, v54, 4, v62
v_subrev_u32 v63, 64, v62
v_cmp_eq_u32 vcc, 0, v53
v_mov_b32 v55, 0x70000000
s_nop 0
v_cndmask_b32 v63, v63, v55, vcc
s_lshr_b32 s10, s5, 1
s_mul_i32 s10, s10, 24320
s_add_u32 s10, s10, 116480
v_lshl_add_u32 v55, v54, 2, v53
v_and_b32 v55, 12, v55
v_lshl_add_u32 v57, v53, 4, v55
v_lshl_add_u32 v57, v57, 2, s10
v_add_u32 v53, 1, v53
v_lshl_add_u32 v55, v54, 2, v53
v_and_b32 v55, 12, v55
v_lshl_add_u32 v58, v53, 4, v55
v_lshl_add_u32 v58, v58, 2, s10
v_add_u32 v53, 1, v53
v_lshl_add_u32 v55, v54, 2, v53
v_and_b32 v55, 12, v55
v_lshl_add_u32 v59, v53, 4, v55
v_lshl_add_u32 v59, v59, 2, s10
v_add_u32 v53, 1, v53
v_lshl_add_u32 v55, v54, 2, v53
v_and_b32 v55, 12, v55
v_lshl_add_u32 v60, v53, 4, v55
v_lshl_add_u32 v60, v60, 2, s10
v_add_u32 v53, 1, v53
v_lshl_add_u32 v55, v54, 2, v53
v_and_b32 v55, 12, v55
v_lshl_add_u32 v61, v53, 4, v55
v_lshl_add_u32 v61, v61, 2, s10
s_waitcnt lgkmcnt(0)
v_add_u32 v22, 57344, v15
v_cmp_gt_u32 vcc, 220, v0
s_and_b32 s20, s5, 1
s_lshr_b32 s21, s5, 1
v_and_b32 v7, 15, v1
v_mul_u32_u24 v7, 352, v7
v_lshrrev_b32 v19, 4, v1
v_lshl_add_u32 v7, v19, 3, v7
s_add_u32 s11, s3, s21
s_and_b32 s11, s11, 1
s_mul_i32 s12, s20, 5632
s_mul_i32 s13, s21, 96
s_add_u32 s12, s12, s13
s_add_u32 s12, s12, 57520
s_mul_i32 s13, s11, 176
s_add_u32 s15, s12, s13
s_sub_u32 s12, s12, s13
s_add_u32 s12, s12, 176
v_add_u32 v19, s12, v7
v_add_u32 v20, s15, v7
s_lshl_b32 s11, s4, 1
s_add_u32 s11, s11, s20
s_mul_i32 s11, s11, 160
s_mul_i32 s12, s3, 20
s_add_u32 s11, s11, s12
s_mul_i32 s12, s21, 12
s_add_u32 s11, s11, s12
s_lshl_b32 s11, s11, 8
s_add_u32 s15, s11, 0xfc0000
v_mov_b32 v21, 0x3f803f80
v_mov_b32 v28, 0
v_mov_b32 v29, 0
s_waitcnt vmcnt(7)
s_barrier
s_and_b64 exec, exec, vcc
ds_write_b128 v22, a[0:3] offset:0
ds_write_b128 v22, a[4:7] offset:176
ds_write_b128 v22, a[8:11] offset:352
s_mov_b64 exec, -1
v_dot2c_f32_bf16 v28, v238, v21
v_dot2c_f32_bf16 v29, v238, v238
v_dot2c_f32_bf16 v28, v239, v21
v_dot2c_f32_bf16 v29, v239, v239
v_dot2c_f32_bf16 v28, v240, v21
v_dot2c_f32_bf16 v29, v240, v240
v_dot2c_f32_bf16 v28, v241, v21
v_dot2c_f32_bf16 v29, v241, v241
v_dot2c_f32_bf16 v28, v242, v21
v_dot2c_f32_bf16 v29, v242, v242
v_dot2c_f32_bf16 v28, v243, v21
v_dot2c_f32_bf16 v29, v243, v243
v_dot2c_f32_bf16 v28, v244, v21
v_dot2c_f32_bf16 v29, v244, v244
v_dot2c_f32_bf16 v28, v245, v21
v_dot2c_f32_bf16 v29, v245, v245
v_dot2c_f32_bf16 v28, v246, v21
v_dot2c_f32_bf16 v29, v246, v246
v_dot2c_f32_bf16 v28, v247, v21
v_dot2c_f32_bf16 v29, v247, v247
s_waitcnt lgkmcnt(0)
s_barrier
ds_read_b64 a[12:13], v20 offset:0
ds_read_b64 a[14:15], v19 offset:0
ds_read_b64 a[16:17], v19 offset:32
ds_read_b64 a[18:19], v20 offset:32
ds_read_b64 a[20:21], v20 offset:64
ds_read_b64 a[22:23], v19 offset:64
v_add_f32_dpp v28, v28, v28 row_ror:8 row_mask:0xf bank_mask:0xf
v_add_f32_dpp v29, v29, v29 row_ror:8 row_mask:0xf bank_mask:0xf
s_nop 0
v_add_f32_dpp v28, v28, v28 row_ror:4 row_mask:0xf bank_mask:0xf
v_add_f32_dpp v29, v29, v29 row_ror:4 row_mask:0xf bank_mask:0xf
s_nop 0
v_add_f32_dpp v28, v28, v28 row_ror:2 row_mask:0xf bank_mask:0xf
v_add_f32_dpp v29, v29, v29 row_ror:2 row_mask:0xf bank_mask:0xf
s_nop 0
v_add_f32_dpp v28, v28, v28 row_ror:1 row_mask:0xf bank_mask:0xf
v_add_f32_dpp v29, v29, v29 row_ror:1 row_mask:0xf bank_mask:0xf
v_mov_b32 v30, v28
v_mov_b32 v31, v29
s_nop 0
v_permlane16_swap_b32 v28, v30
v_permlane16_swap_b32 v29, v31
v_add_f32 v28, v28, v30
v_add_f32 v29, v29, v31
v_mul_f32 v28, 0x3acccccd, v28
v_mul_f32 v29, 0x3acccccd, v29
v_fma_f32 v29, -v28, v28, v29
v_max_f32 v29, 0, v29
v_add_f32 v29, 0x3727c5ac, v29
v_rsq_f32 v30, v29
s_nop 0
v_mul_f32 v29, v28, v30
v_sub_f32 v29, 0, v29
v_mov_b32 v28, v30
v_mov_b32 v30, s6
v_mov_b32 v31, s6
s_waitcnt lgkmcnt(0)
v_lshlrev_b32 v6, 3, v1
s_lshl_b32 s12, s3, 9
s_add_u32 s12, s12, 0x2000
poll_28:
buffer_load_dwordx2 v[236:237], v6, s[44:47], s12 offen sc1
s_waitcnt vmcnt(0)
v_cmp_eq_u32 vcc, s6, v236
v_cmp_eq_u32 s[10:11], s6, v237
s_nop 3
s_and_b64 vcc, vcc, s[10:11]
s_cmp_eq_u64 vcc, -1
s_cbranch_scc1 pollok_29
s_sub_u32 s98, s98, 1
s_cbranch_scc0 poll_28
s_mov_b32 s98, 0
pollok_29:
s_lshr_b32 s12, s5, 1
s_add_u32 s12, s12, s69
s_lshl_b32 s12, s12, 14
s_add_u32 s12, s12, 0x100000
buffer_load_dword v52, v63, s[44:47], s12 offen sc1
buffer_load_dwordx4 v[32:35], v62, s[44:47], s12 offen offset:0 sc1
buffer_load_dwordx4 v[36:39], v62, s[44:47], s12 offen offset:64 sc1
buffer_load_dwordx4 v[40:43], v62, s[44:47], s12 offen offset:128 sc1
buffer_load_dwordx4 v[44:47], v62, s[44:47], s12 offen offset:192 sc1
buffer_load_dwordx4 v[48:51], v62, s[44:47], s12 offen offset:256 sc1
s_lshl_b32 s8, s2, 3
s_lshl_b32 s10, s5, 1
s_add_u32 s8, s8, s10
s_lshl_b32 s8, s8, 4
s_add_u32 s8, s8, 0x60000
v_lshrrev_b32 v7, 5, v1
v_lshlrev_b32 v7, 4, v7
s_mov_b32 exec_lo, 0x1
s_mov_b32 exec_hi, 0x1
buffer_store_dwordx4 v[28:31], v7, s[44:47], s8 offen sc1
s_mov_b64 exec, -1
buffer_store_dwordx4 a[12:15], v3, s[44:47], s15 offen offset:0 sc1
buffer_store_dwordx4 a[16:19], v3, s[44:47], s15 offen offset:1024 sc1
s_cmp_lt_u32 s5, 2
s_cbranch_scc0 q3_30
buffer_store_dwordx4 a[20:23], v3, s[44:47], s15 offen offset:2048 sc1
s_branch q3d_31
q3_30:
s_mov_b64 exec, 1
buffer_load_dword v255, off, s[44:47], 0
s_mov_b64 exec, -1
q3d_31:
s_barrier
s_cmp_ge_u32 s5, 2
s_cbranch_scc1 xpad_33
s_lshl_b32 s8, s5, 8
s_add_u32 s8, s8, s2
s_cmp_ge_u32 s8, 448
s_cbranch_scc1 xpad_33
s_mov_b32 s52, s34
s_mov_b32 s53, s35
s_mov_b32 s54, 0x21c000
s_mov_b32 s55, 0x20000
s_and_b32 s22, s8, 7
s_lshr_b32 s10, s8, 3
s_mul_i32 s11, s10, 37
s_lshr_b32 s11, s11, 9
s_mul_i32 s12, s11, 14
s_sub_u32 s12, s10, s12
s_mul_i32 s11, s11, 432
s_mul_i32 s13, s12, 11
s_lshr_b32 s13, s13, 5
s_mul_i32 s28, s13, 12
s_lshl_b32 s29, s12, 5
s_add_u32 s28, s28, s29
s_sub_u32 s29, s12, 12
s_mul_i32 s29, s29, 216
s_add_u32 s29, s29, 96
s_cmp_ge_u32 s12, 12
s_cselect_b32 s28, s29, s28
s_cselect_b32 s29, 117760, 0
s_add_u32 s28, s28, s11
s_mul_i32 s28, s28, 1280
s_mul_i32 s22, s22, 160
s_add_u32 s28, s28, s22
s_add_u32 s22, s28, s29
v_add_u32 v19, 0, v1
v_mul_u32_u24 v24, 205, v19
v_lshrrev_b32 v24, 11, v24
v_mul_u32_u24 v25, 10, v24
v_sub_u32 v19, v19, v25
v_lshlrev_b32 v19, 4, v19
v_mul_u32_u24 v24, 1280, v24
v_add_u32 v19, v19, v24
v_add_u32 v20, 64, v1
v_mul_u32_u24 v24, 205, v20
v_lshrrev_b32 v24, 11, v24
v_mul_u32_u24 v25, 10, v24
v_sub_u32 v20, v20, v25
v_lshlrev_b32 v20, 4, v20
v_mul_u32_u24 v24, 1280, v24
v_add_u32 v20, v20, v24
v_subrev_u32 v20, 1024, v20
v_add_u32 v21, 128, v1
v_mul_u32_u24 v24, 205, v21
v_lshrrev_b32 v24, 11, v24
v_mul_u32_u24 v25, 10, v24
v_sub_u32 v21, v21, v25
v_lshlrev_b32 v21, 4, v21
v_mul_u32_u24 v24, 1280, v24
v_add_u32 v21, v21, v24
v_subrev_u32 v21, 2048, v21
v_add_u32 v22, 192, v1
v_mul_u32_u24 v24, 205, v22
v_lshrrev_b32 v24, 11, v24
v_mul_u32_u24 v25, 10, v24
v_sub_u32 v22, v22, v25
v_lshlrev_b32 v22, 4, v22
v_mul_u32_u24 v24, 1280, v24
v_add_u32 v22, v22, v24
v_subrev_u32 v22, 3072, v22
v_add_u32 v23, 256, v1
v_mul_u32_u24 v24, 205, v23
v_lshrrev_b32 v24, 11, v24
v_mul_u32_u24 v25, 10, v24
v_sub_u32 v23, v23, v25
v_lshlrev_b32 v23, 4, v23
v_mul_u32_u24 v24, 1280, v24
v_add_u32 v23, v23, v24
v_lshrrev_b32 v24, 5, v1
v_mul_i32_i24 v24, s29, v24
v_add_u32 v21, v21, v24
s_mul_i32 s10, s5, 5120
s_add_u32 m0, s10, 57344
s_nop 0
buffer_load_dwordx4 v19, s[52:55], s28 offen offset:0 lds
buffer_load_dwordx4 v20, s[52:55], s28 offen offset:1024 lds
buffer_load_dwordx4 v21, s[52:55], s28 offen offset:2048 lds
buffer_load_dwordx4 v22, s[52:55], s22 offen offset:3072 lds
s_add_u32 m0, s10, 61440
s_nop 0
buffer_load_dwordx4 v23, s[52:55], s22 offen lds
s_branch xdone_34
xpad_33:
s_mov_b64 exec, 1
buffer_load_dword v255, off, s[44:47], 0
buffer_load_dword v255, off, s[44:47], 0
buffer_load_dword v255, off, s[44:47], 0
buffer_load_dword v255, off, s[44:47], 0
buffer_load_dword v255, off, s[44:47], 0
s_mov_b64 exec, -1
xdone_34:
s_mov_b32 s52, s32
s_mov_b32 s53, s33
s_mov_b32 s54, 0xd80
s_mov_b32 s55, 0x20000
s_mov_b32 s56, s36
s_mov_b32 s57, s37
s_mov_b32 s58, 0x500
s_mov_b32 s59, 0x20000
s_and_b32 s8, s4, 15
s_mul_i32 s8, s8, 216
buffer_load_ushort v250, v26, s[52:55], s8 offen
s_and_b32 s8, s4, 7
s_mul_i32 s8, s8, 160
buffer_load_dword v251, v27, s[56:59], s8 offen
s_mov_b32 s52, s30
s_mov_b32 s53, s31
s_mov_b32 s54, 0x21c000
s_mov_b32 s55, 0x20000
s_mov_b64 exec, 0x1ffff
buffer_load_dword v255, v14, s[52:55], 0 offen
s_mov_b64 exec, -1
ds_read_b64 v[64:65], v4 offset:0
ds_read_b64 v[66:67], v4 offset:8
ds_read_b64 v[68:69], v4 offset:512
ds_read_b64 v[70:71], v4 offset:520
ds_read_b64 v[72:73], v4 offset:1024
ds_read_b64 v[74:75], v4 offset:1032
ds_read_b64 v[76:77], v4 offset:1536
ds_read_b64 v[78:79], v4 offset:1544
ds_read_b64 v[80:81], v4 offset:2048
ds_read_b64 v[82:83], v4 offset:2056
ds_read_b64 v[104:105], v4 offset:21504
ds_read_b64 v[106:107], v4 offset:21512
ds_read_b64 v[108:109], v4 offset:22016
ds_read_b64 v[110:111], v4 offset:22024
ds_read_b64 v[112:113], v4 offset:22528
ds_read_b64 v[114:115], v4 offset:22536
ds_read_b64 v[116:117], v4 offset:23040
ds_read_b64 v[118:119], v4 offset:23048
ds_read_b64 v[120:121], v4 offset:23552
ds_read_b64 v[122:123], v4 offset:23560
s_lshl_b32 s8, s5, 8
s_add_u32 s8, s8, s2
v_lshrrev_b32 v252, 2, v1
v_mul_u32_u24 v252, 160, v252
v_and_b32 v254, 3, v1
s_and_b32 s10, s5, 1
s_mul_i32 s10, s10, 5120
s_add_u32 s10, s10, 57344
v_add_u32 v252, s10, v252
v_lshl_add_u32 v253, v254, 3, v252
v_lshl_add_u32 v252, v254, 4, v252
s_lshr_b32 s10, s8, 3
s_mul_i32 s11, s10, 37
s_lshr_b32 s11, s11, 9
s_mul_i32 s11, s11, 14
s_sub_u32 s12, s10, s11
s_mul_i32 s13, s12, 11
s_lshr_b32 s13, s13, 5
s_lshl_b32 s22, s12, 2
s_mul_i32 s13, s13, 11
s_sub_u32 s13, s22, s13
s_add_u32 s13, s13, s11
s_cmp_ge_u32 s12, 12
s_cselect_b32 s10, s10, s13
s_and_b32 s12, s8, 7
s_mul_i32 s12, s12, 56
s_add_u32 s12, s12, s10
s_mul_i32 s12, s12, 5120
s_add_u32 s12, s12, 0x600000
s_cmp_lt_u32 s8, 448
s_cselect_b32 s12, s12, 0x70000000
v_add_u32 v254, s12, v3
s_sub_u32 s16, 4, s5
s_lshr_b32 s8, s5, 1
s_sub_u32 s16, s16, s8
s_bfe_u32 s17, s69, 0x10002
s_mul_i32 s18, s16, 1280
s_add_u32 s18, s18, s69
s_lshl_b32 s18, s18, 8
s_lshl_b32 s19, s16, 12
s_add_u32 s19, s19, 0x60000
v_lshrrev_b32 v7, 4, v1
v_and_b32 v6, 15, v1
s_mov_b32 s8, 40960
v_mul_u32_u24 v231, s8, v7
v_lshl_add_u32 v231, v6, 4, v231
v_lshlrev_b32 v248, 5, v1
s_lshl_b32 s8, s17, 4
s_sub_u32 s10, 16, s8
v_add_u32 v249, s10, v248
v_add_u32 v248, s8, v248
s_lshl_b32 s23, s3, 3
s_add_u32 s23, s23, s16
s_lshl_b32 s23, s23, 6
s_add_u32 s23, s23, 0x1000
v_and_b32 v31, 15, v1
v_lshlrev_b32 v31, 2, v31
v_mov_b32 v6, v5
v_bfe_u32 v7, v1, 1, 3
v_add_lshl_u32 v7, v7, s5, 4
v_and_or_b32 v5, v7, 48, v6
s_waitcnt vmcnt(16)
ds_write_b128 v57, v[32:35] offset:12160
v_alignbyte_b32 v84, v33, v32, 2
v_alignbyte_b32 v85, v34, v33, 2
v_alignbyte_b32 v86, v35, v34, 2
v_alignbyte_b32 v87, v52, v35, 2
ds_write_b128 v57, v[84:87]
s_waitcnt vmcnt(15)
ds_write_b128 v58, v[36:39] offset:12160
v_alignbyte_b32 v88, v37, v36, 2
v_alignbyte_b32 v89, v38, v37, 2
v_alignbyte_b32 v90, v39, v38, 2
v_alignbyte_b32 v91, v32, v39, 2
ds_write_b128 v58, v[88:91]
s_waitcnt vmcnt(14)
ds_write_b128 v59, v[40:43] offset:12160
v_alignbyte_b32 v92, v41, v40, 2
v_alignbyte_b32 v93, v42, v41, 2
v_alignbyte_b32 v94, v43, v42, 2
v_alignbyte_b32 v95, v36, v43, 2
ds_write_b128 v59, v[92:95]
s_waitcnt vmcnt(13)
ds_write_b128 v60, v[44:47] offset:12160
v_alignbyte_b32 v96, v45, v44, 2
v_alignbyte_b32 v97, v46, v45, 2
v_alignbyte_b32 v98, v47, v46, 2
v_alignbyte_b32 v99, v40, v47, 2
ds_write_b128 v60, v[96:99]
s_waitcnt vmcnt(12)
ds_write_b128 v61, v[48:51] offset:12160
v_alignbyte_b32 v100, v49, v48, 2
v_alignbyte_b32 v101, v50, v49, 2
v_alignbyte_b32 v102, v51, v50, 2
v_alignbyte_b32 v103, v44, v51, 2
ds_write_b128 v61, v[100:103]
s_waitcnt lgkmcnt(0)
s_barrier
ds_read_b128 v[100:103], v5 offset:9984
ds_read_b128 v[96:99], v5 offset:7936
ds_read_b128 v[88:91], v5 offset:3840
ds_read_b128 v[84:87], v5 offset:1792
ds_read_b128 v[140:143], v5 offset:34304
ds_read_b128 v[136:139], v5 offset:32256
ds_read_b128 v[128:131], v5 offset:28160
ds_read_b128 v[124:127], v5 offset:26112
ds_read_b128 v[92:95], v5 offset:5888
ds_read_b128 v[132:135], v5 offset:30208
v_subrev_u32 v7, 16, v7
v_and_or_b32 v5, v7, 48, v6
s_waitcnt lgkmcnt(9)
v_mfma_f32_16x16x32_bf16 v[32:35], v[160:163], v[100:103], 0
s_waitcnt lgkmcnt(8)
v_mfma_f32_16x16x32_bf16 v[36:39], v[160:163], v[96:99], 0
s_add_u32 s8, s5, 0
s_mul_i32 s28, s8, 7168
s_mul_i32 s29, s8, 110592
s_cmp_lt_u32 s8, 10
s_cselect_b32 s8, s24, s25
s_add_u32 s29, s29, s8
s_mov_b32 m0, s28
s_nop 0
buffer_load_dwordx4 v224, s[60:63], s29 offen offset:0 lds
s_waitcnt lgkmcnt(7)
v_mfma_f32_16x16x32_bf16 v[40:43], v[160:163], v[88:91], 0
s_waitcnt lgkmcnt(6)
v_mfma_f32_16x16x32_bf16 v[44:47], v[160:163], v[84:87], 0
s_waitcnt lgkmcnt(5)
v_mfma_f32_16x16x32_bf16 v[48:51], v[200:203], v[140:143], 0
buffer_load_dwordx4 v225, s[60:63], s29 offen offset:1024 lds
s_waitcnt lgkmcnt(4)
v_mfma_f32_16x16x32_bf16 v[52:55], v[200:203], v[136:139], 0
s_waitcnt lgkmcnt(3)
v_mfma_f32_16x16x32_bf16 v[56:59], v[200:203], v[128:131], 0
s_waitcnt lgkmcnt(2)
v_mfma_f32_16x16x32_bf16 v[60:63], v[200:203], v[124:127], 0
buffer_load_dwordx4 v226, s[60:63], s29 offen offset:2048 lds
v_mfma_f32_16x16x32_bf16 v[32:35], v[64:67], v[100:103], v[32:35]
ds_read_b64 v[144:145], v4 offset:64
ds_read_b64 v[146:147], v4 offset:72
v_mfma_f32_16x16x32_bf16 v[36:39], v[64:67], v[96:99], v[36:39]
ds_read_b128 v[180:183], v5 offset:9728
v_mfma_f32_16x16x32_bf16 v[40:43], v[64:67], v[88:91], v[40:43]
ds_read_b128 v[176:179], v5 offset:7680
v_mfma_f32_16x16x32_bf16 v[44:47], v[64:67], v[84:87], v[44:47]
ds_read_b128 v[168:171], v5 offset:3584
v_mfma_f32_16x16x32_bf16 v[48:51], v[104:107], v[140:143], v[48:51]
ds_read_b128 v[164:167], v5 offset:1536
ds_read_b64 v[184:185], v4 offset:21568
v_mfma_f32_16x16x32_bf16 v[52:55], v[104:107], v[136:139], v[52:55]
ds_read_b64 v[186:187], v4 offset:21576
v_mfma_f32_16x16x32_bf16 v[56:59], v[104:107], v[128:131], v[56:59]
ds_read_b128 v[220:223], v5 offset:34048
v_mfma_f32_16x16x32_bf16 v[60:63], v[104:107], v[124:127], v[60:63]
ds_read_b128 v[216:219], v5 offset:32000
v_mfma_f32_16x16x32_bf16 v[32:35], v[68:71], v[96:99], v[32:35]
ds_read_b128 v[208:211], v5 offset:27904
ds_read_b128 v[204:207], v5 offset:25856
s_waitcnt lgkmcnt(13)
v_mfma_f32_16x16x32_bf16 v[36:39], v[68:71], v[92:95], v[36:39]
ds_read_b64 v[148:149], v4 offset:576
v_mfma_f32_16x16x32_bf16 v[40:43], v[68:71], v[84:87], v[40:43]
ds_read_b64 v[150:151], v4 offset:584
v_mfma_f32_16x16x32_bf16 v[48:51], v[108:111], v[136:139], v[48:51]
ds_read_b128 v[172:175], v5 offset:5632
s_waitcnt lgkmcnt(15)
v_mfma_f32_16x16x32_bf16 v[52:55], v[108:111], v[132:135], v[52:55]
ds_read_b64 v[188:189], v4 offset:22080
ds_read_b64 v[190:191], v4 offset:22088
v_mfma_f32_16x16x32_bf16 v[56:59], v[108:111], v[124:127], v[56:59]
ds_read_b128 v[212:215], v5 offset:29952
v_mfma_f32_16x16x32_bf16 v[32:35], v[72:75], v[92:95], v[32:35]
ds_read_b64 v[152:153], v4 offset:1088
v_mfma_f32_16x16x32_bf16 v[36:39], v[72:75], v[88:91], v[36:39]
ds_read_b64 v[154:155], v4 offset:1096
v_mfma_f32_16x16x32_bf16 v[48:51], v[112:115], v[132:135], v[48:51]
ds_read_b64 v[192:193], v4 offset:22592
ds_read_b64 v[194:195], v4 offset:22600
v_mfma_f32_16x16x32_bf16 v[52:55], v[112:115], v[128:131], v[52:55]
ds_read_b64 v[156:157], v4 offset:1600
v_mfma_f32_16x16x32_bf16 v[32:35], v[76:79], v[88:91], v[32:35]
ds_read_b64 v[158:159], v4 offset:1608
v_mfma_f32_16x16x32_bf16 v[36:39], v[76:79], v[84:87], v[36:39]
ds_read_b64 v[196:197], v4 offset:23104
v_mfma_f32_16x16x32_bf16 v[48:51], v[116:119], v[128:131], v[48:51]
ds_read_b64 v[198:199], v4 offset:23112
ds_read_b64 v[160:161], v4 offset:2112
v_mfma_f32_16x16x32_bf16 v[52:55], v[116:119], v[124:127], v[52:55]
ds_read_b64 v[162:163], v4 offset:2120
v_mfma_f32_16x16x32_bf16 v[32:35], v[80:83], v[84:87], v[32:35]
ds_read_b64 v[200:201], v4 offset:23616
v_mfma_f32_16x16x32_bf16 v[48:51], v[120:123], v[124:127], v[48:51]
ds_read_b64 v[202:203], v4 offset:23624
v_subrev_u32 v7, 16, v7
v_and_or_b32 v5, v7, 48, v6
s_waitcnt lgkmcnt(15)
v_mfma_f32_16x16x32_bf16 v[32:35], v[144:147], v[180:183], v[32:35]
ds_read_b64 v[64:65], v4 offset:128
ds_read_b64 v[66:67], v4 offset:136
v_mfma_f32_16x16x32_bf16 v[36:39], v[144:147], v[176:179], v[36:39]
ds_read_b128 v[100:103], v5 offset:9472
s_waitcnt vmcnt(11)
s_lshl_b32 s8, s3, 5
s_add_u32 s8, s8, s4
s_lshl_b32 s8, s8, 2
s_add_u32 s8, s8, s5
s_lshl_b32 s8, s8, 2
s_add_u32 s8, s8, 0x1000
s_cmp_lg_u32 s7, 0
s_cbranch_scc1 qfc_35
buffer_store_dword v2, off, s[44:47], s8
qfb_36:
v_mfma_f32_16x16x32_bf16 v[40:43], v[144:147], v[168:171], v[40:43]
ds_read_b128 v[96:99], v5 offset:7424
v_mfma_f32_16x16x32_bf16 v[44:47], v[144:147], v[164:167], v[44:47]
ds_read_b128 v[88:91], v5 offset:3328
v_mfma_f32_16x16x32_bf16 v[48:51], v[184:187], v[220:223], v[48:51]
ds_read_b128 v[84:87], v5 offset:1280
ds_read_b64 v[104:105], v4 offset:21632
buffer_load_dwordx4 v227, s[60:63], s29 offen offset:3072 lds
v_mfma_f32_16x16x32_bf16 v[52:55], v[184:187], v[216:219], v[52:55]
ds_read_b64 v[106:107], v4 offset:21640
v_mfma_f32_16x16x32_bf16 v[56:59], v[184:187], v[208:211], v[56:59]
ds_read_b128 v[140:143], v5 offset:33792
v_mfma_f32_16x16x32_bf16 v[60:63], v[184:187], v[204:207], v[60:63]
ds_read_b128 v[136:139], v5 offset:31744
s_add_u32 m0, s28, 4096
s_nop 0
buffer_load_dwordx4 v228, s[60:63], s29 offen offset:0 lds
v_mfma_f32_16x16x32_bf16 v[32:35], v[148:151], v[176:179], v[32:35]
ds_read_b128 v[128:131], v5 offset:27648
ds_read_b128 v[124:127], v5 offset:25600
v_mfma_f32_16x16x32_bf16 v[36:39], v[148:151], v[172:175], v[36:39]
ds_read_b64 v[68:69], v4 offset:640
v_mfma_f32_16x16x32_bf16 v[40:43], v[148:151], v[164:167], v[40:43]
ds_read_b64 v[70:71], v4 offset:648
buffer_load_dwordx4 v229, s[60:63], s29 offen offset:1024 lds
s_waitcnt lgkmcnt(15)
v_mfma_f32_16x16x32_bf16 v[48:51], v[188:191], v[216:219], v[48:51]
ds_read_b128 v[92:95], v5 offset:5376
v_mfma_f32_16x16x32_bf16 v[52:55], v[188:191], v[212:215], v[52:55]
ds_read_b64 v[108:109], v4 offset:22144
ds_read_b64 v[110:111], v4 offset:22152
v_mfma_f32_16x16x32_bf16 v[56:59], v[188:191], v[204:207], v[56:59]
ds_read_b128 v[132:135], v5 offset:29696
v_mfma_f32_16x16x32_bf16 v[32:35], v[152:155], v[172:175], v[32:35]
ds_read_b64 v[72:73], v4 offset:1152
v_mfma_f32_16x16x32_bf16 v[36:39], v[152:155], v[168:171], v[36:39]
ds_read_b64 v[74:75], v4 offset:1160
v_mfma_f32_16x16x32_bf16 v[48:51], v[192:195], v[212:215], v[48:51]
ds_read_b64 v[112:113], v4 offset:22656
ds_read_b64 v[114:115], v4 offset:22664
v_mfma_f32_16x16x32_bf16 v[52:55], v[192:195], v[208:211], v[52:55]
ds_read_b64 v[76:77], v4 offset:1664
v_mfma_f32_16x16x32_bf16 v[32:35], v[156:159], v[168:171], v[32:35]
ds_read_b64 v[78:79], v4 offset:1672
v_mfma_f32_16x16x32_bf16 v[36:39], v[156:159], v[164:167], v[36:39]
ds_read_b64 v[116:117], v4 offset:23168
v_mfma_f32_16x16x32_bf16 v[48:51], v[196:199], v[208:211], v[48:51]
ds_read_b64 v[118:119], v4 offset:23176
ds_read_b64 v[80:81], v4 offset:2176
v_mfma_f32_16x16x32_bf16 v[52:55], v[196:199], v[204:207], v[52:55]
ds_read_b64 v[82:83], v4 offset:2184
v_mfma_f32_16x16x32_bf16 v[32:35], v[160:163], v[164:167], v[32:35]
ds_read_b64 v[120:121], v4 offset:23680
s_waitcnt lgkmcnt(15)
v_mfma_f32_16x16x32_bf16 v[48:51], v[200:203], v[204:207], v[48:51]
ds_read_b64 v[122:123], v4 offset:23688
v_subrev_u32 v7, 16, v7
v_and_or_b32 v5, v7, 48, v6
v_mfma_f32_16x16x32_bf16 v[32:35], v[64:67], v[100:103], v[32:35]
ds_read_b64 v[144:145], v4 offset:192
ds_read_b64 v[146:147], v4 offset:200
v_mfma_f32_16x16x32_bf16 v[36:39], v[64:67], v[96:99], v[36:39]
ds_read_b128 v[180:183], v5 offset:9216
buffer_load_dwordx4 v230, s[60:63], s29 offen offset:2048 lds
v_mfma_f32_16x16x32_bf16 v[40:43], v[64:67], v[88:91], v[40:43]
ds_read_b128 v[176:179], v5 offset:7168
v_mfma_f32_16x16x32_bf16 v[44:47], v[64:67], v[84:87], v[44:47]
ds_read_b128 v[168:171], v5 offset:3072
v_mfma_f32_16x16x32_bf16 v[48:51], v[104:107], v[140:143], v[48:51]
ds_read_b128 v[164:167], v5 offset:1024
ds_read_b64 v[184:185], v4 offset:21696
s_add_u32 s8, s5, 4
s_mul_i32 s28, s8, 7168
s_mul_i32 s29, s8, 110592
s_cmp_lt_u32 s8, 10
s_cselect_b32 s8, s24, s25
s_add_u32 s29, s29, s8
s_mov_b32 m0, s28
s_nop 0
buffer_load_dwordx4 v224, s[60:63], s29 offen offset:0 lds
v_mfma_f32_16x16x32_bf16 v[52:55], v[104:107], v[136:139], v[52:55]
ds_read_b64 v[186:187], v4 offset:21704
v_mfma_f32_16x16x32_bf16 v[56:59], v[104:107], v[128:131], v[56:59]
ds_read_b128 v[220:223], v5 offset:33536
v_mfma_f32_16x16x32_bf16 v[60:63], v[104:107], v[124:127], v[60:63]
ds_read_b128 v[216:219], v5 offset:31488
buffer_load_dwordx4 v225, s[60:63], s29 offen offset:1024 lds
v_mfma_f32_16x16x32_bf16 v[32:35], v[68:71], v[96:99], v[32:35]
ds_read_b128 v[208:211], v5 offset:27392
ds_read_b128 v[204:207], v5 offset:25344
s_waitcnt lgkmcnt(15)
v_mfma_f32_16x16x32_bf16 v[36:39], v[68:71], v[92:95], v[36:39]
ds_read_b64 v[148:149], v4 offset:704
v_mfma_f32_16x16x32_bf16 v[40:43], v[68:71], v[84:87], v[40:43]
ds_read_b64 v[150:151], v4 offset:712
v_mfma_f32_16x16x32_bf16 v[48:51], v[108:111], v[136:139], v[48:51]
ds_read_b128 v[172:175], v5 offset:5120
v_mfma_f32_16x16x32_bf16 v[52:55], v[108:111], v[132:135], v[52:55]
ds_read_b64 v[188:189], v4 offset:22208
ds_read_b64 v[190:191], v4 offset:22216
v_mfma_f32_16x16x32_bf16 v[56:59], v[108:111], v[124:127], v[56:59]
ds_read_b128 v[212:215], v5 offset:29440
v_mfma_f32_16x16x32_bf16 v[32:35], v[72:75], v[92:95], v[32:35]
ds_read_b64 v[152:153], v4 offset:1216
v_mfma_f32_16x16x32_bf16 v[36:39], v[72:75], v[88:91], v[36:39]
ds_read_b64 v[154:155], v4 offset:1224
v_mfma_f32_16x16x32_bf16 v[48:51], v[112:115], v[132:135], v[48:51]
ds_read_b64 v[192:193], v4 offset:22720
ds_read_b64 v[194:195], v4 offset:22728
v_mfma_f32_16x16x32_bf16 v[52:55], v[112:115], v[128:131], v[52:55]
ds_read_b64 v[156:157], v4 offset:1728
v_mfma_f32_16x16x32_bf16 v[32:35], v[76:79], v[88:91], v[32:35]
ds_read_b64 v[158:159], v4 offset:1736
v_mfma_f32_16x16x32_bf16 v[36:39], v[76:79], v[84:87], v[36:39]
ds_read_b64 v[196:197], v4 offset:23232
v_mfma_f32_16x16x32_bf16 v[48:51], v[116:119], v[128:131], v[48:51]
ds_read_b64 v[198:199], v4 offset:23240
ds_read_b64 v[160:161], v4 offset:2240
v_mfma_f32_16x16x32_bf16 v[52:55], v[116:119], v[124:127], v[52:55]
ds_read_b64 v[162:163], v4 offset:2248
s_waitcnt lgkmcnt(15)
v_mfma_f32_16x16x32_bf16 v[32:35], v[80:83], v[84:87], v[32:35]
ds_read_b64 v[200:201], v4 offset:23744
v_mfma_f32_16x16x32_bf16 v[48:51], v[120:123], v[124:127], v[48:51]
ds_read_b64 v[202:203], v4 offset:23752
v_subrev_u32 v7, 16, v7
v_and_or_b32 v5, v7, 48, v6
v_mfma_f32_16x16x32_bf16 v[32:35], v[144:147], v[180:183], v[32:35]
ds_read_b64 v[64:65], v4 offset:256
ds_read_b64 v[66:67], v4 offset:264
v_mfma_f32_16x16x32_bf16 v[36:39], v[144:147], v[176:179], v[36:39]
ds_read_b128 v[100:103], v5 offset:8960
buffer_load_dword v30, v31, s[44:47], s23 offen sc1
v_mfma_f32_16x16x32_bf16 v[40:43], v[144:147], v[168:171], v[40:43]
ds_read_b128 v[96:99], v5 offset:6912
v_mfma_f32_16x16x32_bf16 v[44:47], v[144:147], v[164:167], v[44:47]
ds_read_b128 v[88:91], v5 offset:2816
v_mfma_f32_16x16x32_bf16 v[48:51], v[184:187], v[220:223], v[48:51]
ds_read_b128 v[84:87], v5 offset:768
ds_read_b64 v[104:105], v4 offset:21760
buffer_load_dwordx4 v226, s[60:63], s29 offen offset:2048 lds
v_mfma_f32_16x16x32_bf16 v[52:55], v[184:187], v[216:219], v[52:55]
ds_read_b64 v[106:107], v4 offset:21768
v_mfma_f32_16x16x32_bf16 v[56:59], v[184:187], v[208:211], v[56:59]
ds_read_b128 v[140:143], v5 offset:33280
v_mfma_f32_16x16x32_bf16 v[60:63], v[184:187], v[204:207], v[60:63]
ds_read_b128 v[136:139], v5 offset:31232
buffer_load_dwordx4 v227, s[60:63], s29 offen offset:3072 lds
s_waitcnt lgkmcnt(15)
v_mfma_f32_16x16x32_bf16 v[32:35], v[148:151], v[176:179], v[32:35]
ds_read_b128 v[128:131], v5 offset:27136
ds_read_b128 v[124:127], v5 offset:25088
v_mfma_f32_16x16x32_bf16 v[36:39], v[148:151], v[172:175], v[36:39]
ds_read_b64 v[68:69], v4 offset:768
v_mfma_f32_16x16x32_bf16 v[40:43], v[148:151], v[164:167], v[40:43]
ds_read_b64 v[70:71], v4 offset:776
s_add_u32 m0, s28, 4096
s_nop 0
buffer_load_dwordx4 v228, s[60:63], s29 offen offset:0 lds
v_mfma_f32_16x16x32_bf16 v[48:51], v[188:191], v[216:219], v[48:51]
ds_read_b128 v[92:95], v5 offset:4864
v_mfma_f32_16x16x32_bf16 v[52:55], v[188:191], v[212:215], v[52:55]
ds_read_b64 v[108:109], v4 offset:22272
ds_read_b64 v[110:111], v4 offset:22280
v_mfma_f32_16x16x32_bf16 v[56:59], v[188:191], v[204:207], v[56:59]
ds_read_b128 v[132:135], v5 offset:29184
v_mfma_f32_16x16x32_bf16 v[32:35], v[152:155], v[172:175], v[32:35]
ds_read_b64 v[72:73], v4 offset:1280
v_mfma_f32_16x16x32_bf16 v[36:39], v[152:155], v[168:171], v[36:39]
ds_read_b64 v[74:75], v4 offset:1288
v_mfma_f32_16x16x32_bf16 v[48:51], v[192:195], v[212:215], v[48:51]
ds_read_b64 v[112:113], v4 offset:22784
ds_read_b64 v[114:115], v4 offset:22792
v_mfma_f32_16x16x32_bf16 v[52:55], v[192:195], v[208:211], v[52:55]
ds_read_b64 v[76:77], v4 offset:1792
v_mfma_f32_16x16x32_bf16 v[32:35], v[156:159], v[168:171], v[32:35]
ds_read_b64 v[78:79], v4 offset:1800
v_mfma_f32_16x16x32_bf16 v[36:39], v[156:159], v[164:167], v[36:39]
ds_read_b64 v[116:117], v4 offset:23296
s_waitcnt lgkmcnt(15)
v_mfma_f32_16x16x32_bf16 v[48:51], v[196:199], v[208:211], v[48:51]
ds_read_b64 v[118:119], v4 offset:23304
ds_read_b64 v[80:81], v4 offset:2304
v_mfma_f32_16x16x32_bf16 v[52:55], v[196:199], v[204:207], v[52:55]
ds_read_b64 v[82:83], v4 offset:2312
v_mfma_f32_16x16x32_bf16 v[32:35], v[160:163], v[164:167], v[32:35]
ds_read_b64 v[120:121], v4 offset:23808
v_mfma_f32_16x16x32_bf16 v[48:51], v[200:203], v[204:207], v[48:51]
ds_read_b64 v[122:123], v4 offset:23816
v_subrev_u32 v7, 16, v7
v_and_or_b32 v5, v7, 48, v6
v_mfma_f32_16x16x32_bf16 v[32:35], v[64:67], v[100:103], v[32:35]
ds_read_b64 v[144:145], v4 offset:320
ds_read_b64 v[146:147], v4 offset:328
v_mfma_f32_16x16x32_bf16 v[36:39], v[64:67], v[96:99], v[36:39]
ds_read_b128 v[180:183], v5 offset:8704
s_waitcnt vmcnt(17)
ds_read_b64_tr_b16 a[24:25], v252 offset:0
ds_read_b64_tr_b16 a[26:27], v252 offset:2560
v_mfma_f32_16x16x32_bf16 v[40:43], v[64:67], v[88:91], v[40:43]
ds_read_b128 v[176:179], v5 offset:6656
v_mfma_f32_16x16x32_bf16 v[44:47], v[64:67], v[84:87], v[44:47]
ds_read_b128 v[168:171], v5 offset:2560
v_mfma_f32_16x16x32_bf16 v[48:51], v[104:107], v[140:143], v[48:51]
ds_read_b128 v[164:167], v5 offset:512
ds_read_b64 v[184:185], v4 offset:21824
ds_read_b64_tr_b16 a[28:29], v252 offset:8
ds_read_b64_tr_b16 a[30:31], v252 offset:2568
v_mfma_f32_16x16x32_bf16 v[52:55], v[104:107], v[136:139], v[52:55]
ds_read_b64 v[186:187], v4 offset:21832
s_waitcnt lgkmcnt(15)
v_mfma_f32_16x16x32_bf16 v[56:59], v[104:107], v[128:131], v[56:59]
ds_read_b128 v[220:223], v5 offset:33024
v_mfma_f32_16x16x32_bf16 v[60:63], v[104:107], v[124:127], v[60:63]
ds_read_b128 v[216:219], v5 offset:30976
ds_read_b64_tr_b16 a[32:33], v252 offset:64
ds_read_b64_tr_b16 a[34:35], v252 offset:2624
v_mfma_f32_16x16x32_bf16 v[32:35], v[68:71], v[96:99], v[32:35]
ds_read_b128 v[208:211], v5 offset:26880
ds_read_b128 v[204:207], v5 offset:24832
v_mfma_f32_16x16x32_bf16 v[36:39], v[68:71], v[92:95], v[36:39]
ds_read_b64 v[148:149], v4 offset:832
v_mfma_f32_16x16x32_bf16 v[40:43], v[68:71], v[84:87], v[40:43]
ds_read_b64 v[150:151], v4 offset:840
ds_read_b64_tr_b16 a[36:37], v252 offset:72
ds_read_b64_tr_b16 a[38:39], v252 offset:2632
v_mfma_f32_16x16x32_bf16 v[48:51], v[108:111], v[136:139], v[48:51]
ds_read_b128 v[172:175], v5 offset:4608
v_mfma_f32_16x16x32_bf16 v[52:55], v[108:111], v[132:135], v[52:55]
ds_read_b64 v[188:189], v4 offset:22336
ds_read_b64 v[190:191], v4 offset:22344
v_mfma_f32_16x16x32_bf16 v[56:59], v[108:111], v[124:127], v[56:59]
ds_read_b128 v[212:215], v5 offset:28928
ds_read_b64_tr_b16 a[40:41], v253 offset:128
ds_read_b64_tr_b16 a[42:43], v253 offset:2688
v_mfma_f32_16x16x32_bf16 v[32:35], v[72:75], v[92:95], v[32:35]
ds_read_b64 v[152:153], v4 offset:1344
v_mfma_f32_16x16x32_bf16 v[36:39], v[72:75], v[88:91], v[36:39]
ds_read_b64 v[154:155], v4 offset:1352
v_mfma_f32_16x16x32_bf16 v[48:51], v[112:115], v[132:135], v[48:51]
ds_read_b64 v[192:193], v4 offset:22848
ds_read_b64 v[194:195], v4 offset:22856
buffer_load_dwordx4 v229, s[60:63], s29 offen offset:1024 lds
v_mfma_f32_16x16x32_bf16 v[52:55], v[112:115], v[128:131], v[52:55]
ds_read_b64 v[156:157], v4 offset:1856
v_mfma_f32_16x16x32_bf16 v[32:35], v[76:79], v[88:91], v[32:35]
ds_read_b64 v[158:159], v4 offset:1864
v_mfma_f32_16x16x32_bf16 v[36:39], v[76:79], v[84:87], v[36:39]
ds_read_b64 v[196:197], v4 offset:23360
buffer_load_dwordx4 v230, s[60:63], s29 offen offset:2048 lds
v_mfma_f32_16x16x32_bf16 v[48:51], v[116:119], v[128:131], v[48:51]
ds_read_b64 v[198:199], v4 offset:23368
ds_read_b64 v[160:161], v4 offset:2368
v_mfma_f32_16x16x32_bf16 v[52:55], v[116:119], v[124:127], v[52:55]
ds_read_b64 v[162:163], v4 offset:2376
s_waitcnt lgkmcnt(15)
v_mfma_f32_16x16x32_bf16 v[32:35], v[80:83], v[84:87], v[32:35]
ds_read_b64 v[200:201], v4 offset:23872
v_mfma_f32_16x16x32_bf16 v[48:51], v[120:123], v[124:127], v[48:51]
ds_read_b64 v[202:203], v4 offset:23880
v_subrev_u32 v7, 16, v7
v_and_or_b32 v5, v7, 48, v6
v_mfma_f32_16x16x32_bf16 v[32:35], v[144:147], v[180:183], v[32:35]
ds_read_b64 v[64:65], v4 offset:384
ds_read_b64 v[66:67], v4 offset:392
v_mfma_f32_16x16x32_bf16 v[36:39], v[144:147], v[176:179], v[36:39]
ds_read_b128 v[100:103], v5 offset:8448
buffer_load_dwordx4 v[232:235], v248, s[44:47], s19 offen offset:0 sc1
buffer_load_dwordx4 v[236:239], v249, s[44:47], s19 offen offset:0 sc1
buffer_load_dwordx4 v[240:243], v248, s[44:47], s19 offen offset:2048 sc1
buffer_load_dwordx4 v[244:247], v249, s[44:47], s19 offen offset:2048 sc1
v_mfma_f32_16x16x32_bf16 v[40:43], v[144:147], v[168:171], v[40:43]
ds_read_b128 v[96:99], v5 offset:6400
v_mfma_f32_16x16x32_bf16 v[44:47], v[144:147], v[164:167], v[44:47]
ds_read_b128 v[88:91], v5 offset:2304
v_mfma_f32_16x16x32_bf16 v[48:51], v[184:187], v[220:223], v[48:51]
ds_read_b128 v[84:87], v5 offset:256
ds_read_b64 v[104:105], v4 offset:21888
v_mfma_f32_16x16x32_bf16 v[52:55], v[184:187], v[216:219], v[52:55]
ds_read_b64 v[106:107], v4 offset:21896
v_mfma_f32_16x16x32_bf16 v[56:59], v[184:187], v[208:211], v[56:59]
ds_read_b128 v[140:143], v5 offset:32768
v_mfma_f32_16x16x32_bf16 v[60:63], v[184:187], v[204:207], v[60:63]
ds_read_b128 v[136:139], v5 offset:30720
v_mfma_f32_16x16x32_bf16 v[32:35], v[148:151], v[176:179], v[32:35]
ds_read_b128 v[128:131], v5 offset:26624
ds_read_b128 v[124:127], v5 offset:24576
v_mfma_f32_16x16x32_bf16 v[36:39], v[148:151], v[172:175], v[36:39]
ds_read_b64 v[68:69], v4 offset:896
v_mfma_f32_16x16x32_bf16 v[40:43], v[148:151], v[164:167], v[40:43]
ds_read_b64 v[70:71], v4 offset:904
s_waitcnt lgkmcnt(15)
v_mfma_f32_16x16x32_bf16 v[48:51], v[188:191], v[216:219], v[48:51]
ds_read_b128 v[92:95], v5 offset:4352
v_mfma_f32_16x16x32_bf16 v[52:55], v[188:191], v[212:215], v[52:55]
ds_read_b64 v[108:109], v4 offset:22400
ds_read_b64 v[110:111], v4 offset:22408
v_mfma_f32_16x16x32_bf16 v[56:59], v[188:191], v[204:207], v[56:59]
ds_read_b128 v[132:135], v5 offset:28672
v_mfma_f32_16x16x32_bf16 v[32:35], v[152:155], v[172:175], v[32:35]
ds_read_b64 v[72:73], v4 offset:1408
v_mfma_f32_16x16x32_bf16 v[36:39], v[152:155], v[168:171], v[36:39]
ds_read_b64 v[74:75], v4 offset:1416
v_mfma_f32_16x16x32_bf16 v[48:51], v[192:195], v[212:215], v[48:51]
ds_read_b64 v[112:113], v4 offset:22912
ds_read_b64 v[114:115], v4 offset:22920
v_mfma_f32_16x16x32_bf16 v[52:55], v[192:195], v[208:211], v[52:55]
ds_read_b64 v[76:77], v4 offset:1920
v_mfma_f32_16x16x32_bf16 v[32:35], v[156:159], v[168:171], v[32:35]
ds_read_b64 v[78:79], v4 offset:1928
v_mfma_f32_16x16x32_bf16 v[36:39], v[156:159], v[164:167], v[36:39]
ds_read_b64 v[116:117], v4 offset:23424
v_mfma_f32_16x16x32_bf16 v[48:51], v[196:199], v[208:211], v[48:51]
ds_read_b64 v[118:119], v4 offset:23432
ds_read_b64 v[80:81], v4 offset:2432
v_mfma_f32_16x16x32_bf16 v[52:55], v[196:199], v[204:207], v[52:55]
ds_read_b64 v[82:83], v4 offset:2440
v_mfma_f32_16x16x32_bf16 v[32:35], v[160:163], v[164:167], v[32:35]
ds_read_b64 v[120:121], v4 offset:23936
s_waitcnt lgkmcnt(15)
v_mfma_f32_16x16x32_bf16 v[48:51], v[200:203], v[204:207], v[48:51]
ds_read_b64 v[122:123], v4 offset:23944
v_subrev_u32 v7, 16, v7
v_and_or_b32 v5, v7, 48, v6
v_mfma_f32_16x16x32_bf16 v[32:35], v[64:67], v[100:103], v[32:35]
ds_read_b64 v[144:145], v4 offset:448
ds_read_b64 v[146:147], v4 offset:456
v_mfma_f32_16x16x32_bf16 v[36:39], v[64:67], v[96:99], v[36:39]
ds_read_b128 v[180:183], v5 offset:8192
s_waitcnt vmcnt(9)
v_cmp_ne_u32 vcc, s6, v30
s_nop 3
s_cbranch_vccz qok_37
poll_38:
buffer_load_dword v30, v31, s[44:47], s23 offen sc1
s_waitcnt vmcnt(0)
v_cmp_eq_u32 vcc, s6, v30
s_nop 3
s_cmp_eq_u64 vcc, -1
s_cbranch_scc1 pollok_39
s_sub_u32 s98, s98, 1
s_cbranch_scc0 poll_38
s_mov_b32 s98, 0
pollok_39:
qok_37:
s_add_u32 s8, s18, 0xfc0000
buffer_load_dwordx4 v[8:11], v231, s[44:47], s8 offen offset:0 sc1
buffer_load_dwordx4 v[16:19], v231, s[44:47], s8 offen offset:256 sc1
s_add_u32 s8, s18, 0xfe8000
buffer_load_dwordx4 v[12:15], v231, s[44:47], s8 offen offset:0 sc1
buffer_load_dwordx4 v[20:23], v231, s[44:47], s8 offen offset:256 sc1
v_mfma_f32_16x16x32_bf16 v[40:43], v[64:67], v[88:91], v[40:43]
ds_read_b128 v[176:179], v5 offset:6144
v_mfma_f32_16x16x32_bf16 v[44:47], v[64:67], v[84:87], v[44:47]
ds_read_b128 v[168:171], v5 offset:2048
v_mfma_f32_16x16x32_bf16 v[48:51], v[104:107], v[140:143], v[48:51]
ds_read_b128 v[164:167], v5 offset:0
ds_read_b64 v[184:185], v4 offset:21952
v_mfma_f32_16x16x32_bf16 v[52:55], v[104:107], v[136:139], v[52:55]
ds_read_b64 v[186:187], v4 offset:21960
v_mfma_f32_16x16x32_bf16 v[56:59], v[104:107], v[128:131], v[56:59]
ds_read_b128 v[220:223], v5 offset:32512
v_mfma_f32_16x16x32_bf16 v[60:63], v[104:107], v[124:127], v[60:63]
ds_read_b128 v[216:219], v5 offset:30464
v_mfma_f32_16x16x32_bf16 v[32:35], v[68:71], v[96:99], v[32:35]
ds_read_b128 v[208:211], v5 offset:26368
ds_read_b128 v[204:207], v5 offset:24320
s_waitcnt lgkmcnt(15)
v_mfma_f32_16x16x32_bf16 v[36:39], v[68:71], v[92:95], v[36:39]
ds_read_b64 v[148:149], v4 offset:960
v_mfma_f32_16x16x32_bf16 v[40:43], v[68:71], v[84:87], v[40:43]
ds_read_b64 v[150:151], v4 offset:968
v_mfma_f32_16x16x32_bf16 v[48:51], v[108:111], v[136:139], v[48:51]
ds_read_b128 v[172:175], v5 offset:4096
v_mfma_f32_16x16x32_bf16 v[52:55], v[108:111], v[132:135], v[52:55]
ds_read_b64 v[188:189], v4 offset:22464
ds_read_b64 v[190:191], v4 offset:22472
v_mfma_f32_16x16x32_bf16 v[56:59], v[108:111], v[124:127], v[56:59]
ds_read_b128 v[212:215], v5 offset:28416
v_mfma_f32_16x16x32_bf16 v[32:35], v[72:75], v[92:95], v[32:35]
ds_read_b64 v[152:153], v4 offset:1472
v_mfma_f32_16x16x32_bf16 v[36:39], v[72:75], v[88:91], v[36:39]
ds_read_b64 v[154:155], v4 offset:1480
v_mfma_f32_16x16x32_bf16 v[48:51], v[112:115], v[132:135], v[48:51]
ds_read_b64 v[192:193], v4 offset:22976
ds_read_b64 v[194:195], v4 offset:22984
v_mfma_f32_16x16x32_bf16 v[52:55], v[112:115], v[128:131], v[52:55]
ds_read_b64 v[156:157], v4 offset:1984
v_mfma_f32_16x16x32_bf16 v[32:35], v[76:79], v[88:91], v[32:35]
ds_read_b64 v[158:159], v4 offset:1992
v_mfma_f32_16x16x32_bf16 v[36:39], v[76:79], v[84:87], v[36:39]
ds_read_b64 v[196:197], v4 offset:23488
v_mfma_f32_16x16x32_bf16 v[48:51], v[116:119], v[128:131], v[48:51]
ds_read_b64 v[198:199], v4 offset:23496
ds_read_b64 v[160:161], v4 offset:2496
v_mfma_f32_16x16x32_bf16 v[52:55], v[116:119], v[124:127], v[52:55]
ds_read_b64 v[162:163], v4 offset:2504
s_waitcnt lgkmcnt(15)
v_mfma_f32_16x16x32_bf16 v[32:35], v[80:83], v[84:87], v[32:35]
ds_read_b64 v[200:201], v4 offset:24000
v_mfma_f32_16x16x32_bf16 v[48:51], v[120:123], v[124:127], v[48:51]
ds_read_b64 v[202:203], v4 offset:24008
v_mfma_f32_16x16x32_bf16 v[32:35], v[144:147], v[180:183], v[32:35]
v_mfma_f32_16x16x32_bf16 v[36:39], v[144:147], v[176:179], v[36:39]
v_mfma_f32_16x16x32_bf16 v[40:43], v[144:147], v[168:171], v[40:43]
v_mfma_f32_16x16x32_bf16 v[44:47], v[144:147], v[164:167], v[44:47]
v_mfma_f32_16x16x32_bf16 v[48:51], v[184:187], v[220:223], v[48:51]
v_mfma_f32_16x16x32_bf16 v[52:55], v[184:187], v[216:219], v[52:55]
v_mfma_f32_16x16x32_bf16 v[56:59], v[184:187], v[208:211], v[56:59]
v_mfma_f32_16x16x32_bf16 v[60:63], v[184:187], v[204:207], v[60:63]
s_waitcnt lgkmcnt(15)
v_mfma_f32_16x16x32_bf16 v[32:35], v[148:151], v[176:179], v[32:35]
v_mfma_f32_16x16x32_bf16 v[36:39], v[148:151], v[172:175], v[36:39]
v_mfma_f32_16x16x32_bf16 v[40:43], v[148:151], v[164:167], v[40:43]
s_waitcnt lgkmcnt(13)
v_mfma_f32_16x16x32_bf16 v[48:51], v[188:191], v[216:219], v[48:51]
s_waitcnt lgkmcnt(12)
v_mfma_f32_16x16x32_bf16 v[52:55], v[188:191], v[212:215], v[52:55]
v_mfma_f32_16x16x32_bf16 v[56:59], v[188:191], v[204:207], v[56:59]
s_waitcnt lgkmcnt(10)
v_mfma_f32_16x16x32_bf16 v[32:35], v[152:155], v[172:175], v[32:35]
v_mfma_f32_16x16x32_bf16 v[36:39], v[152:155], v[168:171], v[36:39]
s_waitcnt lgkmcnt(8)
v_mfma_f32_16x16x32_bf16 v[48:51], v[192:195], v[212:215], v[48:51]
v_mfma_f32_16x16x32_bf16 v[52:55], v[192:195], v[208:211], v[52:55]
s_waitcnt lgkmcnt(6)
v_mfma_f32_16x16x32_bf16 v[32:35], v[156:159], v[168:171], v[32:35]
v_mfma_f32_16x16x32_bf16 v[36:39], v[156:159], v[164:167], v[36:39]
s_waitcnt lgkmcnt(4)
v_mfma_f32_16x16x32_bf16 v[48:51], v[196:199], v[208:211], v[48:51]
v_mfma_f32_16x16x32_bf16 v[52:55], v[196:199], v[204:207], v[52:55]
s_waitcnt lgkmcnt(2)
v_mfma_f32_16x16x32_bf16 v[32:35], v[160:163], v[164:167], v[32:35]
s_waitcnt lgkmcnt(0)
v_mfma_f32_16x16x32_bf16 v[48:51], v[200:203], v[204:207], v[48:51]
s_barrier
s_mul_i32 s8, s5, 2080
s_add_u32 s8, s8, 143360
v_lshlrev_b32 v6, 3, v1
v_add_u32 v6, s8, v6
s_nop 0
v_cvt_pk_bf16_f32 v64, v32, v33
v_cvt_pk_bf16_f32 v65, v34, v35
ds_write_b64 v6, v[64:65] offset:0
v_cvt_pk_bf16_f32 v66, v36, v37
v_cvt_pk_bf16_f32 v67, v38, v39
ds_write_b64 v6, v[66:67] offset:512
v_cvt_pk_bf16_f32 v68, v40, v41
v_cvt_pk_bf16_f32 v69, v42, v43
ds_write_b64 v6, v[68:69] offset:1024
v_cvt_pk_bf16_f32 v70, v44, v45
v_cvt_pk_bf16_f32 v71, v46, v47
ds_write_b64 v6, v[70:71] offset:1536
v_cvt_pk_bf16_f32 v72, v48, v49
v_cvt_pk_bf16_f32 v73, v50, v51
ds_write_b64 v6, v[72:73] offset:8320
v_cvt_pk_bf16_f32 v74, v52, v53
v_cvt_pk_bf16_f32 v75, v54, v55
ds_write_b64 v6, v[74:75] offset:8832
v_cvt_pk_bf16_f32 v76, v56, v57
v_cvt_pk_bf16_f32 v77, v58, v59
ds_write_b64 v6, v[76:77] offset:9344
v_cvt_pk_bf16_f32 v78, v60, v61
v_cvt_pk_bf16_f32 v79, v62, v63
ds_write_b64 v6, v[78:79] offset:9856
v_bfe_u32 v7, v1, 2, 2
v_mul_u32_u24 v7, 2080, v7
v_and_b32 v4, 3, v1
v_lshl_add_u32 v7, v4, 7, v7
v_and_b32 v4, 48, v1
s_lshl_b32 s8, s5, 9
s_add_u32 s8, s8, 143360
v_add3_u32 v7, v7, v4, s8
s_lshl_b32 s8, s17, 3
s_sub_u32 s10, 8, s8
v_add_u32 v4, s8, v7
v_add_u32 v5, s10, v7
s_waitcnt lgkmcnt(0)
s_barrier
ds_read_b64_tr_b16 v[64:65], v4 offset:0
ds_read_b64_tr_b16 v[66:67], v5 offset:0
ds_read_b64_tr_b16 v[68:69], v4 offset:64
ds_read_b64_tr_b16 v[70:71], v5 offset:64
ds_read_b64_tr_b16 v[72:73], v4 offset:8320
ds_read_b64_tr_b16 v[74:75], v5 offset:8320
ds_read_b64_tr_b16 v[76:77], v4 offset:8384
ds_read_b64_tr_b16 v[78:79], v5 offset:8384
s_waitcnt vmcnt(0)
v_cmp_eq_u32 vcc, s6, v234
v_cmp_eq_u32 s[10:11], s6, v238
s_nop 3
s_and_b64 vcc, vcc, s[10:11]
v_cmp_eq_u32 s[10:11], s6, v242
s_nop 3
s_and_b64 vcc, vcc, s[10:11]
v_cmp_eq_u32 s[10:11], s6, v246
s_nop 3
s_and_b64 vcc, vcc, s[10:11]
s_cmp_eq_u64 vcc, -1
s_cbranch_scc1 stok_40
poll_41:
buffer_load_dwordx4 v[232:235], v248, s[44:47], s19 offen offset:0 sc1
buffer_load_dwordx4 v[236:239], v249, s[44:47], s19 offen offset:0 sc1
buffer_load_dwordx4 v[240:243], v248, s[44:47], s19 offen offset:2048 sc1
buffer_load_dwordx4 v[244:247], v249, s[44:47], s19 offen offset:2048 sc1
s_waitcnt vmcnt(0)
v_cmp_eq_u32 vcc, s6, v234
v_cmp_eq_u32 s[10:11], s6, v238
s_nop 3
s_and_b64 vcc, vcc, s[10:11]
v_cmp_eq_u32 s[10:11], s6, v242
s_nop 3
s_and_b64 vcc, vcc, s[10:11]
v_cmp_eq_u32 s[10:11], s6, v246
s_nop 3
s_and_b64 vcc, vcc, s[10:11]
s_cmp_eq_u64 vcc, -1
s_cbranch_scc1 pollok_42
s_sub_u32 s98, s98, 1
s_cbranch_scc0 poll_41
s_mov_b32 s98, 0
pollok_42:
stok_40:
s_add_u32 s20, s18, 0x840000
s_add_u32 s21, s18, 0xac0000
s_waitcnt lgkmcnt(6)
v_lshlrev_b32 v128, 16, v8
v_and_b32 v129, s14, v8
v_lshlrev_b32 v136, 16, v64
v_and_b32 v137, s14, v64
v_lshlrev_b32 v130, 16, v9
v_and_b32 v131, s14, v9
v_lshlrev_b32 v138, 16, v65
v_and_b32 v139, s14, v65
v_lshlrev_b32 v132, 16, v10
v_and_b32 v133, s14, v10
v_lshlrev_b32 v140, 16, v66
v_and_b32 v141, s14, v66
v_lshlrev_b32 v134, 16, v11
v_and_b32 v135, s14, v11
v_lshlrev_b32 v142, 16, v67
v_and_b32 v143, s14, v67
v_pk_fma_f32 v[144:145], v[128:129], v[232:233], v[232:233] op_sel:[0,0,1] op_sel_hi:[1,0,1]
v_pk_fma_f32 v[146:147], v[130:131], v[232:233], v[232:233] op_sel:[0,0,1] op_sel_hi:[1,0,1]
v_pk_fma_f32 v[148:149], v[132:133], v[236:237], v[236:237] op_sel:[0,0,1] op_sel_hi:[1,0,1]
v_pk_fma_f32 v[150:151], v[134:135], v[236:237], v[236:237] op_sel:[0,0,1] op_sel_hi:[1,0,1]
v_pk_fma_f32 v[144:145], v[144:145], v[136:137], v[128:129]
v_pk_fma_f32 v[146:147], v[146:147], v[138:139], v[130:131]
v_pk_fma_f32 v[148:149], v[148:149], v[140:141], v[132:133]
v_pk_fma_f32 v[150:151], v[150:151], v[142:143], v[134:135]
v_cvt_pk_bf16_f32 v112, v144, v145
v_cvt_pk_bf16_f32 v113, v146, v147
v_cvt_pk_bf16_f32 v114, v148, v149
v_cvt_pk_bf16_f32 v115, v150, v151
buffer_store_dwordx4 v[112:115], v231, s[44:47], s21 offen offset:0 sc1
s_waitcnt lgkmcnt(2)
v_lshlrev_b32 v128, 16, v16
v_and_b32 v129, s14, v16
v_lshlrev_b32 v136, 16, v72
v_and_b32 v137, s14, v72
v_lshlrev_b32 v130, 16, v17
v_and_b32 v131, s14, v17
v_lshlrev_b32 v138, 16, v73
v_and_b32 v139, s14, v73
v_lshlrev_b32 v132, 16, v18
v_and_b32 v133, s14, v18
v_lshlrev_b32 v140, 16, v74
v_and_b32 v141, s14, v74
v_lshlrev_b32 v134, 16, v19
v_and_b32 v135, s14, v19
v_lshlrev_b32 v142, 16, v75
v_and_b32 v143, s14, v75
v_pk_fma_f32 v[144:145], v[128:129], v[232:233], v[232:233] op_sel:[0,0,1] op_sel_hi:[1,0,1]
v_pk_fma_f32 v[146:147], v[130:131], v[232:233], v[232:233] op_sel:[0,0,1] op_sel_hi:[1,0,1]
v_pk_fma_f32 v[148:149], v[132:133], v[236:237], v[236:237] op_sel:[0,0,1] op_sel_hi:[1,0,1]
v_pk_fma_f32 v[150:151], v[134:135], v[236:237], v[236:237] op_sel:[0,0,1] op_sel_hi:[1,0,1]
v_pk_fma_f32 v[144:145], v[144:145], v[136:137], v[128:129]
v_pk_fma_f32 v[146:147], v[146:147], v[138:139], v[130:131]
v_pk_fma_f32 v[148:149], v[148:149], v[140:141], v[132:133]
v_pk_fma_f32 v[150:151], v[150:151], v[142:143], v[134:135]
v_cvt_pk_bf16_f32 v120, v144, v145
v_cvt_pk_bf16_f32 v121, v146, v147
v_cvt_pk_bf16_f32 v122, v148, v149
v_cvt_pk_bf16_f32 v123, v150, v151
buffer_store_dwordx4 v[120:123], v231, s[44:47], s21 offen offset:256 sc1
s_add_u32 s20, s18, 0x868000
s_add_u32 s21, s18, 0xae8000
v_lshlrev_b32 v128, 16, v12
v_and_b32 v129, s14, v12
v_lshlrev_b32 v136, 16, v68
v_and_b32 v137, s14, v68
v_lshlrev_b32 v130, 16, v13
v_and_b32 v131, s14, v13
v_lshlrev_b32 v138, 16, v69
v_and_b32 v139, s14, v69
v_lshlrev_b32 v132, 16, v14
v_and_b32 v133, s14, v14
v_lshlrev_b32 v140, 16, v70
v_and_b32 v141, s14, v70
v_lshlrev_b32 v134, 16, v15
v_and_b32 v135, s14, v15
v_lshlrev_b32 v142, 16, v71
v_and_b32 v143, s14, v71
v_pk_fma_f32 v[144:145], v[128:129], v[240:241], v[240:241] op_sel:[0,0,1] op_sel_hi:[1,0,1]
v_pk_fma_f32 v[146:147], v[130:131], v[240:241], v[240:241] op_sel:[0,0,1] op_sel_hi:[1,0,1]
v_pk_fma_f32 v[148:149], v[132:133], v[244:245], v[244:245] op_sel:[0,0,1] op_sel_hi:[1,0,1]
v_pk_fma_f32 v[150:151], v[134:135], v[244:245], v[244:245] op_sel:[0,0,1] op_sel_hi:[1,0,1]
v_pk_fma_f32 v[144:145], v[144:145], v[136:137], v[128:129]
v_pk_fma_f32 v[146:147], v[146:147], v[138:139], v[130:131]
v_pk_fma_f32 v[148:149], v[148:149], v[140:141], v[132:133]
v_pk_fma_f32 v[150:151], v[150:151], v[142:143], v[134:135]
v_cvt_pk_bf16_f32 v116, v144, v145
v_cvt_pk_bf16_f32 v117, v146, v147
v_cvt_pk_bf16_f32 v118, v148, v149
v_cvt_pk_bf16_f32 v119, v150, v151
buffer_store_dwordx4 v[116:119], v231, s[44:47], s21 offen offset:0 sc1
s_waitcnt lgkmcnt(0)
v_lshlrev_b32 v128, 16, v20
v_and_b32 v129, s14, v20
v_lshlrev_b32 v136, 16, v76
v_and_b32 v137, s14, v76
v_lshlrev_b32 v130, 16, v21
v_and_b32 v131, s14, v21
v_lshlrev_b32 v138, 16, v77
v_and_b32 v139, s14, v77
v_lshlrev_b32 v132, 16, v22
v_and_b32 v133, s14, v22
v_lshlrev_b32 v140, 16, v78
v_and_b32 v141, s14, v78
v_lshlrev_b32 v134, 16, v23
v_and_b32 v135, s14, v23
v_lshlrev_b32 v142, 16, v79
v_and_b32 v143, s14, v79
v_pk_fma_f32 v[144:145], v[128:129], v[240:241], v[240:241] op_sel:[0,0,1] op_sel_hi:[1,0,1]
v_pk_fma_f32 v[146:147], v[130:131], v[240:241], v[240:241] op_sel:[0,0,1] op_sel_hi:[1,0,1]
v_pk_fma_f32 v[148:149], v[132:133], v[244:245], v[244:245] op_sel:[0,0,1] op_sel_hi:[1,0,1]
v_pk_fma_f32 v[150:151], v[134:135], v[244:245], v[244:245] op_sel:[0,0,1] op_sel_hi:[1,0,1]
v_pk_fma_f32 v[144:145], v[144:145], v[136:137], v[128:129]
v_pk_fma_f32 v[146:147], v[146:147], v[138:139], v[130:131]
v_pk_fma_f32 v[148:149], v[148:149], v[140:141], v[132:133]
v_pk_fma_f32 v[150:151], v[150:151], v[142:143], v[134:135]
v_cvt_pk_bf16_f32 v124, v144, v145
v_cvt_pk_bf16_f32 v125, v146, v147
v_cvt_pk_bf16_f32 v126, v148, v149
v_cvt_pk_bf16_f32 v127, v150, v151
buffer_store_dwordx4 v[124:127], v231, s[44:47], s21 offen offset:256 sc1
buffer_store_dwordx4 a[24:27], v254, s[44:47], 0 offen offset:0 sc1
buffer_store_dwordx4 a[28:31], v254, s[44:47], 0 offen offset:1024 sc1
buffer_store_dwordx4 a[32:35], v254, s[44:47], 0 offen offset:2048 sc1
buffer_store_dwordx4 a[36:39], v254, s[44:47], 0 offen offset:3072 sc1
s_movk_i32 s8, 0x1000
buffer_store_dwordx4 a[40:43], v254, s[44:47], s8 offen sc1
s_add_u32 s8, s5, 8
s_mul_i32 s28, s8, 7168
s_mul_i32 s29, s8, 110592
s_cmp_lt_u32 s8, 10
s_cselect_b32 s8, s24, s25
s_add_u32 s29, s29, s8
s_mov_b32 m0, s28
s_nop 0
buffer_load_dwordx4 v224, s[60:63], s29 offen offset:0 lds
buffer_load_dwordx4 v225, s[60:63], s29 offen offset:1024 lds
buffer_load_dwordx4 v226, s[60:63], s29 offen offset:2048 lds
buffer_load_dwordx4 v227, s[60:63], s29 offen offset:3072 lds
s_add_u32 m0, s28, 4096
s_nop 0
buffer_load_dwordx4 v228, s[60:63], s29 offen offset:0 lds
s_mul_i32 s8, s5, 7168
v_lshrrev_b32 v4, 2, v1
v_mul_u32_u24 v4, 224, v4
v_and_b32 v5, 3, v1
v_lshl_add_u32 v4, v5, 3, v4
v_add_u32 v4, s8, v4
v_add_u32 v5, 0x15000, v4
v_mov_b32 v80, 0x3f803f80
v_mov_b32 v81, 0x3f803f80
v_mov_b32 v82, 0x3f803f80
v_mov_b32 v83, 0x3f803f80
ds_read_b64_tr_b16 v[96:97], v4 offset:0
ds_read_b64_tr_b16 v[98:99], v4 offset:3584
ds_read_b64_tr_b16 v[100:101], v4 offset:32
ds_read_b64_tr_b16 v[102:103], v4 offset:3616
ds_read_b64_tr_b16 v[104:105], v4 offset:64
ds_read_b64_tr_b16 v[106:107], v4 offset:3648
ds_read_b64_tr_b16 v[108:109], v4 offset:96
ds_read_b64_tr_b16 v[110:111], v4 offset:3680
ds_read_b64_tr_b16 v[112:113], v4 offset:128
ds_read_b64_tr_b16 v[114:115], v4 offset:3712
ds_read_b64_tr_b16 v[116:117], v4 offset:160
ds_read_b64_tr_b16 v[118:119], v4 offset:3744
ds_read_b64_tr_b16 v[120:121], v4 offset:192
ds_read_b64_tr_b16 v[122:123], v4 offset:3776
s_waitcnt lgkmcnt(12)
v_mfma_f32_16x16x32_bf16 v[32:35], v[96:99], v[80:83], 0
ds_read_b64_tr_b16 v[124:125], v4 offset:28672
ds_read_b64_tr_b16 v[126:127], v4 offset:32256
s_waitcnt lgkmcnt(12)
v_mfma_f32_16x16x32_bf16 v[36:39], v[100:103], v[80:83], 0
ds_read_b64_tr_b16 v[128:129], v4 offset:28704
ds_read_b64_tr_b16 v[130:131], v4 offset:32288
s_waitcnt lgkmcnt(12)
v_mfma_f32_16x16x32_bf16 v[40:43], v[104:107], v[80:83], 0
ds_read_b64_tr_b16 v[132:133], v4 offset:28736
ds_read_b64_tr_b16 v[134:135], v4 offset:32320
s_waitcnt lgkmcnt(12)
v_mfma_f32_16x16x32_bf16 v[44:47], v[108:111], v[80:83], 0
ds_read_b64_tr_b16 v[136:137], v4 offset:28768
ds_read_b64_tr_b16 v[138:139], v4 offset:32352
s_waitcnt lgkmcnt(12)
v_mfma_f32_16x16x32_bf16 v[48:51], v[112:115], v[80:83], 0
ds_read_b64_tr_b16 v[140:141], v4 offset:28800
ds_read_b64_tr_b16 v[142:143], v4 offset:32384
s_waitcnt lgkmcnt(12)
v_mfma_f32_16x16x32_bf16 v[52:55], v[116:119], v[80:83], 0
ds_read_b64_tr_b16 v[144:145], v4 offset:28832
ds_read_b64_tr_b16 v[146:147], v4 offset:32416
s_waitcnt lgkmcnt(12)
v_mfma_f32_16x16x32_bf16 v[56:59], v[120:123], v[80:83], 0
ds_read_b64_tr_b16 v[148:149], v4 offset:28864
ds_read_b64_tr_b16 v[150:151], v4 offset:32448
s_waitcnt lgkmcnt(12)
v_mfma_f32_16x16x32_bf16 v[32:35], v[124:127], v[80:83], v[32:35]
s_waitcnt lgkmcnt(10)
v_mfma_f32_16x16x32_bf16 v[36:39], v[128:131], v[80:83], v[36:39]
s_waitcnt lgkmcnt(8)
v_mfma_f32_16x16x32_bf16 v[40:43], v[132:135], v[80:83], v[40:43]
s_waitcnt lgkmcnt(6)
v_mfma_f32_16x16x32_bf16 v[44:47], v[136:139], v[80:83], v[44:47]
s_waitcnt lgkmcnt(4)
v_mfma_f32_16x16x32_bf16 v[48:51], v[140:143], v[80:83], v[48:51]
s_waitcnt lgkmcnt(2)
v_mfma_f32_16x16x32_bf16 v[52:55], v[144:147], v[80:83], v[52:55]
s_waitcnt lgkmcnt(0)
v_mfma_f32_16x16x32_bf16 v[56:59], v[148:151], v[80:83], v[56:59]
s_lshl_b32 s8, s16, 10
s_lshl_b32 s9, s69, 2
s_add_u32 s8, s8, s9
s_add_u32 s8, s8, 0x4000
v_mov_b32 v6, s6
v_mov_b32 v7, s6
s_waitcnt vmcnt(5)
s_mov_b64 exec, 1
buffer_store_dwordx2 v[6:7], off, s[44:47], s8 sc1
s_mov_b64 exec, -1
s_add_u32 s100, s8, 0x14000
s_mov_b64 s[22:23], 3
s_lshl_b32 s8, s5, 8
s_add_u32 s8, s8, s2
s_cmp_ge_u32 s8, 448
s_cbranch_scc1 nopf_43
s_and_b32 s9, s8, 7
s_lshr_b32 s10, s8, 3
s_lshl_b32 s9, s9, 6
s_add_u32 s9, s9, s10
s_lshl_b32 s9, s9, 2
s_add_u32 s9, s9, 0x3000
s_mov_b64 exec, 1
buffer_store_dword v2, off, s[44:47], s9 sc1
s_mov_b64 exec, -1
nopf_43:
buffer_load_dwordx4 v229, s[60:63], s29 offen offset:1024 lds
v_min_u32 v22, 55, v1
v_lshlrev_b32 v22, 2, v22
s_lshl_b32 s10, s67, 8
s_add_u32 s12, s10, 0x3000
v_min_u32 v12, 39, v1
v_lshlrev_b32 v12, 4, v12
buffer_load_dwordx4 v230, s[60:63], s29 offen offset:2048 lds
s_lshl_b32 s30, s3, 10
s_add_u32 s30, s30, 0x4000
s_lshr_b32 s10, 0xe4, s3
s_bitcmp1_b32 s10, 0
s_cselect_b32 s31, 0, 7168
s_cselect_b32 s11, 80, 0
s_add_u32 s31, s31, 0x4000
v_lshrrev_b32 v26, 5, v1
s_add_u32 s8, s5, 12
s_mul_i32 s28, s8, 7168
s_mul_i32 s29, s8, 110592
s_cmp_lt_u32 s8, 10
s_cselect_b32 s8, s24, s25
s_add_u32 s29, s29, s8
s_mov_b32 m0, s28
s_nop 0
buffer_load_dwordx4 v224, s[60:63], s29 offen offset:0 lds
v_lshlrev_b32 v26, 7, v26
v_and_b32 v27, 31, v1
v_add_u32 v26, v26, v27
v_mul_u32_u24 v26, 224, v26
s_mul_i32 s11, s5, 7168
s_add_u32 s11, s11, 216
buffer_load_dwordx4 v225, s[60:63], s29 offen offset:1024 lds
v_add_u32 v24, s11, v26
v_add_u32 v7, 0x1c000, v24
v_mov_b32 v25, 0x3f80
v_lshlrev_b32 v220, 16, v250
v_mul_f32 v220, 0x3eeff558, v220
v_lshrrev_b32 v20, 4, v1
buffer_load_dwordx4 v226, s[60:63], s29 offen offset:2048 lds
v_lshlrev_b32 v20, 4, v20
s_mul_i32 s10, s5, 448
s_add_u32 s10, s10, 160000
v_add_u32 v20, s10, v20
v_and_b32 v21, 127, v0
v_lshlrev_b32 v222, 2, v21
buffer_load_dwordx4 v227, s[60:63], s29 offen offset:3072 lds
v_add_u32 v222, 160000, v222
s_lshr_b32 s10, s5, 1
s_mul_i32 s10, s10, 112
v_add_u32 v221, s10, v21
v_mul_u32_u24 v221, 224, v221
v_mov_b32 v26, 162048
s_add_u32 m0, s28, 4096
s_nop 0
buffer_load_dwordx4 v228, s[60:63], s29 offen offset:0 lds
v_cmp_gt_u32 vcc, 112, v21
s_nop 1
v_cndmask_b32 v221, v26, v221, vcc
s_cmp_lt_u32 s5, 2
s_cselect_b64 s[68:69], -1, 0
s_mov_b64 s[0:1], s[22:23]
v_lshlrev_b32 v223, 2, v1
s_mul_i32 s32, s67, 56
s_mul_i32 s10, s5, 14
buffer_load_dwordx4 v229, s[60:63], s29 offen offset:1024 lds
s_add_u32 s32, s32, s10
s_mul_i32 s32, s32, 5120
s_add_u32 s32, s32, 0x600000
s_mov_b32 s48, 0x100001
s_mov_b32 s49, 0x10000100
s_mov_b32 s50, 0x200002
buffer_load_dwordx4 v230, s[60:63], s29 offen offset:2048 lds
s_mov_b32 s51, 0x20000200
s_mov_b32 s52, 0x400004
s_mov_b32 s53, 0x40000400
s_mov_b32 s54, 0x800008
s_mov_b32 s55, 0x80000800
s_mov_b32 s56, 0x3eeff558
s_add_u32 s8, s5, 16
s_mul_i32 s28, s8, 7168
s_mul_i32 s29, s8, 110592
s_cmp_lt_u32 s8, 10
s_cselect_b32 s8, s24, s25
s_add_u32 s29, s29, s8
s_mov_b32 m0, s28
s_nop 0
buffer_load_dwordx4 v224, s[60:63], s29 offen offset:0 lds
s_mov_b32 s57, 0x3eeff558
s_mov_b32 s58, -1
s_mov_b32 s59, 0xffff
s_add_u32 s10, s5, s67
s_and_b32 s10, s10, 1
s_lshl_b32 s10, s10, 3
buffer_load_dwordx4 v225, s[60:63], s29 offen offset:1024 lds
v_and_b32 v16, 15, v1
v_lshlrev_b32 v16, 4, v16
v_lshrrev_b32 v17, 4, v1
v_lshl_add_u32 v28, v17, 9, v16
v_lshrrev_b32 v18, 5, v1
v_lshlrev_b32 v18, 3, v18
buffer_load_dwordx4 v226, s[60:63], s29 offen offset:2048 lds
v_xor_b32 v18, s10, v18
v_add_u32 v28, v28, v18
s_add_u32 s10, s10, 4096
v_add_u32 v29, s10, v3
s_not_b32 s10, s6
s_cmp_eq_u32 s7, 0
s_cselect_b32 s99, s6, s10
buffer_load_dwordx4 v227, s[60:63], s29 offen offset:3072 lds
v_mov_b32 v18, v12
v_mov_b32 v19, v12
s_add_u32 s101, s30, 0x14000
s_add_u32 s31, s31, 0x14000
s_lshl_b32 s10, s64, 1
s_add_u32 s10, s10, s66
s_add_u32 m0, s28, 4096
s_nop 0
buffer_load_dwordx4 v228, s[60:63], s29 offen offset:0 lds
s_lshl_b32 s10, s10, 1
s_lshr_b32 s11, s5, 1
s_add_u32 s10, s10, s11
s_mul_i32 s10, s10, 160
s_mul_i32 s11, s67, 20
s_add_u32 s10, s10, s11
buffer_load_dwordx4 v229, s[60:63], s29 offen offset:1024 lds
s_lshl_b32 s25, s10, 8
s_mov_b32 s15, 0
s_lshl_b32 s10, s64, 2
s_add_u32 s10, s10, s5
s_mul_i32 s16, s10, 40960
s_add_u32 s16, s16, 0xac0000
buffer_load_dwordx4 v230, s[60:63], s29 offen offset:2048 lds
s_and_b32 s10, s64, 1
s_mul_i32 s10, s10, 20480
s_sub_u32 s24, s16, s10
s_add_u32 s16, s16, s10
s_lshl_b32 s19, s64, 10
s_add_u32 s19, s19, 0x6000
s_add_u32 s20, s18, 0x840000
buffer_store_dwordx4 v[64:67], v231, s[44:47], s20 offen offset:0 sc1
buffer_store_dwordx4 v[72:75], v231, s[44:47], s20 offen offset:256 sc1
s_add_u32 s20, s18, 0x868000
buffer_store_dwordx4 v[68:71], v231, s[44:47], s20 offen offset:0 sc1
buffer_store_dwordx4 v[76:79], v231, s[44:47], s20 offen offset:256 sc1
s_mov_b32 s18, 0x1240000
s_branch L_convdone
L_cidle:
v_add_u32 v22, 57344, v15
v_cmp_gt_u32 vcc, 220, v0
s_and_b32 s20, s5, 1
s_lshr_b32 s21, s5, 1
v_and_b32 v7, 15, v1
v_mul_u32_u24 v7, 352, v7
v_lshrrev_b32 v19, 4, v1
v_lshl_add_u32 v7, v19, 3, v7
s_add_u32 s11, s3, s21
s_and_b32 s11, s11, 1
s_mul_i32 s12, s20, 5632
s_mul_i32 s13, s21, 96
s_add_u32 s12, s12, s13
s_add_u32 s12, s12, 57520
s_mul_i32 s13, s11, 176
s_add_u32 s15, s12, s13
s_sub_u32 s12, s12, s13
s_add_u32 s12, s12, 176
v_add_u32 v19, s12, v7
v_add_u32 v20, s15, v7
s_lshl_b32 s11, s4, 1
s_add_u32 s11, s11, s20
s_mul_i32 s11, s11, 160
s_mul_i32 s12, s3, 20
s_add_u32 s11, s11, s12
s_mul_i32 s12, s21, 12
s_add_u32 s11, s11, s12
s_lshl_b32 s11, s11, 8
s_add_u32 s15, s11, 0xfc0000
v_mov_b32 v21, 0x3f803f80
v_mov_b32 v28, 0
v_mov_b32 v29, 0
s_waitcnt vmcnt(7)
s_barrier
s_and_b64 exec, exec, vcc
ds_write_b128 v22, a[0:3] offset:0
ds_write_b128 v22, a[4:7] offset:176
ds_write_b128 v22, a[8:11] offset:352
s_mov_b64 exec, -1
v_dot2c_f32_bf16 v28, v238, v21
v_dot2c_f32_bf16 v29, v238, v238
v_dot2c_f32_bf16 v28, v239, v21
v_dot2c_f32_bf16 v29, v239, v239
v_dot2c_f32_bf16 v28, v240, v21
v_dot2c_f32_bf16 v29, v240, v240
v_dot2c_f32_bf16 v28, v241, v21
v_dot2c_f32_bf16 v29, v241, v241
v_dot2c_f32_bf16 v28, v242, v21
v_dot2c_f32_bf16 v29, v242, v242
v_dot2c_f32_bf16 v28, v243, v21
v_dot2c_f32_bf16 v29, v243, v243
v_dot2c_f32_bf16 v28, v244, v21
v_dot2c_f32_bf16 v29, v244, v244
v_dot2c_f32_bf16 v28, v245, v21
v_dot2c_f32_bf16 v29, v245, v245
v_dot2c_f32_bf16 v28, v246, v21
v_dot2c_f32_bf16 v29, v246, v246
v_dot2c_f32_bf16 v28, v247, v21
v_dot2c_f32_bf16 v29, v247, v247
s_waitcnt lgkmcnt(0)
s_barrier
ds_read_b64 a[12:13], v20 offset:0
ds_read_b64 a[14:15], v19 offset:0
ds_read_b64 a[16:17], v19 offset:32
ds_read_b64 a[18:19], v20 offset:32
ds_read_b64 a[20:21], v20 offset:64
ds_read_b64 a[22:23], v19 offset:64
v_add_f32_dpp v28, v28, v28 row_ror:8 row_mask:0xf bank_mask:0xf
v_add_f32_dpp v29, v29, v29 row_ror:8 row_mask:0xf bank_mask:0xf
s_nop 0
v_add_f32_dpp v28, v28, v28 row_ror:4 row_mask:0xf bank_mask:0xf
v_add_f32_dpp v29, v29, v29 row_ror:4 row_mask:0xf bank_mask:0xf
s_nop 0
v_add_f32_dpp v28, v28, v28 row_ror:2 row_mask:0xf bank_mask:0xf
v_add_f32_dpp v29, v29, v29 row_ror:2 row_mask:0xf bank_mask:0xf
s_nop 0
v_add_f32_dpp v28, v28, v28 row_ror:1 row_mask:0xf bank_mask:0xf
v_add_f32_dpp v29, v29, v29 row_ror:1 row_mask:0xf bank_mask:0xf
v_mov_b32 v30, v28
v_mov_b32 v31, v29
s_nop 0
v_permlane16_swap_b32 v28, v30
v_permlane16_swap_b32 v29, v31
v_add_f32 v28, v28, v30
v_add_f32 v29, v29, v31
v_mul_f32 v28, 0x3acccccd, v28
v_mul_f32 v29, 0x3acccccd, v29
v_fma_f32 v29, -v28, v28, v29
v_max_f32 v29, 0, v29
v_add_f32 v29, 0x3727c5ac, v29
v_rsq_f32 v30, v29
s_nop 0
v_mul_f32 v29, v28, v30
v_sub_f32 v29, 0, v29
v_mov_b32 v28, v30
v_mov_b32 v30, s6
v_mov_b32 v31, s6
s_waitcnt lgkmcnt(0)
s_lshl_b32 s8, s2, 3
s_lshl_b32 s10, s5, 1
s_add_u32 s8, s8, s10
s_lshl_b32 s8, s8, 4
s_add_u32 s8, s8, 0x60000
v_lshrrev_b32 v7, 5, v1
v_lshlrev_b32 v7, 4, v7
s_mov_b32 exec_lo, 0x1
s_mov_b32 exec_hi, 0x1
buffer_store_dwordx4 v[28:31], v7, s[44:47], s8 offen sc1
s_mov_b64 exec, -1
buffer_store_dwordx4 a[12:15], v3, s[44:47], s15 offen offset:0 sc1
buffer_store_dwordx4 a[16:19], v3, s[44:47], s15 offen offset:1024 sc1
s_cmp_lt_u32 s5, 2
s_cbranch_scc0 q3_44
buffer_store_dwordx4 a[20:23], v3, s[44:47], s15 offen offset:2048 sc1
s_branch q3d_45
q3_44:
s_mov_b64 exec, 1
buffer_load_dword v255, off, s[44:47], 0
s_mov_b64 exec, -1
q3d_45:
s_barrier
s_mov_b32 s52, s32
s_mov_b32 s53, s33
s_mov_b32 s54, 0xd80
s_mov_b32 s55, 0x20000
s_mov_b32 s56, s36
s_mov_b32 s57, s37
s_mov_b32 s58, 0x500
s_mov_b32 s59, 0x20000
s_and_b32 s8, s4, 15
s_mul_i32 s8, s8, 216
buffer_load_ushort v250, v26, s[52:55], s8 offen
s_and_b32 s8, s4, 7
s_mul_i32 s8, s8, 160
buffer_load_dword v251, v27, s[56:59], s8 offen
s_mov_b32 s52, s30
s_mov_b32 s53, s31
s_mov_b32 s54, 0x21c000
s_mov_b32 s55, 0x20000
s_mov_b64 exec, 0x1ffff
buffer_load_dword v255, v14, s[52:55], 0 offen
s_mov_b64 exec, -1
s_cmp_ge_u32 s5, 2
s_cbranch_scc1 xpad_47
s_lshl_b32 s8, s5, 8
s_add_u32 s8, s8, s2
s_cmp_ge_u32 s8, 448
s_cbranch_scc1 xpad_47
s_mov_b32 s52, s34
s_mov_b32 s53, s35
s_mov_b32 s54, 0x21c000
s_mov_b32 s55, 0x20000
s_and_b32 s22, s8, 7
s_lshr_b32 s10, s8, 3
s_mul_i32 s11, s10, 37
s_lshr_b32 s11, s11, 9
s_mul_i32 s12, s11, 14
s_sub_u32 s12, s10, s12
s_mul_i32 s11, s11, 432
s_mul_i32 s13, s12, 11
s_lshr_b32 s13, s13, 5
s_mul_i32 s28, s13, 12
s_lshl_b32 s29, s12, 5
s_add_u32 s28, s28, s29
s_sub_u32 s29, s12, 12
s_mul_i32 s29, s29, 216
s_add_u32 s29, s29, 96
s_cmp_ge_u32 s12, 12
s_cselect_b32 s28, s29, s28
s_cselect_b32 s29, 117760, 0
s_add_u32 s28, s28, s11
s_mul_i32 s28, s28, 1280
s_mul_i32 s22, s22, 160
s_add_u32 s28, s28, s22
s_add_u32 s22, s28, s29
v_add_u32 v19, 0, v1
v_mul_u32_u24 v24, 205, v19
v_lshrrev_b32 v24, 11, v24
v_mul_u32_u24 v25, 10, v24
v_sub_u32 v19, v19, v25
v_lshlrev_b32 v19, 4, v19
v_mul_u32_u24 v24, 1280, v24
v_add_u32 v19, v19, v24
v_add_u32 v20, 64, v1
v_mul_u32_u24 v24, 205, v20
v_lshrrev_b32 v24, 11, v24
v_mul_u32_u24 v25, 10, v24
v_sub_u32 v20, v20, v25
v_lshlrev_b32 v20, 4, v20
v_mul_u32_u24 v24, 1280, v24
v_add_u32 v20, v20, v24
v_subrev_u32 v20, 1024, v20
v_add_u32 v21, 128, v1
v_mul_u32_u24 v24, 205, v21
v_lshrrev_b32 v24, 11, v24
v_mul_u32_u24 v25, 10, v24
v_sub_u32 v21, v21, v25
v_lshlrev_b32 v21, 4, v21
v_mul_u32_u24 v24, 1280, v24
v_add_u32 v21, v21, v24
v_subrev_u32 v21, 2048, v21
v_add_u32 v22, 192, v1
v_mul_u32_u24 v24, 205, v22
v_lshrrev_b32 v24, 11, v24
v_mul_u32_u24 v25, 10, v24
v_sub_u32 v22, v22, v25
v_lshlrev_b32 v22, 4, v22
v_mul_u32_u24 v24, 1280, v24
v_add_u32 v22, v22, v24
v_subrev_u32 v22, 3072, v22
v_add_u32 v23, 256, v1
v_mul_u32_u24 v24, 205, v23
v_lshrrev_b32 v24, 11, v24
v_mul_u32_u24 v25, 10, v24
v_sub_u32 v23, v23, v25
v_lshlrev_b32 v23, 4, v23
v_mul_u32_u24 v24, 1280, v24
v_add_u32 v23, v23, v24
v_lshrrev_b32 v24, 5, v1
v_mul_i32_i24 v24, s29, v24
v_add_u32 v21, v21, v24
s_mul_i32 s10, s5, 5120
s_add_u32 m0, s10, 57344
s_nop 0
buffer_load_dwordx4 v19, s[52:55], s28 offen offset:0 lds
buffer_load_dwordx4 v20, s[52:55], s28 offen offset:1024 lds
buffer_load_dwordx4 v21, s[52:55], s28 offen offset:2048 lds
buffer_load_dwordx4 v22, s[52:55], s22 offen offset:3072 lds
s_add_u32 m0, s10, 61440
s_nop 0
buffer_load_dwordx4 v23, s[52:55], s22 offen lds
s_branch xdone_48
xpad_47:
s_mov_b64 exec, 1
buffer_load_dword v255, off, s[44:47], 0
buffer_load_dword v255, off, s[44:47], 0
buffer_load_dword v255, off, s[44:47], 0
buffer_load_dword v255, off, s[44:47], 0
buffer_load_dword v255, off, s[44:47], 0
s_mov_b64 exec, -1
xdone_48:
s_waitcnt vmcnt(8)
s_lshl_b32 s8, s3, 5
s_add_u32 s8, s8, s4
s_lshl_b32 s8, s8, 2
s_add_u32 s8, s8, s5
s_lshl_b32 s8, s8, 2
s_add_u32 s8, s8, 0x1000
s_cmp_lg_u32 s7, 0
s_cbranch_scc1 qfc_49
buffer_store_dword v2, off, s[44:47], s8
qfb_50:
s_waitcnt vmcnt(0)
s_lshl_b32 s8, s5, 8
s_add_u32 s8, s8, s2
v_lshrrev_b32 v252, 2, v1
v_mul_u32_u24 v252, 160, v252
v_and_b32 v254, 3, v1
s_and_b32 s10, s5, 1
s_mul_i32 s10, s10, 5120
s_add_u32 s10, s10, 57344
v_add_u32 v252, s10, v252
v_lshl_add_u32 v253, v254, 3, v252
v_lshl_add_u32 v252, v254, 4, v252
s_lshr_b32 s10, s8, 3
s_mul_i32 s11, s10, 37
s_lshr_b32 s11, s11, 9
s_mul_i32 s11, s11, 14
s_sub_u32 s12, s10, s11
s_mul_i32 s13, s12, 11
s_lshr_b32 s13, s13, 5
s_lshl_b32 s22, s12, 2
s_mul_i32 s13, s13, 11
s_sub_u32 s13, s22, s13
s_add_u32 s13, s13, s11
s_cmp_ge_u32 s12, 12
s_cselect_b32 s10, s10, s13
s_and_b32 s12, s8, 7
s_mul_i32 s12, s12, 56
s_add_u32 s12, s12, s10
s_mul_i32 s12, s12, 5120
s_add_u32 s12, s12, 0x600000
s_cmp_lt_u32 s8, 448
s_cselect_b32 s12, s12, 0x70000000
v_add_u32 v254, s12, v3
ds_read_b64_tr_b16 a[24:25], v252 offset:0
ds_read_b64_tr_b16 a[26:27], v252 offset:2560
ds_read_b64_tr_b16 a[28:29], v252 offset:8
ds_read_b64_tr_b16 a[30:31], v252 offset:2568
ds_read_b64_tr_b16 a[32:33], v252 offset:64
ds_read_b64_tr_b16 a[34:35], v252 offset:2624
ds_read_b64_tr_b16 a[36:37], v252 offset:72
ds_read_b64_tr_b16 a[38:39], v252 offset:2632
ds_read_b64_tr_b16 a[40:41], v253 offset:128
ds_read_b64_tr_b16 a[42:43], v253 offset:2688
s_waitcnt lgkmcnt(8)
buffer_store_dwordx4 a[24:27], v254, s[44:47], 0 offen offset:0 sc1
s_waitcnt lgkmcnt(6)
buffer_store_dwordx4 a[28:31], v254, s[44:47], 0 offen offset:1024 sc1
s_waitcnt lgkmcnt(4)
buffer_store_dwordx4 a[32:35], v254, s[44:47], 0 offen offset:2048 sc1
s_waitcnt lgkmcnt(2)
buffer_store_dwordx4 a[36:39], v254, s[44:47], 0 offen offset:3072 sc1
s_waitcnt lgkmcnt(0)
s_movk_i32 s8, 0x1000
buffer_store_dwordx4 a[40:43], v254, s[44:47], s8 offen sc1
s_barrier
s_add_u32 s8, s5, 0
s_mul_i32 s28, s8, 7168
s_mul_i32 s29, s8, 110592
s_cmp_lt_u32 s8, 10
s_cselect_b32 s8, s24, s25
s_add_u32 s29, s29, s8
s_mov_b32 m0, s28
s_nop 0
buffer_load_dwordx4 v224, s[60:63], s29 offen offset:0 lds
buffer_load_dwordx4 v225, s[60:63], s29 offen offset:1024 lds
buffer_load_dwordx4 v226, s[60:63], s29 offen offset:2048 lds
buffer_load_dwordx4 v227, s[60:63], s29 offen offset:3072 lds
s_add_u32 m0, s28, 4096
s_nop 0
buffer_load_dwordx4 v228, s[60:63], s29 offen offset:0 lds
buffer_load_dwordx4 v229, s[60:63], s29 offen offset:1024 lds
buffer_load_dwordx4 v230, s[60:63], s29 offen offset:2048 lds
s_add_u32 s8, s5, 4
s_mul_i32 s28, s8, 7168
s_mul_i32 s29, s8, 110592
s_cmp_lt_u32 s8, 10
s_cselect_b32 s8, s24, s25
s_add_u32 s29, s29, s8
s_mov_b32 m0, s28
s_nop 0
buffer_load_dwordx4 v224, s[60:63], s29 offen offset:0 lds
buffer_load_dwordx4 v225, s[60:63], s29 offen offset:1024 lds
buffer_load_dwordx4 v226, s[60:63], s29 offen offset:2048 lds
buffer_load_dwordx4 v227, s[60:63], s29 offen offset:3072 lds
s_add_u32 m0, s28, 4096
s_nop 0
buffer_load_dwordx4 v228, s[60:63], s29 offen offset:0 lds
buffer_load_dwordx4 v229, s[60:63], s29 offen offset:1024 lds
buffer_load_dwordx4 v230, s[60:63], s29 offen offset:2048 lds
s_add_u32 s8, s5, 8
s_mul_i32 s28, s8, 7168
s_mul_i32 s29, s8, 110592
s_cmp_lt_u32 s8, 10
s_cselect_b32 s8, s24, s25
s_add_u32 s29, s29, s8
s_mov_b32 m0, s28
s_nop 0
buffer_load_dwordx4 v224, s[60:63], s29 offen offset:0 lds
buffer_load_dwordx4 v225, s[60:63], s29 offen offset:1024 lds
buffer_load_dwordx4 v226, s[60:63], s29 offen offset:2048 lds
buffer_load_dwordx4 v227, s[60:63], s29 offen offset:3072 lds
s_add_u32 m0, s28, 4096
s_nop 0
buffer_load_dwordx4 v228, s[60:63], s29 offen offset:0 lds
buffer_load_dwordx4 v229, s[60:63], s29 offen offset:1024 lds
buffer_load_dwordx4 v230, s[60:63], s29 offen offset:2048 lds
s_add_u32 s8, s5, 12
s_mul_i32 s28, s8, 7168
s_mul_i32 s29, s8, 110592
s_cmp_lt_u32 s8, 10
s_cselect_b32 s8, s24, s25
s_add_u32 s29, s29, s8
s_mov_b32 m0, s28
s_nop 0
buffer_load_dwordx4 v224, s[60:63], s29 offen offset:0 lds
buffer_load_dwordx4 v225, s[60:63], s29 offen offset:1024 lds
buffer_load_dwordx4 v226, s[60:63], s29 offen offset:2048 lds
buffer_load_dwordx4 v227, s[60:63], s29 offen offset:3072 lds
s_add_u32 m0, s28, 4096
s_nop 0
buffer_load_dwordx4 v228, s[60:63], s29 offen offset:0 lds
buffer_load_dwordx4 v229, s[60:63], s29 offen offset:1024 lds
buffer_load_dwordx4 v230, s[60:63], s29 offen offset:2048 lds
s_add_u32 s8, s5, 16
s_mul_i32 s28, s8, 7168
s_mul_i32 s29, s8, 110592
s_cmp_lt_u32 s8, 10
s_cselect_b32 s8, s24, s25
s_add_u32 s29, s29, s8
s_mov_b32 m0, s28
s_nop 0
buffer_load_dwordx4 v224, s[60:63], s29 offen offset:0 lds
buffer_load_dwordx4 v225, s[60:63], s29 offen offset:1024 lds
buffer_load_dwordx4 v226, s[60:63], s29 offen offset:2048 lds
buffer_load_dwordx4 v227, s[60:63], s29 offen offset:3072 lds
s_add_u32 m0, s28, 4096
s_nop 0
buffer_load_dwordx4 v228, s[60:63], s29 offen offset:0 lds
buffer_load_dwordx4 v229, s[60:63], s29 offen offset:1024 lds
buffer_load_dwordx4 v230, s[60:63], s29 offen offset:2048 lds
s_waitcnt vmcnt(35)
s_lshl_b32 s8, s5, 8
s_add_u32 s8, s8, s2
s_cmp_ge_u32 s8, 448
s_cbranch_scc1 nopf_51
s_and_b32 s9, s8, 7
s_lshr_b32 s10, s8, 3
s_lshl_b32 s9, s9, 6
s_add_u32 s9, s9, s10
s_lshl_b32 s9, s9, 2
s_add_u32 s9, s9, 0x3000
s_mov_b64 exec, 1
buffer_store_dword v2, off, s[44:47], s9 sc1
s_mov_b64 exec, -1
nopf_51:
s_mov_b32 s100, 0x70000000
s_mov_b64 s[22:23], 1
v_min_u32 v22, 55, v1
v_lshlrev_b32 v22, 2, v22
s_lshl_b32 s10, s67, 8
s_add_u32 s12, s10, 0x3000
v_min_u32 v12, 39, v1
v_lshlrev_b32 v12, 4, v12
s_lshl_b32 s30, s3, 10
s_add_u32 s30, s30, 0x4000
s_lshr_b32 s10, 0xe4, s3
s_bitcmp1_b32 s10, 0
s_cselect_b32 s31, 0, 7168
s_cselect_b32 s11, 80, 0
s_add_u32 s31, s31, 0x4000
v_lshrrev_b32 v26, 5, v1
v_lshlrev_b32 v26, 7, v26
v_and_b32 v27, 31, v1
v_add_u32 v26, v26, v27
v_mul_u32_u24 v26, 224, v26
s_mul_i32 s11, s5, 7168
s_add_u32 s11, s11, 216
v_add_u32 v24, s11, v26
v_add_u32 v7, 0x1c000, v24
v_mov_b32 v25, 0x3f80
v_lshlrev_b32 v220, 16, v250
v_mul_f32 v220, 0x3eeff558, v220
v_lshrrev_b32 v20, 4, v1
v_lshlrev_b32 v20, 4, v20
s_mul_i32 s10, s5, 448
s_add_u32 s10, s10, 160000
v_add_u32 v20, s10, v20
v_and_b32 v21, 127, v0
v_lshlrev_b32 v222, 2, v21
v_add_u32 v222, 160000, v222
s_lshr_b32 s10, s5, 1
s_mul_i32 s10, s10, 112
v_add_u32 v221, s10, v21
v_mul_u32_u24 v221, 224, v221
v_mov_b32 v26, 162048
v_cmp_gt_u32 vcc, 112, v21
s_nop 1
v_cndmask_b32 v221, v26, v221, vcc
s_cmp_lt_u32 s5, 2
s_cselect_b64 s[68:69], -1, 0
s_mov_b64 s[0:1], s[22:23]
v_lshlrev_b32 v223, 2, v1
s_mul_i32 s32, s67, 56
s_mul_i32 s10, s5, 14
s_add_u32 s32, s32, s10
s_mul_i32 s32, s32, 5120
s_add_u32 s32, s32, 0x600000
s_mov_b32 s48, 0x100001
s_mov_b32 s49, 0x10000100
s_mov_b32 s50, 0x200002
s_mov_b32 s51, 0x20000200
s_mov_b32 s52, 0x400004
s_mov_b32 s53, 0x40000400
s_mov_b32 s54, 0x800008
s_mov_b32 s55, 0x80000800
s_mov_b32 s56, 0x3eeff558
s_mov_b32 s57, 0x3eeff558
s_mov_b32 s58, -1
s_mov_b32 s59, 0xffff
s_add_u32 s10, s5, s67
s_and_b32 s10, s10, 1
s_lshl_b32 s10, s10, 3
v_and_b32 v16, 15, v1
v_lshlrev_b32 v16, 4, v16
v_lshrrev_b32 v17, 4, v1
v_lshl_add_u32 v28, v17, 9, v16
v_lshrrev_b32 v18, 5, v1
v_lshlrev_b32 v18, 3, v18
v_xor_b32 v18, s10, v18
v_add_u32 v28, v28, v18
s_add_u32 s10, s10, 4096
v_add_u32 v29, s10, v3
s_not_b32 s10, s6
s_cmp_eq_u32 s7, 0
s_cselect_b32 s99, s6, s10
v_mov_b32 v18, v12
v_mov_b32 v19, v12
s_add_u32 s101, s30, 0x14000
s_add_u32 s31, s31, 0x14000
s_lshl_b32 s10, s64, 1
s_add_u32 s10, s10, s66
s_lshl_b32 s10, s10, 1
s_lshr_b32 s11, s5, 1
s_add_u32 s10, s10, s11
s_mul_i32 s10, s10, 160
s_mul_i32 s11, s67, 20
s_add_u32 s10, s10, s11
s_lshl_b32 s25, s10, 8
s_mov_b32 s15, 0
s_lshl_b32 s10, s64, 2
s_add_u32 s10, s10, s5
s_mul_i32 s16, s10, 40960
s_add_u32 s16, s16, 0xac0000
s_and_b32 s10, s64, 1
s_mul_i32 s10, s10, 20480
s_sub_u32 s24, s16, s10
s_add_u32 s16, s16, s10
s_lshl_b32 s19, s64, 10
s_add_u32 s19, s19, 0x6000
s_mov_b32 s18, 0x1240000
s_waitcnt vmcnt(0)
s_mul_i32 s8, s5, 7168
v_lshrrev_b32 v4, 2, v1
v_mul_u32_u24 v4, 224, v4
v_and_b32 v5, 3, v1
v_lshl_add_u32 v4, v5, 3, v4
v_add_u32 v4, s8, v4
v_add_u32 v5, 0x15000, v4
v_mov_b32 v80, 0x3f803f80
v_mov_b32 v81, 0x3f803f80
v_mov_b32 v82, 0x3f803f80
v_mov_b32 v83, 0x3f803f80
ds_read_b64_tr_b16 v[96:97], v4 offset:0
ds_read_b64_tr_b16 v[98:99], v4 offset:3584
ds_read_b64_tr_b16 v[100:101], v4 offset:32
ds_read_b64_tr_b16 v[102:103], v4 offset:3616
ds_read_b64_tr_b16 v[104:105], v4 offset:64
ds_read_b64_tr_b16 v[106:107], v4 offset:3648
ds_read_b64_tr_b16 v[108:109], v4 offset:96
ds_read_b64_tr_b16 v[110:111], v4 offset:3680
ds_read_b64_tr_b16 v[112:113], v4 offset:128
ds_read_b64_tr_b16 v[114:115], v4 offset:3712
ds_read_b64_tr_b16 v[116:117], v4 offset:160
ds_read_b64_tr_b16 v[118:119], v4 offset:3744
ds_read_b64_tr_b16 v[120:121], v4 offset:192
ds_read_b64_tr_b16 v[122:123], v4 offset:3776
s_waitcnt lgkmcnt(12)
v_mfma_f32_16x16x32_bf16 v[32:35], v[96:99], v[80:83], 0
ds_read_b64_tr_b16 v[124:125], v4 offset:28672
ds_read_b64_tr_b16 v[126:127], v4 offset:32256
s_waitcnt lgkmcnt(12)
v_mfma_f32_16x16x32_bf16 v[36:39], v[100:103], v[80:83], 0
ds_read_b64_tr_b16 v[128:129], v4 offset:28704
ds_read_b64_tr_b16 v[130:131], v4 offset:32288
s_waitcnt lgkmcnt(12)
v_mfma_f32_16x16x32_bf16 v[40:43], v[104:107], v[80:83], 0
ds_read_b64_tr_b16 v[132:133], v4 offset:28736
ds_read_b64_tr_b16 v[134:135], v4 offset:32320
s_waitcnt lgkmcnt(12)
v_mfma_f32_16x16x32_bf16 v[44:47], v[108:111], v[80:83], 0
ds_read_b64_tr_b16 v[136:137], v4 offset:28768
ds_read_b64_tr_b16 v[138:139], v4 offset:32352
s_waitcnt lgkmcnt(12)
v_mfma_f32_16x16x32_bf16 v[48:51], v[112:115], v[80:83], 0
ds_read_b64_tr_b16 v[140:141], v4 offset:28800
ds_read_b64_tr_b16 v[142:143], v4 offset:32384
s_waitcnt lgkmcnt(12)
v_mfma_f32_16x16x32_bf16 v[52:55], v[116:119], v[80:83], 0
ds_read_b64_tr_b16 v[144:145], v4 offset:28832
ds_read_b64_tr_b16 v[146:147], v4 offset:32416
s_waitcnt lgkmcnt(12)
v_mfma_f32_16x16x32_bf16 v[56:59], v[120:123], v[80:83], 0
ds_read_b64_tr_b16 v[148:149], v4 offset:28864
ds_read_b64_tr_b16 v[150:151], v4 offset:32448
s_waitcnt lgkmcnt(12)
v_mfma_f32_16x16x32_bf16 v[32:35], v[124:127], v[80:83], v[32:35]
s_waitcnt lgkmcnt(10)
v_mfma_f32_16x16x32_bf16 v[36:39], v[128:131], v[80:83], v[36:39]
s_waitcnt lgkmcnt(8)
v_mfma_f32_16x16x32_bf16 v[40:43], v[132:135], v[80:83], v[40:43]
s_waitcnt lgkmcnt(6)
v_mfma_f32_16x16x32_bf16 v[44:47], v[136:139], v[80:83], v[44:47]
s_waitcnt lgkmcnt(4)
v_mfma_f32_16x16x32_bf16 v[48:51], v[140:143], v[80:83], v[48:51]
s_waitcnt lgkmcnt(2)
v_mfma_f32_16x16x32_bf16 v[52:55], v[144:147], v[80:83], v[52:55]
s_waitcnt lgkmcnt(0)
v_mfma_f32_16x16x32_bf16 v[56:59], v[148:151], v[80:83], v[56:59]
L_convdone:
s_waitcnt vmcnt(16)
ds_read_b64_tr_b16 v[96:97], v4 offset:57344
ds_read_b64_tr_b16 v[98:99], v4 offset:60928
ds_read_b64_tr_b16 v[100:101], v4 offset:57376
ds_read_b64_tr_b16 v[102:103], v4 offset:60960
ds_read_b64_tr_b16 v[104:105], v4 offset:57408
ds_read_b64_tr_b16 v[106:107], v4 offset:60992
ds_read_b64_tr_b16 v[108:109], v4 offset:57440
ds_read_b64_tr_b16 v[110:111], v4 offset:61024
ds_read_b64_tr_b16 v[112:113], v4 offset:57472
ds_read_b64_tr_b16 v[114:115], v4 offset:61056
ds_read_b64_tr_b16 v[116:117], v4 offset:57504
ds_read_b64_tr_b16 v[118:119], v4 offset:61088
ds_read_b64_tr_b16 v[120:121], v4 offset:57536
ds_read_b64_tr_b16 v[122:123], v4 offset:61120
s_waitcnt lgkmcnt(12)
v_mfma_f32_16x16x32_bf16 v[32:35], v[96:99], v[80:83], v[32:35]
s_waitcnt lgkmcnt(10)
v_mfma_f32_16x16x32_bf16 v[36:39], v[100:103], v[80:83], v[36:39]
s_waitcnt lgkmcnt(8)
v_mfma_f32_16x16x32_bf16 v[40:43], v[104:107], v[80:83], v[40:43]
s_waitcnt lgkmcnt(6)
v_mfma_f32_16x16x32_bf16 v[44:47], v[108:111], v[80:83], v[44:47]
s_waitcnt vmcnt(9)
ds_read_b64_tr_b16 v[124:125], v5 offset:0
ds_read_b64_tr_b16 v[126:127], v5 offset:3584
ds_read_b64_tr_b16 v[128:129], v5 offset:32
ds_read_b64_tr_b16 v[130:131], v5 offset:3616
ds_read_b64_tr_b16 v[132:133], v5 offset:64
ds_read_b64_tr_b16 v[134:135], v5 offset:3648
s_waitcnt lgkmcnt(10)
v_mfma_f32_16x16x32_bf16 v[48:51], v[112:115], v[80:83], v[48:51]
s_waitcnt lgkmcnt(8)
v_mfma_f32_16x16x32_bf16 v[52:55], v[116:119], v[80:83], v[52:55]
s_waitcnt lgkmcnt(6)
v_mfma_f32_16x16x32_bf16 v[56:59], v[120:123], v[80:83], v[56:59]
ds_read_b64_tr_b16 v[136:137], v5 offset:96
ds_read_b64_tr_b16 v[138:139], v5 offset:3680
ds_read_b64_tr_b16 v[140:141], v5 offset:128
ds_read_b64_tr_b16 v[142:143], v5 offset:3712
ds_read_b64_tr_b16 v[144:145], v5 offset:160
ds_read_b64_tr_b16 v[146:147], v5 offset:3744
ds_read_b64_tr_b16 v[148:149], v5 offset:192
ds_read_b64_tr_b16 v[150:151], v5 offset:3776
s_waitcnt lgkmcnt(12)
v_mfma_f32_16x16x32_bf16 v[32:35], v[124:127], v[80:83], v[32:35]
s_waitcnt lgkmcnt(10)
v_mfma_f32_16x16x32_bf16 v[36:39], v[128:131], v[80:83], v[36:39]
s_waitcnt lgkmcnt(8)
v_mfma_f32_16x16x32_bf16 v[40:43], v[132:135], v[80:83], v[40:43]
s_waitcnt lgkmcnt(6)
v_mfma_f32_16x16x32_bf16 v[44:47], v[136:139], v[80:83], v[44:47]
s_waitcnt vmcnt(2)
ds_read_b64_tr_b16 v[96:97], v5 offset:28672
ds_read_b64_tr_b16 v[98:99], v5 offset:32256
ds_read_b64_tr_b16 v[100:101], v5 offset:28704
ds_read_b64_tr_b16 v[102:103], v5 offset:32288
ds_read_b64_tr_b16 v[104:105], v5 offset:28736
ds_read_b64_tr_b16 v[106:107], v5 offset:32320
s_waitcnt lgkmcnt(10)
v_mfma_f32_16x16x32_bf16 v[48:51], v[140:143], v[80:83], v[48:51]
s_waitcnt lgkmcnt(8)
v_mfma_f32_16x16x32_bf16 v[52:55], v[144:147], v[80:83], v[52:55]
s_waitcnt lgkmcnt(6)
v_mfma_f32_16x16x32_bf16 v[56:59], v[148:151], v[80:83], v[56:59]
ds_read_b64_tr_b16 v[108:109], v5 offset:28768
ds_read_b64_tr_b16 v[110:111], v5 offset:32352
ds_read_b64_tr_b16 v[112:113], v5 offset:28800
ds_read_b64_tr_b16 v[114:115], v5 offset:32384
ds_read_b64_tr_b16 v[116:117], v5 offset:28832
ds_read_b64_tr_b16 v[118:119], v5 offset:32416
ds_read_b64_tr_b16 v[120:121], v5 offset:28864
ds_read_b64_tr_b16 v[122:123], v5 offset:32448
s_waitcnt lgkmcnt(12)
v_mfma_f32_16x16x32_bf16 v[32:35], v[96:99], v[80:83], v[32:35]
s_waitcnt lgkmcnt(10)
v_mfma_f32_16x16x32_bf16 v[36:39], v[100:103], v[80:83], v[36:39]
s_waitcnt lgkmcnt(8)
v_mfma_f32_16x16x32_bf16 v[40:43], v[104:107], v[80:83], v[40:43]
s_waitcnt lgkmcnt(6)
v_mfma_f32_16x16x32_bf16 v[44:47], v[108:111], v[80:83], v[44:47]
s_waitcnt lgkmcnt(4)
v_mfma_f32_16x16x32_bf16 v[48:51], v[112:115], v[80:83], v[48:51]
s_waitcnt lgkmcnt(2)
v_mfma_f32_16x16x32_bf16 v[52:55], v[116:119], v[80:83], v[52:55]
s_waitcnt lgkmcnt(0)
v_mfma_f32_16x16x32_bf16 v[56:59], v[120:123], v[80:83], v[56:59]
s_cmp_lg_u32 s5, 3
s_cbranch_scc1 c1s_52
buffer_load_dwordx4 v[60:63], v12, s[44:47], s30 offen sc1
buffer_load_dword v23, v22, s[44:47], s12 offen sc1
c1s_52:
ds_write_b32 v24, v25
ds_write_b32 v24, v25 offset:57344
s_mov_b32 exec_lo, 0xffffffff
s_mov_b32 exec_hi, 0x0
ds_write_b32 v7, v25
s_mov_b32 exec_lo, 0x10001
s_mov_b32 exec_hi, 0x10001
ds_write_b128 v20, v[32:35] offset:0
ds_write_b128 v20, v[36:39] offset:64
ds_write_b128 v20, v[40:43] offset:128
ds_write_b128 v20, v[44:47] offset:192
ds_write_b128 v20, v[48:51] offset:256
ds_write_b128 v20, v[52:55] offset:320
ds_write_b128 v20, v[56:59] offset:384
s_mov_b64 exec, -1
v_lshrrev_b32 v4, 2, v1
v_mul_u32_u24 v4, 224, v4
v_and_b32 v5, 3, v1
v_lshl_add_u32 v4, v5, 3, v4
v_lshrrev_b32 v5, 4, v1
v_mul_u32_u24 v5, 896, v5
s_cmp_lg_u32 s5, 3
s_cbranch_scc1 c1b_54
s_waitcnt vmcnt(0)
v_min3_u32 v6, v60, v61, v62
v_max3_u32 v26, v60, v61, v62
v_min3_u32 v6, v6, v63, v23
v_max3_u32 v26, v26, v63, v23
v_xor_b32 v6, s99, v6
v_xor_b32 v26, s99, v26
v_or_b32 v6, v6, v26
v_cmp_ne_u32 vcc, 0, v6
s_nop 3
s_cbranch_vccnz c1c_53
c1b_54:
s_waitcnt lgkmcnt(0)
s_barrier
ds_read_b64_tr_b16 v[96:97], v4 offset:0
ds_read_b64_tr_b16 v[98:99], v4 offset:3584
ds_read_b64_tr_b16 v[100:101], v4 offset:32
ds_read_b64_tr_b16 v[102:103], v4 offset:3616
ds_read_b64_tr_b16 v[104:105], v4 offset:64
ds_read_b64_tr_b16 v[106:107], v4 offset:3648
ds_read_b64_tr_b16 v[108:109], v4 offset:96
ds_read_b64_tr_b16 v[110:111], v4 offset:3680
ds_read_b64_tr_b16 v[112:113], v4 offset:128
ds_read_b64_tr_b16 v[114:115], v4 offset:3712
ds_read_b64_tr_b16 v[116:117], v4 offset:160
ds_read_b64_tr_b16 v[118:119], v4 offset:3744
ds_read_b64_tr_b16 v[120:121], v4 offset:192
ds_read_b64_tr_b16 v[122:123], v4 offset:3776
L_G1:
s_add_u32 s17, s16, 0
buffer_load_dwordx4 v[152:155], v3, s[44:47], s17 offen offset:0 sc1
buffer_load_dwordx4 v[156:159], v3, s[44:47], s17 offen offset:1024 sc1
buffer_load_dwordx4 v[160:163], v3, s[44:47], s17 offen offset:2048 sc1
buffer_load_dwordx4 v[164:167], v3, s[44:47], s17 offen offset:3072 sc1
s_add_u32 s17, s16, 4096
buffer_load_dwordx4 v[168:171], v3, s[44:47], s17 offen offset:0 sc1
buffer_load_dwordx4 v[172:175], v3, s[44:47], s17 offen offset:1024 sc1
buffer_load_dwordx4 v[176:179], v3, s[44:47], s17 offen offset:2048 sc1
buffer_load_dwordx4 v[180:183], v3, s[44:47], s17 offen offset:3072 sc1
s_add_u32 s17, s16, 8192
buffer_load_dwordx4 v[184:187], v3, s[44:47], s17 offen offset:0 sc1
buffer_load_dwordx4 v[188:191], v3, s[44:47], s17 offen offset:1024 sc1
buffer_load_dwordx4 v[192:195], v3, s[44:47], s17 offen offset:2048 sc1
buffer_load_dwordx4 v[196:199], v3, s[44:47], s17 offen offset:3072 sc1
s_lshl_b32 s8, s64, 2
s_add_u32 s8, s8, s5
s_and_b32 s9, s8, 7
s_lshl_b32 s9, s9, 3
s_lshr_b32 s10, s65, 2
s_add_u32 s9, s9, s10
s_mul_i32 s9, s9, 40
s_mul_i32 s10, s3, 5
s_add_u32 s9, s9, s10
s_and_b32 s10, s65, 3
s_add_u32 s9, s9, s10
s_lshl_b32 s9, s9, 10
s_add_u32 s40, s9, 0xfc0000
s_add_u32 s41, s40, 163840
s_lshl_b32 s8, s8, 3
s_lshr_b32 s9, s65, 2
s_add_u32 s8, s8, s9
s_mul_i32 s8, s8, 5120
s_add_u32 s8, s8, 0x100000
s_and_b32 s9, s65, 3
s_lshl_b32 s10, s9, 10
s_add_u32 s26, s8, s10
s_add_u32 s27, s26, 20480
s_sub_u32 s28, s40, s10
s_sub_u32 s29, s41, s10
s_add_u32 s10, s8, 20480
s_bitcmp1_b32 s9, 1
s_cselect_b32 s28, s28, s8
s_cselect_b32 s29, s29, s10
s_and_b32 s9, s9, 1
s_lshl_b32 s9, s9, 3
s_add_u32 s9, s9, 4096
s_add_u32 s28, s28, s9
s_add_u32 s29, s29, s9
s_lshl_b32 s8, s65, 2
s_add_u32 s8, s8, s5
s_lshl_b32 s8, s8, 2
s_add_u32 s13, s8, s19
s_lshl_b32 s8, s5, 6
s_lshl_b32 s9, s66, 3
s_add_u32 s8, s8, s9
s_add_u32 s12, s8, s19
s_lshl_b32 s8, s64, 1
s_add_u32 s8, s8, s66
s_lshl_b32 s8, s8, 2
s_mul_i32 s9, s5, 5
s_add_u32 s10, s5, 0
s_and_b32 s10, s10, 3
s_add_u32 s10, s10, s8
s_and_b32 s11, s10, 15
s_lshl_b32 s11, s11, 2
s_add_u32 s11, s11, s5
s_lshl_b32 s11, s11, 3
s_add_u32 s11, s11, s3
s_mul_i32 s11, s11, 5120
s_add_u32 s42, s11, 0xfc0000
s_mul_i32 s10, s10, 20
s_add_u32 s10, s10, s9
s_lshl_b32 s10, s10, 10
s_add_u32 s20, s10, 0x100000
s_add_u32 s10, s5, 1
s_and_b32 s10, s10, 3
s_add_u32 s10, s10, s8
s_and_b32 s11, s10, 15
s_lshl_b32 s11, s11, 2
s_add_u32 s11, s11, s5
s_lshl_b32 s11, s11, 3
s_add_u32 s11, s11, s3
s_mul_i32 s11, s11, 5120
s_add_u32 s43, s11, 0xfc0000
s_mul_i32 s10, s10, 20
s_add_u32 s10, s10, s9
s_lshl_b32 s10, s10, 10
s_add_u32 s21, s10, 0x100000
s_add_u32 s10, s5, 2
s_and_b32 s10, s10, 3
s_add_u32 s10, s10, s8
s_and_b32 s11, s10, 15
s_lshl_b32 s11, s11, 2
s_add_u32 s11, s11, s5
s_lshl_b32 s11, s11, 3
s_add_u32 s11, s11, s3
s_mul_i32 s11, s11, 5120
s_add_u32 s96, s11, 0xfc0000
s_mul_i32 s10, s10, 20
s_add_u32 s10, s10, s9
s_lshl_b32 s10, s10, 10
s_add_u32 s22, s10, 0x100000
s_add_u32 s10, s5, 3
s_and_b32 s10, s10, 3
s_add_u32 s10, s10, s8
s_and_b32 s11, s10, 15
s_lshl_b32 s11, s11, 2
s_add_u32 s11, s11, s5
s_lshl_b32 s11, s11, 3
s_add_u32 s11, s11, s3
s_mul_i32 s11, s11, 5120
s_add_u32 s97, s11, 0xfc0000
s_mul_i32 s10, s10, 20
s_add_u32 s10, s10, s9
s_lshl_b32 s10, s10, 10
s_add_u32 s23, s10, 0x100000
v_bfe_u32 v31, v1, 1, 2
v_lshlrev_b32 v31, 4, v31
v_and_b32 v6, 1, v1
v_lshl_add_u32 v31, v6, 2, v31
s_mov_b32 s60, s36
s_mov_b32 s61, s37
s_mov_b32 s62, 0x500
s_mov_b32 s63, 0x20000
s_mul_i32 s30, s67, 160
s_waitcnt vmcnt(10) lgkmcnt(0)
v_mfma_f32_16x16x32_bf16 v[60:63], v[96:99], v[154:157], 0
ds_read_b64_tr_b16 v[124:125], v4 offset:7168
ds_read_b64_tr_b16 v[126:127], v4 offset:10752
v_mfma_f32_16x16x32_bf16 v[64:67], v[100:103], v[154:157], 0
ds_read_b64_tr_b16 v[128:129], v4 offset:7200
ds_read_b64_tr_b16 v[130:131], v4 offset:10784
v_mfma_f32_16x16x32_bf16 v[68:71], v[104:107], v[154:157], 0
s_add_u32 s17, s16, 12288
ds_read_b64_tr_b16 v[132:133], v4 offset:7232
v_mfma_f32_16x16x32_bf16 v[72:75], v[108:111], v[154:157], 0
buffer_load_dwordx4 v[200:203], v3, s[44:47], s17 offen offset:0 sc1
ds_read_b64_tr_b16 v[134:135], v4 offset:10816
v_mfma_f32_16x16x32_bf16 v[76:79], v[112:115], v[154:157], 0
ds_read_b64_tr_b16 v[136:137], v4 offset:7264
ds_read_b64_tr_b16 v[138:139], v4 offset:10848
v_mfma_f32_16x16x32_bf16 v[80:83], v[116:119], v[154:157], 0
buffer_load_dwordx4 v[204:207], v3, s[44:47], s17 offen offset:1024 sc1
ds_read_b64_tr_b16 v[140:141], v4 offset:7296
v_mfma_f32_16x16x32_bf16 v[84:87], v[120:123], v[154:157], 0
v_mov_b64 v[26:27], v[158:159]
v_mov_b64 v[24:25], v[152:153]
v_mfma_f32_16x16x32_bf16 v[92:95], v[154:157], v[154:157], 0
buffer_load_dwordx4 v[208:211], v3, s[44:47], s17 offen offset:2048 sc1
ds_read_b64_tr_b16 v[142:143], v4 offset:10880
v_mfma_f32_16x16x32_bf16 v[32:35], v[96:99], v[24:27], 0
ds_read_b64_tr_b16 v[144:145], v4 offset:7328
ds_read_b64_tr_b16 v[146:147], v4 offset:10912
v_mfma_f32_16x16x32_bf16 v[36:39], v[100:103], v[24:27], 0
buffer_load_dwordx4 v[212:215], v3, s[44:47], s17 offen offset:3072 sc1
ds_read_b64_tr_b16 v[148:149], v4 offset:7360
v_mfma_f32_16x16x32_bf16 v[40:43], v[104:107], v[24:27], 0
s_add_u32 s33, s32, 0
ds_read_b64_tr_b16 v[150:151], v4 offset:10944
v_mfma_f32_16x16x32_bf16 v[44:47], v[108:111], v[24:27], 0
buffer_load_dwordx4 a[0:3], v3, s[44:47], s33 offen offset:0
ds_read_b32 v216, v222 offset:0
v_mfma_f32_16x16x32_bf16 v[48:51], v[112:115], v[24:27], 0
ds_read_b32 v217, v222 offset:448
ds_read_b32 v218, v222 offset:896
v_mfma_f32_16x16x32_bf16 v[52:55], v[116:119], v[24:27], 0
buffer_load_dwordx4 a[4:7], v3, s[44:47], s33 offen offset:1024
ds_read_b32 v219, v222 offset:1344
v_mfma_f32_16x16x32_bf16 v[56:59], v[120:123], v[24:27], 0
v_mfma_f32_16x16x32_bf16 v[88:91], v[24:27], v[24:27], 0
buffer_load_dwordx4 a[8:11], v3, s[44:47], s33 offen offset:2048
s_waitcnt vmcnt(15) lgkmcnt(4)
v_mfma_f32_16x16x32_bf16 v[60:63], v[124:127], v[162:165], v[60:63]
ds_read_b64_tr_b16 v[96:97], v4 offset:14336
ds_read_b64_tr_b16 v[98:99], v4 offset:17920
v_mfma_f32_16x16x32_bf16 v[64:67], v[128:131], v[162:165], v[64:67]
ds_read_b64_tr_b16 v[100:101], v4 offset:14368
ds_read_b64_tr_b16 v[102:103], v4 offset:17952
v_mfma_f32_16x16x32_bf16 v[68:71], v[132:135], v[162:165], v[68:71]
ds_read_b64_tr_b16 v[104:105], v4 offset:14400
ds_read_b64_tr_b16 v[106:107], v4 offset:17984
v_mfma_f32_16x16x32_bf16 v[72:75], v[136:139], v[162:165], v[72:75]
ds_read_b64_tr_b16 v[108:109], v4 offset:14432
ds_read_b64_tr_b16 v[110:111], v4 offset:18016
v_mfma_f32_16x16x32_bf16 v[76:79], v[140:143], v[162:165], v[76:79]
s_add_u32 s17, s16, 16384
ds_read_b64_tr_b16 v[112:113], v4 offset:14464
v_mfma_f32_16x16x32_bf16 v[80:83], v[144:147], v[162:165], v[80:83]
buffer_load_dwordx4 v[152:155], v3, s[44:47], s17 offen offset:0 sc1
ds_read_b64_tr_b16 v[114:115], v4 offset:18048
v_mfma_f32_16x16x32_bf16 v[84:87], v[148:151], v[162:165], v[84:87]
v_mov_b64 v[26:27], v[166:167]
v_mov_b64 v[24:25], v[160:161]
v_mfma_f32_16x16x32_bf16 v[92:95], v[162:165], v[162:165], v[92:95]
buffer_load_dwordx4 v[156:159], v3, s[44:47], s17 offen offset:1024 sc1
ds_read_b64_tr_b16 v[116:117], v4 offset:14496
v_mfma_f32_16x16x32_bf16 v[32:35], v[124:127], v[24:27], v[32:35]
s_add_u32 s33, s32, 3072
ds_read_b64_tr_b16 v[118:119], v4 offset:18080
v_mfma_f32_16x16x32_bf16 v[36:39], v[128:131], v[24:27], v[36:39]
buffer_load_dwordx4 a[12:15], v3, s[44:47], s33 offen offset:0
ds_read_b64_tr_b16 v[120:121], v4 offset:14528
v_mfma_f32_16x16x32_bf16 v[40:43], v[132:135], v[24:27], v[40:43]
ds_read_b64_tr_b16 v[122:123], v4 offset:18112
s_waitcnt lgkmcnt(14)
v_add_f32 v216, v216, v217
v_mfma_f32_16x16x32_bf16 v[44:47], v[136:139], v[24:27], v[44:47]
buffer_load_dwordx4 a[16:19], v3, s[44:47], s33 offen offset:1024
v_add_f32 v218, v218, v219
v_mfma_f32_16x16x32_bf16 v[48:51], v[140:143], v[24:27], v[48:51]
v_add_f32 v216, v216, v218
v_cndmask_b32 v216, v220, v216, s[68:69]
v_mfma_f32_16x16x32_bf16 v[52:55], v[144:147], v[24:27], v[52:55]
buffer_load_dwordx4 a[20:23], v3, s[44:47], s33 offen offset:2048
ds_write_b32 v221, v216 offset:220
v_mfma_f32_16x16x32_bf16 v[56:59], v[148:151], v[24:27], v[56:59]
v_mfma_f32_16x16x32_bf16 v[88:91], v[24:27], v[24:27], v[88:91]
s_mov_b64 exec, s[0:1]
buffer_store_dword v2, v223, s[44:47], s100 offen sc1
s_mov_b64 exec, -1
s_waitcnt vmcnt(19) lgkmcnt(1)
v_mfma_f32_16x16x32_bf16 v[60:63], v[96:99], v[170:173], v[60:63]
ds_read_b64_tr_b16 v[124:125], v4 offset:21504
ds_read_b64_tr_b16 v[126:127], v4 offset:25088
v_mfma_f32_16x16x32_bf16 v[64:67], v[100:103], v[170:173], v[64:67]
ds_read_b64_tr_b16 v[128:129], v4 offset:21536
ds_read_b64_tr_b16 v[130:131], v4 offset:25120
v_mfma_f32_16x16x32_bf16 v[68:71], v[104:107], v[170:173], v[68:71]
ds_read_b64_tr_b16 v[132:133], v4 offset:21568
ds_read_b64_tr_b16 v[134:135], v4 offset:25152
v_mfma_f32_16x16x32_bf16 v[72:75], v[108:111], v[170:173], v[72:75]
ds_read_b64_tr_b16 v[136:137], v4 offset:21600
ds_read_b64_tr_b16 v[138:139], v4 offset:25184
v_mfma_f32_16x16x32_bf16 v[76:79], v[112:115], v[170:173], v[76:79]
ds_read_b64_tr_b16 v[140:141], v4 offset:21632
ds_read_b64_tr_b16 v[142:143], v4 offset:25216
v_mfma_f32_16x16x32_bf16 v[80:83], v[116:119], v[170:173], v[80:83]
ds_read_b64_tr_b16 v[144:145], v4 offset:21664
ds_read_b64_tr_b16 v[146:147], v4 offset:25248
v_mfma_f32_16x16x32_bf16 v[84:87], v[120:123], v[170:173], v[84:87]
v_mov_b64 v[26:27], v[174:175]
v_mov_b64 v[24:25], v[168:169]
v_mfma_f32_16x16x32_bf16 v[92:95], v[170:173], v[170:173], v[92:95]
buffer_load_dwordx4 v[160:163], v3, s[44:47], s17 offen offset:2048 sc1
ds_read_b64_tr_b16 v[148:149], v4 offset:21696
v_mfma_f32_16x16x32_bf16 v[32:35], v[96:99], v[24:27], v[32:35]
ds_read_b64_tr_b16 v[150:151], v4 offset:25280
v_mfma_f32_16x16x32_bf16 v[36:39], v[100:103], v[24:27], v[36:39]
buffer_load_dwordx4 v[164:167], v3, s[44:47], s17 offen offset:3072 sc1
v_mfma_f32_16x16x32_bf16 v[40:43], v[104:107], v[24:27], v[40:43]
s_add_u32 s33, s32, 6144
v_mfma_f32_16x16x32_bf16 v[44:47], v[108:111], v[24:27], v[44:47]
buffer_load_dwordx4 a[24:27], v3, s[44:47], s33 offen offset:0
v_mfma_f32_16x16x32_bf16 v[48:51], v[112:115], v[24:27], v[48:51]
v_mfma_f32_16x16x32_bf16 v[52:55], v[116:119], v[24:27], v[52:55]
buffer_load_dwordx4 a[28:31], v3, s[44:47], s33 offen offset:1024
v_mfma_f32_16x16x32_bf16 v[56:59], v[120:123], v[24:27], v[56:59]
v_mfma_f32_16x16x32_bf16 v[88:91], v[24:27], v[24:27], v[88:91]
buffer_load_dwordx4 a[32:35], v3, s[44:47], s33 offen offset:2048
s_waitcnt vmcnt(22) lgkmcnt(0)
v_mfma_f32_16x16x32_bf16 v[60:63], v[124:127], v[178:181], v[60:63]
ds_read_b64_tr_b16 v[96:97], v4 offset:28672
ds_read_b64_tr_b16 v[98:99], v4 offset:32256
v_mfma_f32_16x16x32_bf16 v[64:67], v[128:131], v[178:181], v[64:67]
ds_read_b64_tr_b16 v[100:101], v4 offset:28704
ds_read_b64_tr_b16 v[102:103], v4 offset:32288
v_mfma_f32_16x16x32_bf16 v[68:71], v[132:135], v[178:181], v[68:71]
ds_read_b64_tr_b16 v[104:105], v4 offset:28736
ds_read_b64_tr_b16 v[106:107], v4 offset:32320
v_mfma_f32_16x16x32_bf16 v[72:75], v[136:139], v[178:181], v[72:75]
ds_read_b64_tr_b16 v[108:109], v4 offset:28768
ds_read_b64_tr_b16 v[110:111], v4 offset:32352
v_mfma_f32_16x16x32_bf16 v[76:79], v[140:143], v[178:181], v[76:79]
ds_read_b64_tr_b16 v[112:113], v4 offset:28800
ds_read_b64_tr_b16 v[114:115], v4 offset:32384
v_mfma_f32_16x16x32_bf16 v[80:83], v[144:147], v[178:181], v[80:83]
v_mov_b64 v[24:25], v[176:177]
ds_read_b64_tr_b16 v[116:117], v4 offset:28832
v_mfma_f32_16x16x32_bf16 v[84:87], v[148:151], v[178:181], v[84:87]
s_add_u32 s17, s24, 20480
v_mov_b64 v[26:27], v[182:183]
v_mfma_f32_16x16x32_bf16 v[92:95], v[178:181], v[178:181], v[92:95]
buffer_load_dwordx4 v[168:171], v3, s[44:47], s17 offen offset:0 sc1
ds_read_b64_tr_b16 v[118:119], v4 offset:32416
v_mfma_f32_16x16x32_bf16 v[32:35], v[124:127], v[24:27], v[32:35]
ds_read_b64_tr_b16 v[120:121], v4 offset:28864
ds_read_b64_tr_b16 v[122:123], v4 offset:32448
v_mfma_f32_16x16x32_bf16 v[36:39], v[128:131], v[24:27], v[36:39]
buffer_load_dwordx4 v[172:175], v3, s[44:47], s17 offen offset:1024 sc1
s_barrier
v_mfma_f32_16x16x32_bf16 v[40:43], v[132:135], v[24:27], v[40:43]
s_add_u32 s33, s32, 9216
v_mfma_f32_16x16x32_bf16 v[44:47], v[136:139], v[24:27], v[44:47]
buffer_load_dwordx4 a[36:39], v3, s[44:47], s33 offen offset:0
v_mfma_f32_16x16x32_bf16 v[48:51], v[140:143], v[24:27], v[48:51]
v_mfma_f32_16x16x32_bf16 v[52:55], v[144:147], v[24:27], v[52:55]
buffer_load_dwordx4 a[40:43], v3, s[44:47], s33 offen offset:1024
v_mfma_f32_16x16x32_bf16 v[56:59], v[148:151], v[24:27], v[56:59]
v_mfma_f32_16x16x32_bf16 v[88:91], v[24:27], v[24:27], v[88:91]
buffer_load_dwordx4 a[44:47], v3, s[44:47], s33 offen offset:2048
s_waitcnt vmcnt(25) lgkmcnt(0)
v_mfma_f32_16x16x32_bf16 v[60:63], v[96:99], v[186:189], v[60:63]
ds_read_b64_tr_b16 v[124:125], v4 offset:35840
ds_read_b64_tr_b16 v[126:127], v4 offset:39424
v_mfma_f32_16x16x32_bf16 v[64:67], v[100:103], v[186:189], v[64:67]
ds_read_b64_tr_b16 v[128:129], v4 offset:35872
ds_read_b64_tr_b16 v[130:131], v4 offset:39456
v_mfma_f32_16x16x32_bf16 v[68:71], v[104:107], v[186:189], v[68:71]
ds_read_b64_tr_b16 v[132:133], v4 offset:35904
ds_read_b64_tr_b16 v[134:135], v4 offset:39488
v_mfma_f32_16x16x32_bf16 v[72:75], v[108:111], v[186:189], v[72:75]
ds_read_b64_tr_b16 v[136:137], v4 offset:35936
ds_read_b64_tr_b16 v[138:139], v4 offset:39520
v_mfma_f32_16x16x32_bf16 v[76:79], v[112:115], v[186:189], v[76:79]
ds_read_b64_tr_b16 v[140:141], v4 offset:35968
ds_read_b64_tr_b16 v[142:143], v4 offset:39552
v_mfma_f32_16x16x32_bf16 v[80:83], v[116:119], v[186:189], v[80:83]
ds_read_b64_tr_b16 v[144:145], v4 offset:36000
ds_read_b64_tr_b16 v[146:147], v4 offset:39584
v_mfma_f32_16x16x32_bf16 v[84:87], v[120:123], v[186:189], v[84:87]
v_mov_b64 v[26:27], v[190:191]
v_mov_b64 v[24:25], v[184:185]
v_mfma_f32_16x16x32_bf16 v[92:95], v[186:189], v[186:189], v[92:95]
buffer_load_dwordx4 v[176:179], v3, s[44:47], s17 offen offset:2048 sc1
ds_read_b64_tr_b16 v[148:149], v4 offset:36032
v_mfma_f32_16x16x32_bf16 v[32:35], v[96:99], v[24:27], v[32:35]
ds_read_b64_tr_b16 v[150:151], v4 offset:39616
v_mfma_f32_16x16x32_bf16 v[36:39], v[100:103], v[24:27], v[36:39]
buffer_load_dwordx4 v[180:183], v3, s[44:47], s17 offen offset:3072 sc1
v_mfma_f32_16x16x32_bf16 v[40:43], v[104:107], v[24:27], v[40:43]
s_add_u32 s33, s32, 12288
v_mfma_f32_16x16x32_bf16 v[44:47], v[108:111], v[24:27], v[44:47]
buffer_load_dwordx4 a[48:51], v3, s[44:47], s33 offen offset:0
v_mfma_f32_16x16x32_bf16 v[48:51], v[112:115], v[24:27], v[48:51]
v_mfma_f32_16x16x32_bf16 v[52:55], v[116:119], v[24:27], v[52:55]
buffer_load_dwordx4 a[52:55], v3, s[44:47], s33 offen offset:1024
v_mfma_f32_16x16x32_bf16 v[56:59], v[120:123], v[24:27], v[56:59]
v_mfma_f32_16x16x32_bf16 v[88:91], v[24:27], v[24:27], v[88:91]
buffer_load_dwordx4 a[56:59], v3, s[44:47], s33 offen offset:2048
s_waitcnt vmcnt(28) lgkmcnt(0)
v_mfma_f32_16x16x32_bf16 v[60:63], v[124:127], v[194:197], v[60:63]
ds_read_b64_tr_b16 v[96:97], v4 offset:43008
ds_read_b64_tr_b16 v[98:99], v4 offset:46592
v_mfma_f32_16x16x32_bf16 v[64:67], v[128:131], v[194:197], v[64:67]
ds_read_b64_tr_b16 v[100:101], v4 offset:43040
ds_read_b64_tr_b16 v[102:103], v4 offset:46624
v_mfma_f32_16x16x32_bf16 v[68:71], v[132:135], v[194:197], v[68:71]
ds_read_b64_tr_b16 v[104:105], v4 offset:43072
ds_read_b64_tr_b16 v[106:107], v4 offset:46656
v_mfma_f32_16x16x32_bf16 v[72:75], v[136:139], v[194:197], v[72:75]
ds_read_b64_tr_b16 v[108:109], v4 offset:43104
ds_read_b64_tr_b16 v[110:111], v4 offset:46688
v_mfma_f32_16x16x32_bf16 v[76:79], v[140:143], v[194:197], v[76:79]
ds_read_b64_tr_b16 v[112:113], v4 offset:43136
ds_read_b64_tr_b16 v[114:115], v4 offset:46720
v_mfma_f32_16x16x32_bf16 v[80:83], v[144:147], v[194:197], v[80:83]
v_mov_b64 v[24:25], v[192:193]
ds_read_b64_tr_b16 v[116:117], v4 offset:43168
v_mfma_f32_16x16x32_bf16 v[84:87], v[148:151], v[194:197], v[84:87]
s_add_u32 s17, s24, 24576
v_mov_b64 v[26:27], v[198:199]
v_mfma_f32_16x16x32_bf16 v[92:95], v[194:197], v[194:197], v[92:95]
buffer_load_dwordx4 v[184:187], v3, s[44:47], s17 offen offset:0 sc1
ds_read_b64_tr_b16 v[118:119], v4 offset:46752
v_mfma_f32_16x16x32_bf16 v[32:35], v[124:127], v[24:27], v[32:35]
ds_read_b64_tr_b16 v[120:121], v4 offset:43200
ds_read_b64_tr_b16 v[122:123], v4 offset:46784
v_mfma_f32_16x16x32_bf16 v[36:39], v[128:131], v[24:27], v[36:39]
buffer_load_dwordx4 v[188:191], v3, s[44:47], s17 offen offset:1024 sc1
v_mfma_f32_16x16x32_bf16 v[40:43], v[132:135], v[24:27], v[40:43]
s_add_u32 s33, s32, 15360
v_mfma_f32_16x16x32_bf16 v[44:47], v[136:139], v[24:27], v[44:47]
buffer_load_dwordx4 a[60:63], v3, s[44:47], s33 offen offset:0
v_mfma_f32_16x16x32_bf16 v[48:51], v[140:143], v[24:27], v[48:51]
v_mfma_f32_16x16x32_bf16 v[52:55], v[144:147], v[24:27], v[52:55]
buffer_load_dwordx4 a[64:67], v3, s[44:47], s33 offen offset:1024
v_mfma_f32_16x16x32_bf16 v[56:59], v[148:151], v[24:27], v[56:59]
v_mfma_f32_16x16x32_bf16 v[88:91], v[24:27], v[24:27], v[88:91]
buffer_load_dwordx4 a[68:71], v3, s[44:47], s33 offen offset:2048
s_waitcnt vmcnt(31) lgkmcnt(0)
v_mfma_f32_16x16x32_bf16 v[60:63], v[96:99], v[202:205], v[60:63]
ds_read_b64_tr_b16 v[124:125], v4 offset:50176
ds_read_b64_tr_b16 v[126:127], v4 offset:53760
v_mfma_f32_16x16x32_bf16 v[64:67], v[100:103], v[202:205], v[64:67]
ds_read_b64_tr_b16 v[128:129], v4 offset:50208
ds_read_b64_tr_b16 v[130:131], v4 offset:53792
v_mfma_f32_16x16x32_bf16 v[68:71], v[104:107], v[202:205], v[68:71]
ds_read_b64_tr_b16 v[132:133], v4 offset:50240
ds_read_b64_tr_b16 v[134:135], v4 offset:53824
v_mfma_f32_16x16x32_bf16 v[72:75], v[108:111], v[202:205], v[72:75]
ds_read_b64_tr_b16 v[136:137], v4 offset:50272
ds_read_b64_tr_b16 v[138:139], v4 offset:53856
v_mfma_f32_16x16x32_bf16 v[76:79], v[112:115], v[202:205], v[76:79]
ds_read_b64_tr_b16 v[140:141], v4 offset:50304
ds_read_b64_tr_b16 v[142:143], v4 offset:53888
v_mfma_f32_16x16x32_bf16 v[80:83], v[116:119], v[202:205], v[80:83]
ds_read_b64_tr_b16 v[144:145], v4 offset:50336
ds_read_b64_tr_b16 v[146:147], v4 offset:53920
v_mfma_f32_16x16x32_bf16 v[84:87], v[120:123], v[202:205], v[84:87]
v_mov_b64 v[26:27], v[206:207]
v_mov_b64 v[24:25], v[200:201]
v_mfma_f32_16x16x32_bf16 v[92:95], v[202:205], v[202:205], v[92:95]
buffer_load_dwordx4 v[192:195], v3, s[44:47], s17 offen offset:2048 sc1
ds_read_b64_tr_b16 v[148:149], v4 offset:50368
v_mfma_f32_16x16x32_bf16 v[32:35], v[96:99], v[24:27], v[32:35]
ds_read_b64_tr_b16 v[150:151], v4 offset:53952
v_mfma_f32_16x16x32_bf16 v[36:39], v[100:103], v[24:27], v[36:39]
buffer_load_dwordx4 v[196:199], v3, s[44:47], s17 offen offset:3072 sc1
v_mfma_f32_16x16x32_bf16 v[40:43], v[104:107], v[24:27], v[40:43]
s_add_u32 s33, s32, 18432
v_mfma_f32_16x16x32_bf16 v[44:47], v[108:111], v[24:27], v[44:47]
buffer_load_dwordx4 a[72:75], v3, s[44:47], s33 offen offset:0
v_mfma_f32_16x16x32_bf16 v[48:51], v[112:115], v[24:27], v[48:51]
v_mfma_f32_16x16x32_bf16 v[52:55], v[116:119], v[24:27], v[52:55]
buffer_load_dwordx4 a[76:79], v3, s[44:47], s33 offen offset:1024
v_mfma_f32_16x16x32_bf16 v[56:59], v[120:123], v[24:27], v[56:59]
v_mfma_f32_16x16x32_bf16 v[88:91], v[24:27], v[24:27], v[88:91]
buffer_load_dwordx4 a[80:83], v3, s[44:47], s33 offen offset:2048
s_waitcnt vmcnt(34) lgkmcnt(0)
v_add_u32 v4, 0xe000, v4
v_mfma_f32_16x16x32_bf16 v[60:63], v[124:127], v[210:213], v[60:63]
ds_read_b64_tr_b16 v[96:97], v4 offset:0
ds_read_b64_tr_b16 v[98:99], v4 offset:3584
v_mfma_f32_16x16x32_bf16 v[64:67], v[128:131], v[210:213], v[64:67]
ds_read_b64_tr_b16 v[100:101], v4 offset:32
ds_read_b64_tr_b16 v[102:103], v4 offset:3616
v_mfma_f32_16x16x32_bf16 v[68:71], v[132:135], v[210:213], v[68:71]
ds_read_b64_tr_b16 v[104:105], v4 offset:64
ds_read_b64_tr_b16 v[106:107], v4 offset:3648
v_mfma_f32_16x16x32_bf16 v[72:75], v[136:139], v[210:213], v[72:75]
ds_read_b64_tr_b16 v[108:109], v4 offset:96
ds_read_b64_tr_b16 v[110:111], v4 offset:3680
v_mfma_f32_16x16x32_bf16 v[76:79], v[140:143], v[210:213], v[76:79]
ds_read_b64_tr_b16 v[112:113], v4 offset:128
ds_read_b64_tr_b16 v[114:115], v4 offset:3712
v_mfma_f32_16x16x32_bf16 v[80:83], v[144:147], v[210:213], v[80:83]
v_mov_b64 v[24:25], v[208:209]
ds_read_b64_tr_b16 v[116:117], v4 offset:160
v_mfma_f32_16x16x32_bf16 v[84:87], v[148:151], v[210:213], v[84:87]
s_add_u32 s17, s24, 28672
v_mov_b64 v[26:27], v[214:215]
v_mfma_f32_16x16x32_bf16 v[92:95], v[210:213], v[210:213], v[92:95]
buffer_load_dwordx4 v[200:203], v3, s[44:47], s17 offen offset:0 sc1
ds_read_b64_tr_b16 v[118:119], v4 offset:3744
v_mfma_f32_16x16x32_bf16 v[32:35], v[124:127], v[24:27], v[32:35]
ds_read_b64_tr_b16 v[120:121], v4 offset:192
ds_read_b64_tr_b16 v[122:123], v4 offset:3776
v_mfma_f32_16x16x32_bf16 v[36:39], v[128:131], v[24:27], v[36:39]
buffer_load_dwordx4 v[204:207], v3, s[44:47], s17 offen offset:1024 sc1
v_mfma_f32_16x16x32_bf16 v[40:43], v[132:135], v[24:27], v[40:43]
s_add_u32 s33, s32, 21504
v_mfma_f32_16x16x32_bf16 v[44:47], v[136:139], v[24:27], v[44:47]
buffer_load_dwordx4 a[84:87], v3, s[44:47], s33 offen offset:0
v_mfma_f32_16x16x32_bf16 v[48:51], v[140:143], v[24:27], v[48:51]
v_mfma_f32_16x16x32_bf16 v[52:55], v[144:147], v[24:27], v[52:55]
buffer_load_dwordx4 a[88:91], v3, s[44:47], s33 offen offset:1024
v_mfma_f32_16x16x32_bf16 v[56:59], v[148:151], v[24:27], v[56:59]
v_mfma_f32_16x16x32_bf16 v[88:91], v[24:27], v[24:27], v[88:91]
buffer_load_dwordx4 a[92:95], v3, s[44:47], s33 offen offset:2048
s_waitcnt vmcnt(34) lgkmcnt(0)
v_mfma_f32_16x16x32_bf16 v[60:63], v[96:99], v[154:157], v[60:63]
ds_read_b64_tr_b16 v[124:125], v4 offset:7168
ds_read_b64_tr_b16 v[126:127], v4 offset:10752
v_mfma_f32_16x16x32_bf16 v[64:67], v[100:103], v[154:157], v[64:67]
ds_read_b64_tr_b16 v[128:129], v4 offset:7200
ds_read_b64_tr_b16 v[130:131], v4 offset:10784
v_mfma_f32_16x16x32_bf16 v[68:71], v[104:107], v[154:157], v[68:71]
ds_read_b64_tr_b16 v[132:133], v4 offset:7232
ds_read_b64_tr_b16 v[134:135], v4 offset:10816
v_mfma_f32_16x16x32_bf16 v[72:75], v[108:111], v[154:157], v[72:75]
ds_read_b64_tr_b16 v[136:137], v4 offset:7264
ds_read_b64_tr_b16 v[138:139], v4 offset:10848
v_mfma_f32_16x16x32_bf16 v[76:79], v[112:115], v[154:157], v[76:79]
ds_read_b64_tr_b16 v[140:141], v4 offset:7296
ds_read_b64_tr_b16 v[142:143], v4 offset:10880
v_mfma_f32_16x16x32_bf16 v[80:83], v[116:119], v[154:157], v[80:83]
ds_read_b64_tr_b16 v[144:145], v4 offset:7328
ds_read_b64_tr_b16 v[146:147], v4 offset:10912
v_mfma_f32_16x16x32_bf16 v[84:87], v[120:123], v[154:157], v[84:87]
v_mov_b64 v[26:27], v[158:159]
v_mov_b64 v[24:25], v[152:153]
v_mfma_f32_16x16x32_bf16 v[92:95], v[154:157], v[154:157], v[92:95]
buffer_load_dwordx4 v[208:211], v3, s[44:47], s17 offen offset:2048 sc1
ds_read_b64_tr_b16 v[148:149], v4 offset:7360
v_mfma_f32_16x16x32_bf16 v[32:35], v[96:99], v[24:27], v[32:35]
ds_read_b64_tr_b16 v[150:151], v4 offset:10944
v_mfma_f32_16x16x32_bf16 v[36:39], v[100:103], v[24:27], v[36:39]
buffer_load_dwordx4 v[212:215], v3, s[44:47], s17 offen offset:3072 sc1
v_mfma_f32_16x16x32_bf16 v[40:43], v[104:107], v[24:27], v[40:43]
s_add_u32 s33, s32, 24576
v_mfma_f32_16x16x32_bf16 v[44:47], v[108:111], v[24:27], v[44:47]
buffer_load_dwordx4 a[96:99], v3, s[44:47], s33 offen offset:0
v_mfma_f32_16x16x32_bf16 v[48:51], v[112:115], v[24:27], v[48:51]
v_mfma_f32_16x16x32_bf16 v[52:55], v[116:119], v[24:27], v[52:55]
buffer_load_dwordx4 a[100:103], v3, s[44:47], s33 offen offset:1024
v_mfma_f32_16x16x32_bf16 v[56:59], v[120:123], v[24:27], v[56:59]
v_mfma_f32_16x16x32_bf16 v[88:91], v[24:27], v[24:27], v[88:91]
buffer_load_dwordx4 a[104:107], v3, s[44:47], s33 offen offset:2048
s_waitcnt vmcnt(33) lgkmcnt(0)
v_mfma_f32_16x16x32_bf16 v[60:63], v[124:127], v[162:165], v[60:63]
ds_read_b64_tr_b16 v[96:97], v4 offset:14336
ds_read_b64_tr_b16 v[98:99], v4 offset:17920
v_mfma_f32_16x16x32_bf16 v[64:67], v[128:131], v[162:165], v[64:67]
ds_read_b64_tr_b16 v[100:101], v4 offset:14368
ds_read_b64_tr_b16 v[102:103], v4 offset:17952
v_mfma_f32_16x16x32_bf16 v[68:71], v[132:135], v[162:165], v[68:71]
ds_read_b64_tr_b16 v[104:105], v4 offset:14400
ds_read_b64_tr_b16 v[106:107], v4 offset:17984
v_mfma_f32_16x16x32_bf16 v[72:75], v[136:139], v[162:165], v[72:75]
ds_read_b64_tr_b16 v[108:109], v4 offset:14432
ds_read_b64_tr_b16 v[110:111], v4 offset:18016
v_mfma_f32_16x16x32_bf16 v[76:79], v[140:143], v[162:165], v[76:79]
ds_read_b64_tr_b16 v[112:113], v4 offset:14464
ds_read_b64_tr_b16 v[114:115], v4 offset:18048
v_mfma_f32_16x16x32_bf16 v[80:83], v[144:147], v[162:165], v[80:83]
v_mov_b64 v[24:25], v[160:161]
ds_read_b64_tr_b16 v[116:117], v4 offset:14496
v_mfma_f32_16x16x32_bf16 v[84:87], v[148:151], v[162:165], v[84:87]
s_add_u32 s17, s24, 32768
v_mov_b64 v[26:27], v[166:167]
v_mfma_f32_16x16x32_bf16 v[92:95], v[162:165], v[162:165], v[92:95]
buffer_load_dwordx4 v[152:155], v3, s[44:47], s17 offen offset:0 sc1
ds_read_b64_tr_b16 v[118:119], v4 offset:18080
v_mfma_f32_16x16x32_bf16 v[32:35], v[124:127], v[24:27], v[32:35]
ds_read_b64_tr_b16 v[120:121], v4 offset:14528
ds_read_b64_tr_b16 v[122:123], v4 offset:18112
v_mfma_f32_16x16x32_bf16 v[36:39], v[128:131], v[24:27], v[36:39]
buffer_load_dwordx4 v[156:159], v3, s[44:47], s17 offen offset:1024 sc1
v_mfma_f32_16x16x32_bf16 v[40:43], v[132:135], v[24:27], v[40:43]
s_add_u32 s33, s32, 27648
v_mfma_f32_16x16x32_bf16 v[44:47], v[136:139], v[24:27], v[44:47]
buffer_load_dwordx4 a[108:111], v3, s[44:47], s33 offen offset:0
v_mfma_f32_16x16x32_bf16 v[48:51], v[140:143], v[24:27], v[48:51]
v_mfma_f32_16x16x32_bf16 v[52:55], v[144:147], v[24:27], v[52:55]
buffer_load_dwordx4 a[112:115], v3, s[44:47], s33 offen offset:1024
v_mfma_f32_16x16x32_bf16 v[56:59], v[148:151], v[24:27], v[56:59]
v_mfma_f32_16x16x32_bf16 v[88:91], v[24:27], v[24:27], v[88:91]
buffer_load_dwordx4 a[116:119], v3, s[44:47], s33 offen offset:2048
s_waitcnt vmcnt(33) lgkmcnt(0)
v_mfma_f32_16x16x32_bf16 v[60:63], v[96:99], v[170:173], v[60:63]
ds_read_b64_tr_b16 v[124:125], v4 offset:21504
ds_read_b64_tr_b16 v[126:127], v4 offset:25088
v_mfma_f32_16x16x32_bf16 v[64:67], v[100:103], v[170:173], v[64:67]
ds_read_b64_tr_b16 v[128:129], v4 offset:21536
ds_read_b64_tr_b16 v[130:131], v4 offset:25120
v_mfma_f32_16x16x32_bf16 v[68:71], v[104:107], v[170:173], v[68:71]
ds_read_b64_tr_b16 v[132:133], v4 offset:21568
ds_read_b64_tr_b16 v[134:135], v4 offset:25152
v_mfma_f32_16x16x32_bf16 v[72:75], v[108:111], v[170:173], v[72:75]
ds_read_b64_tr_b16 v[136:137], v4 offset:21600
ds_read_b64_tr_b16 v[138:139], v4 offset:25184
v_mfma_f32_16x16x32_bf16 v[76:79], v[112:115], v[170:173], v[76:79]
ds_read_b64_tr_b16 v[140:141], v4 offset:21632
ds_read_b64_tr_b16 v[142:143], v4 offset:25216
v_mfma_f32_16x16x32_bf16 v[80:83], v[116:119], v[170:173], v[80:83]
ds_read_b64_tr_b16 v[144:145], v4 offset:21664
ds_read_b64_tr_b16 v[146:147], v4 offset:25248
v_mfma_f32_16x16x32_bf16 v[84:87], v[120:123], v[170:173], v[84:87]
v_mov_b64 v[26:27], v[174:175]
v_mov_b64 v[24:25], v[168:169]
v_mfma_f32_16x16x32_bf16 v[92:95], v[170:173], v[170:173], v[92:95]
buffer_load_dwordx4 v[160:163], v3, s[44:47], s17 offen offset:2048 sc1
ds_read_b64_tr_b16 v[148:149], v4 offset:21696
v_mfma_f32_16x16x32_bf16 v[32:35], v[96:99], v[24:27], v[32:35]
ds_read_b64_tr_b16 v[150:151], v4 offset:25280
v_mfma_f32_16x16x32_bf16 v[36:39], v[100:103], v[24:27], v[36:39]
buffer_load_dwordx4 v[164:167], v3, s[44:47], s17 offen offset:3072 sc1
v_mfma_f32_16x16x32_bf16 v[40:43], v[104:107], v[24:27], v[40:43]
s_add_u32 s33, s32, 30720
v_mfma_f32_16x16x32_bf16 v[44:47], v[108:111], v[24:27], v[44:47]
buffer_load_dwordx4 a[120:123], v3, s[44:47], s33 offen offset:0
v_mfma_f32_16x16x32_bf16 v[48:51], v[112:115], v[24:27], v[48:51]
v_mfma_f32_16x16x32_bf16 v[52:55], v[116:119], v[24:27], v[52:55]
buffer_load_dwordx4 a[124:127], v3, s[44:47], s33 offen offset:1024
v_mfma_f32_16x16x32_bf16 v[56:59], v[120:123], v[24:27], v[56:59]
v_mfma_f32_16x16x32_bf16 v[88:91], v[24:27], v[24:27], v[88:91]
buffer_load_dwordx4 a[128:131], v3, s[44:47], s33 offen offset:2048
s_waitcnt vmcnt(33) lgkmcnt(0)
v_mfma_f32_16x16x32_bf16 v[60:63], v[124:127], v[178:181], v[60:63]
ds_read_b64_tr_b16 v[96:97], v4 offset:28672
ds_read_b64_tr_b16 v[98:99], v4 offset:32256
v_mfma_f32_16x16x32_bf16 v[64:67], v[128:131], v[178:181], v[64:67]
ds_read_b64_tr_b16 v[100:101], v4 offset:28704
ds_read_b64_tr_b16 v[102:103], v4 offset:32288
v_mfma_f32_16x16x32_bf16 v[68:71], v[132:135], v[178:181], v[68:71]
ds_read_b64_tr_b16 v[104:105], v4 offset:28736
ds_read_b64_tr_b16 v[106:107], v4 offset:32320
v_mfma_f32_16x16x32_bf16 v[72:75], v[136:139], v[178:181], v[72:75]
ds_read_b64_tr_b16 v[108:109], v4 offset:28768
ds_read_b64_tr_b16 v[110:111], v4 offset:32352
v_mfma_f32_16x16x32_bf16 v[76:79], v[140:143], v[178:181], v[76:79]
ds_read_b64_tr_b16 v[112:113], v4 offset:28800
ds_read_b64_tr_b16 v[114:115], v4 offset:32384
v_mfma_f32_16x16x32_bf16 v[80:83], v[144:147], v[178:181], v[80:83]
v_mov_b64 v[24:25], v[176:177]
ds_read_b64_tr_b16 v[116:117], v4 offset:28832
v_mfma_f32_16x16x32_bf16 v[84:87], v[148:151], v[178:181], v[84:87]
s_add_u32 s17, s24, 36864
v_mov_b64 v[26:27], v[182:183]
v_mfma_f32_16x16x32_bf16 v[92:95], v[178:181], v[178:181], v[92:95]
buffer_load_dwordx4 v[168:171], v3, s[44:47], s17 offen offset:0 sc1
ds_read_b64_tr_b16 v[118:119], v4 offset:32416
v_mfma_f32_16x16x32_bf16 v[32:35], v[124:127], v[24:27], v[32:35]
ds_read_b64_tr_b16 v[120:121], v4 offset:28864
ds_read_b64_tr_b16 v[122:123], v4 offset:32448
v_mfma_f32_16x16x32_bf16 v[36:39], v[128:131], v[24:27], v[36:39]
buffer_load_dwordx4 v[172:175], v3, s[44:47], s17 offen offset:1024 sc1
v_mfma_f32_16x16x32_bf16 v[40:43], v[132:135], v[24:27], v[40:43]
s_add_u32 s33, s32, 33792
v_mfma_f32_16x16x32_bf16 v[44:47], v[136:139], v[24:27], v[44:47]
buffer_load_dwordx4 a[132:135], v3, s[44:47], s33 offen offset:0
v_mfma_f32_16x16x32_bf16 v[48:51], v[140:143], v[24:27], v[48:51]
v_mfma_f32_16x16x32_bf16 v[52:55], v[144:147], v[24:27], v[52:55]
buffer_load_dwordx4 a[136:139], v3, s[44:47], s33 offen offset:1024
v_mfma_f32_16x16x32_bf16 v[56:59], v[148:151], v[24:27], v[56:59]
v_mfma_f32_16x16x32_bf16 v[88:91], v[24:27], v[24:27], v[88:91]
buffer_load_dwordx4 a[140:143], v3, s[44:47], s33 offen offset:2048
s_waitcnt vmcnt(33) lgkmcnt(0)
v_mfma_f32_16x16x32_bf16 v[60:63], v[96:99], v[186:189], v[60:63]
ds_read_b64_tr_b16 v[124:125], v4 offset:35840
ds_read_b64_tr_b16 v[126:127], v4 offset:39424
v_mfma_f32_16x16x32_bf16 v[64:67], v[100:103], v[186:189], v[64:67]
ds_read_b64_tr_b16 v[128:129], v4 offset:35872
ds_read_b64_tr_b16 v[130:131], v4 offset:39456
v_mfma_f32_16x16x32_bf16 v[68:71], v[104:107], v[186:189], v[68:71]
ds_read_b64_tr_b16 v[132:133], v4 offset:35904
ds_read_b64_tr_b16 v[134:135], v4 offset:39488
v_mfma_f32_16x16x32_bf16 v[72:75], v[108:111], v[186:189], v[72:75]
ds_read_b64_tr_b16 v[136:137], v4 offset:35936
ds_read_b64_tr_b16 v[138:139], v4 offset:39520
v_mfma_f32_16x16x32_bf16 v[76:79], v[112:115], v[186:189], v[76:79]
ds_read_b64_tr_b16 v[140:141], v4 offset:35968
ds_read_b64_tr_b16 v[142:143], v4 offset:39552
v_mfma_f32_16x16x32_bf16 v[80:83], v[116:119], v[186:189], v[80:83]
ds_read_b64_tr_b16 v[144:145], v4 offset:36000
ds_read_b64_tr_b16 v[146:147], v4 offset:39584
v_mfma_f32_16x16x32_bf16 v[84:87], v[120:123], v[186:189], v[84:87]
v_mov_b64 v[26:27], v[190:191]
v_mov_b64 v[24:25], v[184:185]
v_mfma_f32_16x16x32_bf16 v[92:95], v[186:189], v[186:189], v[92:95]
buffer_load_dwordx4 v[176:179], v3, s[44:47], s17 offen offset:2048 sc1
ds_read_b64_tr_b16 v[148:149], v4 offset:36032
v_mfma_f32_16x16x32_bf16 v[32:35], v[96:99], v[24:27], v[32:35]
ds_read_b64_tr_b16 v[150:151], v4 offset:39616
v_mfma_f32_16x16x32_bf16 v[36:39], v[100:103], v[24:27], v[36:39]
buffer_load_dwordx4 v[180:183], v3, s[44:47], s17 offen offset:3072 sc1
v_mfma_f32_16x16x32_bf16 v[40:43], v[104:107], v[24:27], v[40:43]
s_add_u32 s33, s32, 36864
v_mfma_f32_16x16x32_bf16 v[44:47], v[108:111], v[24:27], v[44:47]
buffer_load_dwordx4 a[144:147], v3, s[44:47], s33 offen offset:0
v_mfma_f32_16x16x32_bf16 v[48:51], v[112:115], v[24:27], v[48:51]
v_mfma_f32_16x16x32_bf16 v[52:55], v[116:119], v[24:27], v[52:55]
buffer_load_dwordx4 a[148:151], v3, s[44:47], s33 offen offset:1024
v_mfma_f32_16x16x32_bf16 v[56:59], v[120:123], v[24:27], v[56:59]
v_mfma_f32_16x16x32_bf16 v[88:91], v[24:27], v[24:27], v[88:91]
buffer_load_dwordx4 a[152:155], v3, s[44:47], s33 offen offset:2048
s_waitcnt vmcnt(33) lgkmcnt(0)
v_add_u32 v23, 0xe000, v4
v_mfma_f32_16x16x32_bf16 v[60:63], v[124:127], v[194:197], v[60:63]
ds_read_b64_tr_b16 v[96:97], v4 offset:43008
ds_read_b64_tr_b16 v[98:99], v4 offset:46592
v_mfma_f32_16x16x32_bf16 v[64:67], v[128:131], v[194:197], v[64:67]
ds_read_b64_tr_b16 v[100:101], v4 offset:43040
ds_read_b64_tr_b16 v[102:103], v4 offset:46624
v_mfma_f32_16x16x32_bf16 v[68:71], v[132:135], v[194:197], v[68:71]
ds_read_b64_tr_b16 v[104:105], v4 offset:43200
ds_read_b64_tr_b16 v[106:107], v4 offset:46784
v_mfma_f32_16x16x32_bf16 v[72:75], v[136:139], v[194:197], v[72:75]
ds_read_b64_tr_b16 v[108:109], v4 offset:50176
ds_read_b64_tr_b16 v[110:111], v4 offset:53760
v_mfma_f32_16x16x32_bf16 v[76:79], v[140:143], v[194:197], v[76:79]
ds_read_b64_tr_b16 v[112:113], v4 offset:50208
ds_read_b64_tr_b16 v[114:115], v4 offset:53792
v_mfma_f32_16x16x32_bf16 v[80:83], v[144:147], v[194:197], v[80:83]
v_mov_b64 v[24:25], v[192:193]
ds_read_b64_tr_b16 v[116:117], v4 offset:50368
v_mfma_f32_16x16x32_bf16 v[84:87], v[148:151], v[194:197], v[84:87]
s_add_u32 s33, s32, 39936
v_mov_b64 v[26:27], v[198:199]
v_mfma_f32_16x16x32_bf16 v[92:95], v[194:197], v[194:197], v[92:95]
buffer_load_dwordx4 a[156:159], v3, s[44:47], s33 offen offset:0
ds_read_b64_tr_b16 v[118:119], v4 offset:53952
v_mfma_f32_16x16x32_bf16 v[32:35], v[124:127], v[24:27], v[32:35]
ds_read_b64_tr_b16 v[120:121], v23 offset:0
ds_read_b64_tr_b16 v[122:123], v23 offset:3584
v_mfma_f32_16x16x32_bf16 v[36:39], v[128:131], v[24:27], v[36:39]
buffer_load_dwordx4 a[160:163], v3, s[44:47], s33 offen offset:1024
v_mfma_f32_16x16x32_bf16 v[40:43], v[132:135], v[24:27], v[40:43]
v_mfma_f32_16x16x32_bf16 v[44:47], v[136:139], v[24:27], v[44:47]
buffer_load_dwordx4 a[164:167], v3, s[44:47], s33 offen offset:2048
v_mfma_f32_16x16x32_bf16 v[48:51], v[140:143], v[24:27], v[48:51]
v_mfma_f32_16x16x32_bf16 v[52:55], v[144:147], v[24:27], v[52:55]
v_mfma_f32_16x16x32_bf16 v[56:59], v[148:151], v[24:27], v[56:59]
v_mfma_f32_16x16x32_bf16 v[88:91], v[24:27], v[24:27], v[88:91]
s_waitcnt vmcnt(31) lgkmcnt(8)
v_mfma_f32_16x16x32_bf16 v[60:63], v[96:99], v[202:205], v[60:63]
v_mov_b64 v[24:25], v[200:201]
ds_read_b64_tr_b16 v[124:125], v23 offset:32
v_mfma_f32_16x16x32_bf16 v[64:67], v[100:103], v[202:205], v[64:67]
v_mov_b64 v[26:27], v[206:207]
ds_read_b64_tr_b16 v[126:127], v23 offset:3616
v_mfma_f32_16x16x32_bf16 v[84:87], v[104:107], v[202:205], v[84:87]
ds_read_b64_tr_b16 v[128:129], v23 offset:192
ds_read_b64_tr_b16 v[130:131], v23 offset:3776
v_mfma_f32_16x16x32_bf16 v[92:95], v[202:205], v[202:205], v[92:95]
ds_read_b64_tr_b16 v[132:133], v23 offset:7168
ds_read_b64_tr_b16 v[134:135], v23 offset:10752
v_mfma_f32_16x16x32_bf16 v[32:35], v[96:99], v[24:27], v[32:35]
ds_read_b64_tr_b16 v[136:137], v23 offset:7200
ds_read_b64_tr_b16 v[138:139], v23 offset:10784
v_mfma_f32_16x16x32_bf16 v[36:39], v[100:103], v[24:27], v[36:39]
ds_read_b64_tr_b16 v[140:141], v23 offset:7360
ds_read_b64_tr_b16 v[142:143], v23 offset:10944
v_mfma_f32_16x16x32_bf16 v[56:59], v[104:107], v[24:27], v[56:59]
ds_read_b64_tr_b16 v[144:145], v23 offset:14336
ds_read_b64_tr_b16 v[146:147], v23 offset:17920
v_mfma_f32_16x16x32_bf16 v[88:91], v[24:27], v[24:27], v[88:91]
ds_read_b64_tr_b16 v[148:149], v23 offset:14368
buffer_load_dwordx4 v[216:219], v18, s[44:47], s101 offen sc1
buffer_load_dwordx4 v[220:223], v19, s[44:47], s31 offen sc1
s_add_u32 s33, s32, 43008
buffer_load_dwordx4 a[168:171], v3, s[44:47], s33 offen offset:0
buffer_load_dwordx4 a[172:175], v3, s[44:47], s33 offen offset:1024
s_waitcnt vmcnt(30) lgkmcnt(15)
v_mfma_f32_16x16x32_bf16 v[60:63], v[108:111], v[210:213], v[60:63]
v_mov_b64 v[24:25], v[208:209]
ds_read_b64_tr_b16 v[150:151], v23 offset:17952
v_mfma_f32_16x16x32_bf16 v[64:67], v[112:115], v[210:213], v[64:67]
v_mov_b64 v[26:27], v[214:215]
ds_read_b64_tr_b16 v[96:97], v23 offset:14528
v_mfma_f32_16x16x32_bf16 v[84:87], v[116:119], v[210:213], v[84:87]
ds_read_b64_tr_b16 v[98:99], v23 offset:18112
ds_read_b64_tr_b16 v[100:101], v23 offset:21504
v_mfma_f32_16x16x32_bf16 v[92:95], v[210:213], v[210:213], v[92:95]
ds_read_b64_tr_b16 v[102:103], v23 offset:25088
ds_read_b64_tr_b16 v[104:105], v23 offset:21536
v_mfma_f32_16x16x32_bf16 v[32:35], v[108:111], v[24:27], v[32:35]
ds_read_b64_tr_b16 v[106:107], v23 offset:25120
ds_read_b64_tr_b16 v[108:109], v23 offset:21696
v_mfma_f32_16x16x32_bf16 v[36:39], v[112:115], v[24:27], v[36:39]
ds_read_b64_tr_b16 v[110:111], v23 offset:25280
s_add_u32 s33, s32, 45056
v_mfma_f32_16x16x32_bf16 v[56:59], v[116:119], v[24:27], v[56:59]
buffer_load_dwordx4 a[176:179], v3, s[44:47], s33 offen offset:0
v_mfma_f32_16x16x32_bf16 v[88:91], v[24:27], v[24:27], v[88:91]
s_waitcnt vmcnt(26) lgkmcnt(15)
v_mfma_f32_16x16x32_bf16 v[60:63], v[120:123], v[154:157], v[60:63]
v_mov_b64 v[24:25], v[152:153]
v_add_u32 v6, 0, v5
v_mfma_f32_16x16x32_bf16 v[64:67], v[124:127], v[154:157], v[64:67]
v_mov_b64 v[26:27], v[158:159]
ds_read2_b32 v[184:185], v6 offset0:55 offset1:111
v_mfma_f32_16x16x32_bf16 v[84:87], v[128:131], v[154:157], v[84:87]
ds_read2_b32 v[186:187], v6 offset0:167 offset1:223
v_add_u32 v7, 25088, v5
v_mfma_f32_16x16x32_bf16 v[92:95], v[154:157], v[154:157], v[92:95]
ds_read2_b32 v[188:189], v7 offset0:55 offset1:111
ds_read2_b32 v[190:191], v7 offset0:167 offset1:223
v_mfma_f32_16x16x32_bf16 v[32:35], v[120:123], v[24:27], v[32:35]
v_add_u32 v6, 3584, v5
ds_read2_b32 v[192:193], v6 offset0:55 offset1:111
v_mfma_f32_16x16x32_bf16 v[36:39], v[124:127], v[24:27], v[36:39]
ds_read2_b32 v[194:195], v6 offset0:167 offset1:223
v_add_u32 v7, 28672, v5
v_mfma_f32_16x16x32_bf16 v[56:59], v[128:131], v[24:27], v[56:59]
ds_read2_b32 v[196:197], v7 offset0:55 offset1:111
ds_read2_b32 v[198:199], v7 offset0:167 offset1:223
v_mfma_f32_16x16x32_bf16 v[88:91], v[24:27], v[24:27], v[88:91]
s_add_u32 s33, s32, 46080
s_add_u32 s9, s25, 0xac0000
buffer_load_dwordx4 a[180:183], v3, s[44:47], s33 offen offset:0
buffer_load_dwordx2 v[8:9], v28, s[44:47], s9 offen offset:0 sc1
s_waitcnt vmcnt(23) lgkmcnt(15)
v_mfma_f32_16x16x32_bf16 v[60:63], v[132:135], v[162:165], v[60:63]
v_mov_b64 v[24:25], v[160:161]
v_mfma_f32_16x16x32_bf16 v[64:67], v[136:139], v[162:165], v[64:67]
v_mov_b64 v[26:27], v[166:167]
s_add_u32 s33, s32, 47104
v_mfma_f32_16x16x32_bf16 v[84:87], v[140:143], v[162:165], v[84:87]
s_add_u32 s9, s25, 0xac0000
buffer_load_dwordx4 a[184:187], v3, s[44:47], s33 offen offset:0
v_mfma_f32_16x16x32_bf16 v[92:95], v[162:165], v[162:165], v[92:95]
buffer_load_dwordx2 v[10:11], v28, s[44:47], s9 offen offset:256 sc1
v_mfma_f32_16x16x32_bf16 v[32:35], v[132:135], v[24:27], v[32:35]
v_mfma_f32_16x16x32_bf16 v[36:39], v[136:139], v[24:27], v[36:39]
ds_read_b64_tr_b16 v[136:137], v4 offset:43072
ds_read_b64_tr_b16 v[138:139], v4 offset:46656
v_mfma_f32_16x16x32_bf16 v[56:59], v[140:143], v[24:27], v[56:59]
ds_read_b64_tr_b16 v[140:141], v4 offset:43104
ds_read_b64_tr_b16 v[142:143], v4 offset:46688
v_mfma_f32_16x16x32_bf16 v[88:91], v[24:27], v[24:27], v[88:91]
s_waitcnt vmcnt(20) lgkmcnt(15)
v_mfma_f32_16x16x32_bf16 v[60:63], v[144:147], v[170:173], v[60:63]
v_mov_b64 v[24:25], v[168:169]
v_mfma_f32_16x16x32_bf16 v[64:67], v[148:151], v[170:173], v[64:67]
v_mov_b64 v[26:27], v[174:175]
s_add_u32 s33, s32, 48128
v_mfma_f32_16x16x32_bf16 v[84:87], v[96:99], v[170:173], v[84:87]
s_add_u32 s9, s25, 0xac0000
buffer_load_dwordx4 a[188:191], v3, s[44:47], s33 offen offset:0
v_mfma_f32_16x16x32_bf16 v[92:95], v[170:173], v[170:173], v[92:95]
buffer_load_dwordx2 v[12:13], v28, s[44:47], s9 offen offset:2048 sc1
v_mfma_f32_16x16x32_bf16 v[32:35], v[144:147], v[24:27], v[32:35]
ds_read_b64_tr_b16 v[144:145], v4 offset:43136
ds_read_b64_tr_b16 v[146:147], v4 offset:46720
v_mfma_f32_16x16x32_bf16 v[36:39], v[148:151], v[24:27], v[36:39]
ds_read_b64_tr_b16 v[148:149], v4 offset:43168
ds_read_b64_tr_b16 v[150:151], v4 offset:46752
v_mfma_f32_16x16x32_bf16 v[56:59], v[96:99], v[24:27], v[56:59]
ds_read_b64_tr_b16 v[96:97], v4 offset:50240
ds_read_b64_tr_b16 v[98:99], v4 offset:53824
v_mfma_f32_16x16x32_bf16 v[88:91], v[24:27], v[24:27], v[88:91]
s_waitcnt vmcnt(17) lgkmcnt(15)
v_mfma_f32_16x16x32_bf16 v[60:63], v[100:103], v[178:181], v[60:63]
v_mov_b64 v[24:25], v[176:177]
v_mfma_f32_16x16x32_bf16 v[64:67], v[104:107], v[178:181], v[64:67]
v_mov_b64 v[26:27], v[182:183]
s_add_u32 s33, s32, 49152
v_mfma_f32_16x16x32_bf16 v[84:87], v[108:111], v[178:181], v[84:87]
s_add_u32 s9, s25, 0xac0000
buffer_load_dwordx4 a[192:195], v3, s[44:47], s33 offen offset:0
v_mfma_f32_16x16x32_bf16 v[92:95], v[178:181], v[178:181], v[92:95]
buffer_load_dwordx2 v[14:15], v28, s[44:47], s9 offen offset:2304 sc1
v_mfma_f32_16x16x32_bf16 v[32:35], v[100:103], v[24:27], v[32:35]
ds_read_b64_tr_b16 v[100:101], v4 offset:50272
ds_read_b64_tr_b16 v[102:103], v4 offset:53856
v_mfma_f32_16x16x32_bf16 v[36:39], v[104:107], v[24:27], v[36:39]
ds_read_b64_tr_b16 v[104:105], v4 offset:50304
ds_read_b64_tr_b16 v[106:107], v4 offset:53888
v_mfma_f32_16x16x32_bf16 v[56:59], v[108:111], v[24:27], v[56:59]
ds_read_b64_tr_b16 v[108:109], v4 offset:50336
ds_read_b64_tr_b16 v[110:111], v4 offset:53920
v_mfma_f32_16x16x32_bf16 v[88:91], v[24:27], v[24:27], v[88:91]
s_waitcnt lgkmcnt(8)
s_nop 3
v_cndmask_b32 v112, v56, 0, s[58:59]
s_nop 1
v_cndmask_b32 v114, 0, v88, s[48:49]
v_cndmask_b32 v113, v84, 0, s[58:59]
v_cndmask_b32 v115, 0, v92, s[48:49]
v_cndmask_b32 v114, v114, v89, s[50:51]
v_cndmask_b32 v115, v115, v93, s[50:51]
v_cndmask_b32 v114, v114, v90, s[52:53]
v_cndmask_b32 v115, v115, v94, s[52:53]
v_cndmask_b32 v114, v114, v91, s[54:55]
v_cndmask_b32 v115, v115, v95, s[54:55]
v_mov_b32 v116, v112
v_mov_b32 v117, v113
v_mov_b32 v118, v114
v_mov_b32 v119, v115
v_permlane16_swap_b32 v112, v116
v_permlane16_swap_b32 v113, v117
v_permlane16_swap_b32 v114, v118
v_permlane16_swap_b32 v115, v119
v_add_f32 v112, v112, v116
v_add_f32 v113, v113, v117
v_add_f32 v114, v114, v118
v_add_f32 v115, v115, v119
v_mov_b32 v116, v112
v_mov_b32 v117, v113
v_mov_b32 v118, v114
v_mov_b32 v119, v115
v_permlane32_swap_b32 v112, v116
v_permlane32_swap_b32 v113, v117
v_permlane32_swap_b32 v114, v118
v_permlane32_swap_b32 v115, v119
v_add_f32 v112, v112, v116
v_add_f32 v113, v113, v117
v_add_f32 v114, v114, v118
v_add_f32 v115, v115, v119
v_mul_f32 v112, 0x3acccccd, v112
v_mul_f32 v113, 0x3acccccd, v113
v_mul_f32 v114, 0x3acccccd, v114
v_mul_f32 v115, 0x3acccccd, v115
v_fma_f32 v114, -v112, v112, v114
v_fma_f32 v115, -v113, v113, v115
v_max_f32 v114, 0, v114
v_max_f32 v115, 0, v115
v_add_f32 v116, 0x3727c5ac, v114
v_add_f32 v117, 0x3727c5ac, v115
v_rsq_f32 v116, v116
v_rsq_f32 v117, v117
v_mov_b32 v92, 0xc09d30fc
v_mov_b32 v93, 0xc09d30fc
v_mov_b32 v94, 0x3727c5ac
v_mul_f32 v114, v114, v116
v_mul_f32 v115, v115, v117
v_fma_f32 v114, v114, v116, v94
v_fma_f32 v115, v115, v117, v94
v_rsq_f32 v114, v114
v_rsq_f32 v115, v115
v_mul_f32 v116, s56, v116
v_mul_f32 v117, s56, v117
v_mul_f32 v88, v114, v116
v_mul_f32 v90, v115, v117
v_mul_f32 v89, -v112, v88
v_mul_f32 v91, -v113, v90
v_pk_fma_f32 v[112:113], v[184:185], v[88:89], v[188:189] op_sel:[0,1,0] op_sel_hi:[1,1,1]
v_pk_fma_f32 v[114:115], v[186:187], v[88:89], v[190:191] op_sel:[0,1,0] op_sel_hi:[1,1,1]
v_pk_fma_f32 v[116:117], v[192:193], v[88:89], v[196:197] op_sel:[0,1,0] op_sel_hi:[1,1,1]
v_pk_fma_f32 v[118:119], v[194:195], v[88:89], v[198:199] op_sel:[0,1,0] op_sel_hi:[1,1,1]
v_pk_fma_f32 v[32:33], v[32:33], v[88:89], v[112:113] op_sel_hi:[1,0,1]
v_pk_fma_f32 v[34:35], v[34:35], v[88:89], v[114:115] op_sel_hi:[1,0,1]
v_pk_fma_f32 v[36:37], v[36:37], v[88:89], v[116:117] op_sel_hi:[1,0,1]
v_pk_fma_f32 v[38:39], v[38:39], v[88:89], v[118:119] op_sel_hi:[1,0,1]
v_pk_fma_f32 v[112:113], v[32:33], v[32:33], v[92:93] neg_lo:[1,0,0] neg_hi:[1,0,0]
v_pk_fma_f32 v[114:115], v[34:35], v[34:35], v[92:93] neg_lo:[1,0,0] neg_hi:[1,0,0]
v_pk_fma_f32 v[116:117], v[36:37], v[36:37], v[92:93] neg_lo:[1,0,0] neg_hi:[1,0,0]
v_pk_fma_f32 v[118:119], v[38:39], v[38:39], v[92:93] neg_lo:[1,0,0] neg_hi:[1,0,0]
v_pk_mul_f32 v[112:113], v[112:113], v[32:33]
v_pk_mul_f32 v[114:115], v[114:115], v[34:35]
v_pk_mul_f32 v[116:117], v[116:117], v[36:37]
v_pk_mul_f32 v[118:119], v[118:119], v[38:39]
v_exp_f32 v112, v112
v_exp_f32 v113, v113
v_exp_f32 v114, v114
v_exp_f32 v115, v115
v_exp_f32 v116, v116
v_exp_f32 v117, v117
v_exp_f32 v118, v118
v_exp_f32 v119, v119
v_pk_fma_f32 v[112:113], v[112:113], s[56:57], s[56:57]
v_pk_fma_f32 v[114:115], v[114:115], s[56:57], s[56:57]
v_pk_fma_f32 v[116:117], v[116:117], s[56:57], s[56:57]
v_pk_fma_f32 v[118:119], v[118:119], s[56:57], s[56:57]
v_rcp_f32 v112, v112
v_rcp_f32 v113, v113
v_rcp_f32 v114, v114
v_rcp_f32 v115, v115
v_rcp_f32 v116, v116
v_rcp_f32 v117, v117
v_rcp_f32 v118, v118
v_rcp_f32 v119, v119
v_pk_mul_f32 v[112:113], v[112:113], v[32:33]
v_pk_mul_f32 v[114:115], v[114:115], v[34:35]
v_pk_mul_f32 v[116:117], v[116:117], v[36:37]
v_pk_mul_f32 v[118:119], v[118:119], v[38:39]
v_cvt_pk_bf16_f32 v120, v112, v113
v_cvt_pk_bf16_f32 v121, v114, v115
v_cvt_pk_bf16_f32 v122, v116, v117
v_cvt_pk_bf16_f32 v123, v118, v119
s_add_u32 s8, s26, 0x1140000
buffer_store_dwordx4 v[120:123], v3, s[44:47], s8 offen sc1
v_pk_fma_f32 v[124:125], v[184:185], v[90:91], v[188:189] op_sel:[0,1,0] op_sel_hi:[1,1,1]
v_pk_fma_f32 v[126:127], v[186:187], v[90:91], v[190:191] op_sel:[0,1,0] op_sel_hi:[1,1,1]
v_pk_fma_f32 v[128:129], v[192:193], v[90:91], v[196:197] op_sel:[0,1,0] op_sel_hi:[1,1,1]
v_pk_fma_f32 v[130:131], v[194:195], v[90:91], v[198:199] op_sel:[0,1,0] op_sel_hi:[1,1,1]
v_pk_fma_f32 v[60:61], v[60:61], v[90:91], v[124:125] op_sel_hi:[1,0,1]
v_pk_fma_f32 v[62:63], v[62:63], v[90:91], v[126:127] op_sel_hi:[1,0,1]
v_pk_fma_f32 v[64:65], v[64:65], v[90:91], v[128:129] op_sel_hi:[1,0,1]
v_pk_fma_f32 v[66:67], v[66:67], v[90:91], v[130:131] op_sel_hi:[1,0,1]
v_pk_fma_f32 v[124:125], v[60:61], v[60:61], v[92:93] neg_lo:[1,0,0] neg_hi:[1,0,0]
v_pk_fma_f32 v[126:127], v[62:63], v[62:63], v[92:93] neg_lo:[1,0,0] neg_hi:[1,0,0]
v_pk_fma_f32 v[128:129], v[64:65], v[64:65], v[92:93] neg_lo:[1,0,0] neg_hi:[1,0,0]
v_pk_fma_f32 v[130:131], v[66:67], v[66:67], v[92:93] neg_lo:[1,0,0] neg_hi:[1,0,0]
v_pk_mul_f32 v[124:125], v[124:125], v[60:61]
v_pk_mul_f32 v[126:127], v[126:127], v[62:63]
v_pk_mul_f32 v[128:129], v[128:129], v[64:65]
v_pk_mul_f32 v[130:131], v[130:131], v[66:67]
v_exp_f32 v124, v124
v_exp_f32 v125, v125
v_exp_f32 v126, v126
v_exp_f32 v127, v127
v_exp_f32 v128, v128
v_exp_f32 v129, v129
v_exp_f32 v130, v130
v_exp_f32 v131, v131
v_pk_fma_f32 v[124:125], v[124:125], s[56:57], s[56:57]
v_pk_fma_f32 v[126:127], v[126:127], s[56:57], s[56:57]
v_pk_fma_f32 v[128:129], v[128:129], s[56:57], s[56:57]
v_pk_fma_f32 v[130:131], v[130:131], s[56:57], s[56:57]
v_rcp_f32 v124, v124
v_rcp_f32 v125, v125
v_rcp_f32 v126, v126
v_rcp_f32 v127, v127
v_rcp_f32 v128, v128
v_rcp_f32 v129, v129
v_rcp_f32 v130, v130
v_rcp_f32 v131, v131
v_pk_mul_f32 v[124:125], v[124:125], v[60:61]
v_pk_mul_f32 v[126:127], v[126:127], v[62:63]
v_pk_mul_f32 v[128:129], v[128:129], v[64:65]
v_pk_mul_f32 v[130:131], v[130:131], v[66:67]
v_cvt_pk_bf16_f32 v132, v124, v125
v_cvt_pk_bf16_f32 v133, v126, v127
v_cvt_pk_bf16_f32 v134, v128, v129
v_cvt_pk_bf16_f32 v135, v130, v131
s_add_u32 s8, s27, 0x1140000
buffer_store_dwordx4 v[132:135], v3, s[44:47], s8 offen sc1
v_mfma_f32_16x16x32_bf16 v[68:71], v[136:139], v[202:205], v[68:71]
v_mov_b64 v[24:25], v[200:201]
ds_read_b64_tr_b16 v[112:113], v23 offset:64
v_mfma_f32_16x16x32_bf16 v[72:75], v[140:143], v[202:205], v[72:75]
v_mov_b64 v[26:27], v[206:207]
ds_read_b64_tr_b16 v[114:115], v23 offset:3648
v_mfma_f32_16x16x32_bf16 v[76:79], v[144:147], v[202:205], v[76:79]
ds_read_b64_tr_b16 v[116:117], v23 offset:96
ds_read_b64_tr_b16 v[118:119], v23 offset:3680
v_mfma_f32_16x16x32_bf16 v[80:83], v[148:151], v[202:205], v[80:83]
ds_read_b64_tr_b16 v[120:121], v23 offset:128
ds_read_b64_tr_b16 v[122:123], v23 offset:3712
v_mfma_f32_16x16x32_bf16 v[40:43], v[136:139], v[24:27], v[40:43]
ds_read_b64_tr_b16 v[124:125], v23 offset:160
ds_read_b64_tr_b16 v[126:127], v23 offset:3744
v_mfma_f32_16x16x32_bf16 v[44:47], v[140:143], v[24:27], v[44:47]
ds_read_b64_tr_b16 v[128:129], v23 offset:7232
ds_read_b64_tr_b16 v[130:131], v23 offset:10816
v_mfma_f32_16x16x32_bf16 v[48:51], v[144:147], v[24:27], v[48:51]
ds_read_b64_tr_b16 v[132:133], v23 offset:7264
ds_read_b64_tr_b16 v[134:135], v23 offset:10848
v_mfma_f32_16x16x32_bf16 v[52:55], v[148:151], v[24:27], v[52:55]
ds_read_b64_tr_b16 v[136:137], v23 offset:7296
s_add_u32 s33, s32, 50176
s_add_u32 s9, s25, 0xac0000
buffer_load_dwordx4 a[196:199], v3, s[44:47], s33 offen offset:0
buffer_load_dwordx2 v[16:17], v29, s[44:47], s9 offen sc1
s_waitcnt lgkmcnt(13)
v_mfma_f32_16x16x32_bf16 v[68:71], v[96:99], v[210:213], v[68:71]
v_mov_b64 v[24:25], v[208:209]
ds_read_b64_tr_b16 v[138:139], v23 offset:10880
v_mfma_f32_16x16x32_bf16 v[72:75], v[100:103], v[210:213], v[72:75]
v_mov_b64 v[26:27], v[214:215]
ds_read_b64_tr_b16 v[140:141], v23 offset:7328
v_mfma_f32_16x16x32_bf16 v[76:79], v[104:107], v[210:213], v[76:79]
ds_read_b64_tr_b16 v[142:143], v23 offset:10912
ds_read_b64_tr_b16 v[144:145], v23 offset:14400
v_mfma_f32_16x16x32_bf16 v[80:83], v[108:111], v[210:213], v[80:83]
ds_read_b64_tr_b16 v[146:147], v23 offset:17984
ds_read_b64_tr_b16 v[148:149], v23 offset:14432
v_mfma_f32_16x16x32_bf16 v[40:43], v[96:99], v[24:27], v[40:43]
ds_read_b64_tr_b16 v[150:151], v23 offset:18016
ds_read_b64_tr_b16 v[96:97], v23 offset:14464
v_mfma_f32_16x16x32_bf16 v[44:47], v[100:103], v[24:27], v[44:47]
ds_read_b64_tr_b16 v[98:99], v23 offset:18048
ds_read_b64_tr_b16 v[100:101], v23 offset:14496
v_mfma_f32_16x16x32_bf16 v[48:51], v[104:107], v[24:27], v[48:51]
ds_read_b64_tr_b16 v[102:103], v23 offset:18080
ds_read_b64_tr_b16 v[104:105], v23 offset:21568
v_mfma_f32_16x16x32_bf16 v[52:55], v[108:111], v[24:27], v[52:55]
ds_read_b64_tr_b16 v[106:107], v23 offset:25152
s_add_u32 s33, s32, 51200
buffer_load_dwordx4 a[200:203], v3, s[44:47], s33 offen offset:0
s_waitcnt lgkmcnt(15)
v_mfma_f32_16x16x32_bf16 v[68:71], v[112:115], v[154:157], v[68:71]
v_mov_b64 v[24:25], v[152:153]
ds_read_b64_tr_b16 v[108:109], v23 offset:21600
v_mfma_f32_16x16x32_bf16 v[72:75], v[116:119], v[154:157], v[72:75]
v_mov_b64 v[26:27], v[158:159]
ds_read_b64_tr_b16 v[110:111], v23 offset:25184
v_mfma_f32_16x16x32_bf16 v[76:79], v[120:123], v[154:157], v[76:79]
v_add_u32 v6, 7168, v5
ds_read2_b32 v[200:201], v6 offset0:55 offset1:111
v_mfma_f32_16x16x32_bf16 v[80:83], v[124:127], v[154:157], v[80:83]
ds_read2_b32 v[202:203], v6 offset0:167 offset1:223
v_add_u32 v7, 32256, v5
v_mfma_f32_16x16x32_bf16 v[40:43], v[112:115], v[24:27], v[40:43]
ds_read_b64_tr_b16 v[112:113], v23 offset:21632
ds_read_b64_tr_b16 v[114:115], v23 offset:25216
v_mfma_f32_16x16x32_bf16 v[44:47], v[116:119], v[24:27], v[44:47]
ds_read_b64_tr_b16 v[116:117], v23 offset:21664
ds_read_b64_tr_b16 v[118:119], v23 offset:25248
v_mfma_f32_16x16x32_bf16 v[48:51], v[120:123], v[24:27], v[48:51]
ds_read2_b32 v[204:205], v7 offset0:55 offset1:111
ds_read2_b32 v[206:207], v7 offset0:167 offset1:223
v_mfma_f32_16x16x32_bf16 v[52:55], v[124:127], v[24:27], v[52:55]
v_add_u32 v6, 10752, v5
s_add_u32 s33, s32, 52224
buffer_load_dwordx4 a[204:207], v3, s[44:47], s33 offen offset:0
s_waitcnt lgkmcnt(15)
v_mfma_f32_16x16x32_bf16 v[68:71], v[128:131], v[162:165], v[68:71]
v_mov_b64 v[24:25], v[160:161]
ds_read2_b32 v[208:209], v6 offset0:55 offset1:111
v_mfma_f32_16x16x32_bf16 v[72:75], v[132:135], v[162:165], v[72:75]
v_mov_b64 v[26:27], v[166:167]
ds_read2_b32 v[210:211], v6 offset0:167 offset1:223
v_mfma_f32_16x16x32_bf16 v[76:79], v[136:139], v[162:165], v[76:79]
v_add_u32 v7, 35840, v5
ds_read2_b32 v[212:213], v7 offset0:55 offset1:111
v_mfma_f32_16x16x32_bf16 v[80:83], v[140:143], v[162:165], v[80:83]
ds_read2_b32 v[214:215], v7 offset0:167 offset1:223
v_add_u32 v6, 14336, v5
v_mfma_f32_16x16x32_bf16 v[40:43], v[128:131], v[24:27], v[40:43]
ds_read2_b32 v[152:153], v6 offset0:55 offset1:111
ds_read2_b32 v[154:155], v6 offset0:167 offset1:223
v_mfma_f32_16x16x32_bf16 v[44:47], v[132:135], v[24:27], v[44:47]
v_add_u32 v7, 39424, v5
ds_read2_b32 v[156:157], v7 offset0:55 offset1:111
v_mfma_f32_16x16x32_bf16 v[48:51], v[136:139], v[24:27], v[48:51]
ds_read2_b32 v[158:159], v7 offset0:167 offset1:223
s_waitcnt vmcnt(17)
v_min3_u32 v21, v216, v217, v218
v_mfma_f32_16x16x32_bf16 v[52:55], v[140:143], v[24:27], v[52:55]
v_max3_u32 v22, v216, v217, v218
s_add_u32 s33, s32, 53248
buffer_load_dwordx4 a[208:211], v3, s[44:47], s33 offen offset:0
s_waitcnt lgkmcnt(15)
v_mfma_f32_16x16x32_bf16 v[68:71], v[144:147], v[170:173], v[68:71]
v_mov_b64 v[24:25], v[168:169]
v_add_u32 v6, 17920, v5
v_mfma_f32_16x16x32_bf16 v[72:75], v[148:151], v[170:173], v[72:75]
v_mov_b64 v[26:27], v[174:175]
ds_read2_b32 v[160:161], v6 offset0:55 offset1:111
v_mfma_f32_16x16x32_bf16 v[76:79], v[96:99], v[170:173], v[76:79]
ds_read2_b32 v[162:163], v6 offset0:167 offset1:223
v_add_u32 v7, 43008, v5
v_mfma_f32_16x16x32_bf16 v[80:83], v[100:103], v[170:173], v[80:83]
ds_read2_b32 v[164:165], v7 offset0:55 offset1:111
ds_read2_b32 v[166:167], v7 offset0:167 offset1:223
v_mfma_f32_16x16x32_bf16 v[40:43], v[144:147], v[24:27], v[40:43]
v_min3_u32 v21, v21, v219, v220
v_max3_u32 v22, v22, v219, v220
v_mfma_f32_16x16x32_bf16 v[44:47], v[148:151], v[24:27], v[44:47]
v_min3_u32 v21, v21, v221, v222
v_max3_u32 v22, v22, v221, v222
v_mfma_f32_16x16x32_bf16 v[48:51], v[96:99], v[24:27], v[48:51]
v_min_u32 v21, v21, v223
v_max_u32 v22, v22, v223
v_mfma_f32_16x16x32_bf16 v[52:55], v[100:103], v[24:27], v[52:55]
v_xor_b32 v21, s6, v21
s_add_u32 s33, s32, 54272
buffer_load_dwordx4 a[212:215], v3, s[44:47], s33 offen offset:0
s_waitcnt lgkmcnt(14)
v_mfma_f32_16x16x32_bf16 v[68:71], v[104:107], v[178:181], v[68:71]
v_mov_b64 v[24:25], v[176:177]
v_add_u32 v6, 21504, v5
v_mfma_f32_16x16x32_bf16 v[72:75], v[108:111], v[178:181], v[72:75]
v_mov_b64 v[26:27], v[182:183]
ds_read2_b32 v[168:169], v6 offset0:55 offset1:111
v_mfma_f32_16x16x32_bf16 v[76:79], v[112:115], v[178:181], v[76:79]
ds_read2_b32 v[170:171], v6 offset0:167 offset1:223
v_add_u32 v7, 46592, v5
v_mfma_f32_16x16x32_bf16 v[80:83], v[116:119], v[178:181], v[80:83]
ds_read2_b32 v[172:173], v7 offset0:55 offset1:111
ds_read2_b32 v[174:175], v7 offset0:167 offset1:223
v_mfma_f32_16x16x32_bf16 v[40:43], v[104:107], v[24:27], v[40:43]
v_xor_b32 v22, s6, v22
v_or_b32 v21, v21, v22
v_mfma_f32_16x16x32_bf16 v[44:47], v[108:111], v[24:27], v[44:47]
v_cmp_ne_u32 vcc, 0, v21
v_mfma_f32_16x16x32_bf16 v[48:51], v[112:115], v[24:27], v[48:51]
v_mfma_f32_16x16x32_bf16 v[52:55], v[116:119], v[24:27], v[52:55]
s_waitcnt vmcnt(6)
s_cmp_lg_u32 s7, 0
s_cbranch_scc1 postc_57
buffer_store_dword v2, off, s[44:47], s13 offset:0
postb_58:
s_add_u32 s33, s32, 55296
buffer_load_dwordx4 a[216:219], v3, s[44:47], s33 offen offset:0
s_cbranch_vccnz flc_59
flb_60:
mid_61:
v_and_b32 v6, 48, v1
v_lshrrev_b32 v7, 1, v6
v_mov_b32 v148, v3
v_add_u32 v149, 4096, v3
v_add_u32 v150, 0x1140000, v3
s_waitcnt lgkmcnt(0)
v_pk_fma_f32 v[112:113], v[200:201], v[88:89], v[204:205] op_sel:[0,1,0] op_sel_hi:[1,1,1]
v_pk_fma_f32 v[114:115], v[202:203], v[88:89], v[206:207] op_sel:[0,1,0] op_sel_hi:[1,1,1]
v_pk_fma_f32 v[116:117], v[208:209], v[88:89], v[212:213] op_sel:[0,1,0] op_sel_hi:[1,1,1]
v_pk_fma_f32 v[118:119], v[210:211], v[88:89], v[214:215] op_sel:[0,1,0] op_sel_hi:[1,1,1]
v_pk_fma_f32 v[40:41], v[40:41], v[88:89], v[112:113] op_sel_hi:[1,0,1]
v_pk_fma_f32 v[42:43], v[42:43], v[88:89], v[114:115] op_sel_hi:[1,0,1]
v_pk_fma_f32 v[44:45], v[44:45], v[88:89], v[116:117] op_sel_hi:[1,0,1]
v_pk_fma_f32 v[46:47], v[46:47], v[88:89], v[118:119] op_sel_hi:[1,0,1]
buffer_load_dwordx4 v[136:139], v6, s[60:63], s30 offen
v_pk_fma_f32 v[112:113], v[40:41], v[40:41], v[92:93] neg_lo:[1,0,0] neg_hi:[1,0,0]
v_pk_fma_f32 v[114:115], v[42:43], v[42:43], v[92:93] neg_lo:[1,0,0] neg_hi:[1,0,0]
v_pk_fma_f32 v[116:117], v[44:45], v[44:45], v[92:93] neg_lo:[1,0,0] neg_hi:[1,0,0]
v_pk_fma_f32 v[118:119], v[46:47], v[46:47], v[92:93] neg_lo:[1,0,0] neg_hi:[1,0,0]
v_pk_mul_f32 v[112:113], v[112:113], v[40:41]
v_pk_mul_f32 v[114:115], v[114:115], v[42:43]
v_pk_mul_f32 v[116:117], v[116:117], v[44:45]
v_pk_mul_f32 v[118:119], v[118:119], v[46:47]
v_exp_f32 v112, v112
buffer_load_dwordx4 v[140:143], v6, s[60:63], s30 offen offset:64
v_exp_f32 v113, v113
v_exp_f32 v114, v114
v_exp_f32 v115, v115
v_exp_f32 v116, v116
v_exp_f32 v117, v117
v_exp_f32 v118, v118
v_exp_f32 v119, v119
v_pk_fma_f32 v[112:113], v[112:113], s[56:57], s[56:57]
v_pk_fma_f32 v[114:115], v[114:115], s[56:57], s[56:57]
buffer_load_dwordx2 v[144:145], v7, s[60:63], s30 offen offset:128
v_pk_fma_f32 v[116:117], v[116:117], s[56:57], s[56:57]
v_pk_fma_f32 v[118:119], v[118:119], s[56:57], s[56:57]
v_rcp_f32 v112, v112
v_rcp_f32 v113, v113
v_rcp_f32 v114, v114
v_rcp_f32 v115, v115
v_rcp_f32 v116, v116
v_rcp_f32 v117, v117
v_rcp_f32 v118, v118
s_add_u32 s9, s25, 0x840000
buffer_load_dwordx2 v[18:19], v28, s[44:47], s9 offen offset:0 sc1
buffer_load_dwordx2 v[20:21], v28, s[44:47], s9 offen offset:256 sc1
v_rcp_f32 v119, v119
v_pk_mul_f32 v[112:113], v[112:113], v[40:41]
v_pk_mul_f32 v[114:115], v[114:115], v[42:43]
v_pk_mul_f32 v[116:117], v[116:117], v[44:45]
v_pk_mul_f32 v[118:119], v[118:119], v[46:47]
v_cvt_pk_bf16_f32 v120, v112, v113
v_cvt_pk_bf16_f32 v121, v114, v115
v_cvt_pk_bf16_f32 v122, v116, v117
v_cvt_pk_bf16_f32 v123, v118, v119
buffer_store_dwordx4 v[120:123], v3, s[44:47], s26 offen offset:0
v_pk_fma_f32 v[124:125], v[200:201], v[90:91], v[204:205] op_sel:[0,1,0] op_sel_hi:[1,1,1]
v_pk_fma_f32 v[126:127], v[202:203], v[90:91], v[206:207] op_sel:[0,1,0] op_sel_hi:[1,1,1]
v_pk_fma_f32 v[128:129], v[208:209], v[90:91], v[212:213] op_sel:[0,1,0] op_sel_hi:[1,1,1]
v_pk_fma_f32 v[130:131], v[210:211], v[90:91], v[214:215] op_sel:[0,1,0] op_sel_hi:[1,1,1]
v_pk_fma_f32 v[68:69], v[68:69], v[90:91], v[124:125] op_sel_hi:[1,0,1]
v_pk_fma_f32 v[70:71], v[70:71], v[90:91], v[126:127] op_sel_hi:[1,0,1]
v_pk_fma_f32 v[72:73], v[72:73], v[90:91], v[128:129] op_sel_hi:[1,0,1]
v_pk_fma_f32 v[74:75], v[74:75], v[90:91], v[130:131] op_sel_hi:[1,0,1]
s_add_u32 s9, s25, 0x840000
buffer_load_dwordx2 v[22:23], v28, s[44:47], s9 offen offset:2048 sc1
buffer_load_dwordx2 v[24:25], v28, s[44:47], s9 offen offset:2304 sc1
buffer_load_dwordx2 v[26:27], v29, s[44:47], s9 offen sc1
v_pk_fma_f32 v[124:125], v[68:69], v[68:69], v[92:93] neg_lo:[1,0,0] neg_hi:[1,0,0]
v_pk_fma_f32 v[126:127], v[70:71], v[70:71], v[92:93] neg_lo:[1,0,0] neg_hi:[1,0,0]
v_pk_fma_f32 v[128:129], v[72:73], v[72:73], v[92:93] neg_lo:[1,0,0] neg_hi:[1,0,0]
v_pk_fma_f32 v[130:131], v[74:75], v[74:75], v[92:93] neg_lo:[1,0,0] neg_hi:[1,0,0]
v_pk_mul_f32 v[124:125], v[124:125], v[68:69]
v_pk_mul_f32 v[126:127], v[126:127], v[70:71]
v_pk_mul_f32 v[128:129], v[128:129], v[72:73]
v_pk_mul_f32 v[130:131], v[130:131], v[74:75]
v_exp_f32 v124, v124
s_add_u32 s33, s32, 56320
buffer_load_dwordx4 a[220:223], v3, s[44:47], s33 offen offset:0
v_exp_f32 v125, v125
v_exp_f32 v126, v126
v_exp_f32 v127, v127
v_exp_f32 v128, v128
v_exp_f32 v129, v129
v_exp_f32 v130, v130
v_exp_f32 v131, v131
v_pk_fma_f32 v[124:125], v[124:125], s[56:57], s[56:57]
v_pk_fma_f32 v[126:127], v[126:127], s[56:57], s[56:57]
s_add_u32 s33, s32, 57344
buffer_load_dwordx4 a[224:227], v3, s[44:47], s33 offen offset:0
v_pk_fma_f32 v[128:129], v[128:129], s[56:57], s[56:57]
v_pk_fma_f32 v[130:131], v[130:131], s[56:57], s[56:57]
v_rcp_f32 v124, v124
v_rcp_f32 v125, v125
v_rcp_f32 v126, v126
v_rcp_f32 v127, v127
v_rcp_f32 v128, v128
v_rcp_f32 v129, v129
v_rcp_f32 v130, v130
s_add_u32 s33, s32, 58368
buffer_load_dwordx4 a[228:231], v3, s[44:47], s33 offen offset:0
v_rcp_f32 v131, v131
v_pk_mul_f32 v[124:125], v[124:125], v[68:69]
v_pk_mul_f32 v[126:127], v[126:127], v[70:71]
v_pk_mul_f32 v[128:129], v[128:129], v[72:73]
v_pk_mul_f32 v[130:131], v[130:131], v[74:75]
v_cvt_pk_bf16_f32 v132, v124, v125
v_cvt_pk_bf16_f32 v133, v126, v127
v_cvt_pk_bf16_f32 v134, v128, v129
v_cvt_pk_bf16_f32 v135, v130, v131
buffer_store_dwordx4 v[132:135], v3, s[44:47], s27 offen offset:0
buffer_load_dword v30, v31, s[44:47], s12 offen offset:0 sc1
v_pk_fma_f32 v[112:113], v[152:153], v[88:89], v[156:157] op_sel:[0,1,0] op_sel_hi:[1,1,1]
v_pk_fma_f32 v[114:115], v[154:155], v[88:89], v[158:159] op_sel:[0,1,0] op_sel_hi:[1,1,1]
v_pk_fma_f32 v[116:117], v[160:161], v[88:89], v[164:165] op_sel:[0,1,0] op_sel_hi:[1,1,1]
v_pk_fma_f32 v[118:119], v[162:163], v[88:89], v[166:167] op_sel:[0,1,0] op_sel_hi:[1,1,1]
v_pk_fma_f32 v[48:49], v[48:49], v[88:89], v[112:113] op_sel_hi:[1,0,1]
v_pk_fma_f32 v[50:51], v[50:51], v[88:89], v[114:115] op_sel_hi:[1,0,1]
v_pk_fma_f32 v[52:53], v[52:53], v[88:89], v[116:117] op_sel_hi:[1,0,1]
v_pk_fma_f32 v[54:55], v[54:55], v[88:89], v[118:119] op_sel_hi:[1,0,1]
s_add_u32 s33, s32, 59392
buffer_load_dwordx4 a[232:235], v3, s[44:47], s33 offen offset:0
v_pk_fma_f32 v[112:113], v[48:49], v[48:49], v[92:93] neg_lo:[1,0,0] neg_hi:[1,0,0]
v_pk_fma_f32 v[114:115], v[50:51], v[50:51], v[92:93] neg_lo:[1,0,0] neg_hi:[1,0,0]
v_pk_fma_f32 v[116:117], v[52:53], v[52:53], v[92:93] neg_lo:[1,0,0] neg_hi:[1,0,0]
v_pk_fma_f32 v[118:119], v[54:55], v[54:55], v[92:93] neg_lo:[1,0,0] neg_hi:[1,0,0]
v_pk_mul_f32 v[112:113], v[112:113], v[48:49]
v_pk_mul_f32 v[114:115], v[114:115], v[50:51]
v_pk_mul_f32 v[116:117], v[116:117], v[52:53]
v_pk_mul_f32 v[118:119], v[118:119], v[54:55]
v_exp_f32 v112, v112
s_add_u32 s33, s32, 60416
buffer_load_dwordx4 a[236:239], v3, s[44:47], s33 offen offset:0
v_exp_f32 v113, v113
v_exp_f32 v114, v114
v_exp_f32 v115, v115
v_exp_f32 v116, v116
v_exp_f32 v117, v117
v_exp_f32 v118, v118
v_exp_f32 v119, v119
v_pk_fma_f32 v[112:113], v[112:113], s[56:57], s[56:57]
v_pk_fma_f32 v[114:115], v[114:115], s[56:57], s[56:57]
s_add_u32 s33, s32, 61440
buffer_load_dwordx4 a[240:243], v3, s[44:47], s33 offen offset:0
v_pk_fma_f32 v[116:117], v[116:117], s[56:57], s[56:57]
v_pk_fma_f32 v[118:119], v[118:119], s[56:57], s[56:57]
v_rcp_f32 v112, v112
v_rcp_f32 v113, v113
v_rcp_f32 v114, v114
v_rcp_f32 v115, v115
v_rcp_f32 v116, v116
v_rcp_f32 v117, v117
v_rcp_f32 v118, v118
s_add_u32 s33, s32, 62464
buffer_load_dwordx4 a[244:247], v3, s[44:47], s33 offen offset:0
v_rcp_f32 v119, v119
v_pk_mul_f32 v[112:113], v[112:113], v[48:49]
v_pk_mul_f32 v[114:115], v[114:115], v[50:51]
v_pk_mul_f32 v[116:117], v[116:117], v[52:53]
v_pk_mul_f32 v[118:119], v[118:119], v[54:55]
v_cvt_pk_bf16_f32 v120, v112, v113
v_cvt_pk_bf16_f32 v121, v114, v115
v_cvt_pk_bf16_f32 v122, v116, v117
v_cvt_pk_bf16_f32 v123, v118, v119
buffer_store_dwordx4 v[120:123], v3, s[44:47], s40 offen offset:0
s_waitcnt vmcnt(5)
v_cmp_ne_u32 vcc, s99, v30
s_nop 3
s_cbranch_vccnz chkc_62
chkb_63:
s_cmp_lg_u32 s7, 0
s_cbranch_scc1 postc_64
buffer_store_dword v2, off, s[44:47], s13 offset:256
postb_65:
v_pk_fma_f32 v[124:125], v[152:153], v[90:91], v[156:157] op_sel:[0,1,0] op_sel_hi:[1,1,1]
v_pk_fma_f32 v[126:127], v[154:155], v[90:91], v[158:159] op_sel:[0,1,0] op_sel_hi:[1,1,1]
v_pk_fma_f32 v[128:129], v[160:161], v[90:91], v[164:165] op_sel:[0,1,0] op_sel_hi:[1,1,1]
v_pk_fma_f32 v[130:131], v[162:163], v[90:91], v[166:167] op_sel:[0,1,0] op_sel_hi:[1,1,1]
buffer_load_dwordx4 v[184:187], v150, s[44:47], s20 offen offset:0 sc1
v_pk_fma_f32 v[76:77], v[76:77], v[90:91], v[124:125] op_sel_hi:[1,0,1]
v_pk_fma_f32 v[78:79], v[78:79], v[90:91], v[126:127] op_sel_hi:[1,0,1]
v_pk_fma_f32 v[80:81], v[80:81], v[90:91], v[128:129] op_sel_hi:[1,0,1]
v_pk_fma_f32 v[82:83], v[82:83], v[90:91], v[130:131] op_sel_hi:[1,0,1]
v_pk_fma_f32 v[124:125], v[76:77], v[76:77], v[92:93] neg_lo:[1,0,0] neg_hi:[1,0,0]
s_add_u32 s33, s32, 63488
buffer_load_dwordx4 a[248:251], v3, s[44:47], s33 offen offset:0
v_pk_fma_f32 v[126:127], v[78:79], v[78:79], v[92:93] neg_lo:[1,0,0] neg_hi:[1,0,0]
v_pk_fma_f32 v[128:129], v[80:81], v[80:81], v[92:93] neg_lo:[1,0,0] neg_hi:[1,0,0]
v_pk_fma_f32 v[130:131], v[82:83], v[82:83], v[92:93] neg_lo:[1,0,0] neg_hi:[1,0,0]
v_pk_mul_f32 v[124:125], v[124:125], v[76:77]
v_pk_mul_f32 v[126:127], v[126:127], v[78:79]
buffer_load_dwordx4 v[188:191], v150, s[44:47], s21 offen offset:0 sc1
v_pk_mul_f32 v[128:129], v[128:129], v[80:81]
v_pk_mul_f32 v[130:131], v[130:131], v[82:83]
v_exp_f32 v124, v124
v_exp_f32 v125, v125
v_exp_f32 v126, v126
s_add_u32 s33, s32, 64512
buffer_load_dwordx4 a[252:255], v3, s[44:47], s33 offen offset:0
v_exp_f32 v127, v127
v_exp_f32 v128, v128
v_exp_f32 v129, v129
v_exp_f32 v130, v130
v_exp_f32 v131, v131
buffer_load_dwordx4 v[192:195], v150, s[44:47], s22 offen offset:0 sc1
v_pk_fma_f32 v[124:125], v[124:125], s[56:57], s[56:57]
v_pk_fma_f32 v[126:127], v[126:127], s[56:57], s[56:57]
v_pk_fma_f32 v[128:129], v[128:129], s[56:57], s[56:57]
v_pk_fma_f32 v[130:131], v[130:131], s[56:57], s[56:57]
v_rcp_f32 v124, v124
s_add_u32 s33, s32, 65536
buffer_load_dwordx4 v[232:235], v3, s[44:47], s33 offen offset:0
v_rcp_f32 v125, v125
v_rcp_f32 v126, v126
v_rcp_f32 v127, v127
v_rcp_f32 v128, v128
v_rcp_f32 v129, v129
buffer_load_dwordx4 v[196:199], v150, s[44:47], s23 offen offset:0 sc1
v_rcp_f32 v130, v130
v_rcp_f32 v131, v131
v_pk_mul_f32 v[124:125], v[124:125], v[76:77]
v_pk_mul_f32 v[126:127], v[126:127], v[78:79]
v_pk_mul_f32 v[128:129], v[128:129], v[80:81]
s_add_u32 s33, s32, 66560
buffer_load_dwordx4 v[236:239], v3, s[44:47], s33 offen offset:0
v_pk_mul_f32 v[130:131], v[130:131], v[82:83]
v_cvt_pk_bf16_f32 v132, v124, v125
v_cvt_pk_bf16_f32 v133, v126, v127
v_cvt_pk_bf16_f32 v134, v128, v129
v_cvt_pk_bf16_f32 v135, v130, v131
buffer_store_dwordx4 v[132:135], v3, s[44:47], s41 offen offset:0
v_pk_fma_f32 v[112:113], v[168:169], v[88:89], v[172:173] op_sel:[0,1,0] op_sel_hi:[1,1,1]
v_pk_fma_f32 v[114:115], v[170:171], v[88:89], v[174:175] op_sel:[0,1,0] op_sel_hi:[1,1,1]
v_pk_fma_f32 v[116:117], v[168:169], v[90:91], v[172:173] op_sel:[0,1,0] op_sel_hi:[1,1,1]
v_pk_fma_f32 v[118:119], v[170:171], v[90:91], v[174:175] op_sel:[0,1,0] op_sel_hi:[1,1,1]
buffer_load_dwordx4 v[224:227], v150, s[44:47], s20 offen offset:1024 sc1
v_pk_fma_f32 v[56:57], v[56:57], v[88:89], v[112:113] op_sel_hi:[1,0,1]
v_pk_fma_f32 v[58:59], v[58:59], v[88:89], v[114:115] op_sel_hi:[1,0,1]
v_pk_fma_f32 v[84:85], v[84:85], v[90:91], v[116:117] op_sel_hi:[1,0,1]
v_pk_fma_f32 v[86:87], v[86:87], v[90:91], v[118:119] op_sel_hi:[1,0,1]
v_pk_fma_f32 v[112:113], v[56:57], v[56:57], v[92:93] neg_lo:[1,0,0] neg_hi:[1,0,0]
s_add_u32 s33, s32, 67584
buffer_load_dwordx4 v[240:243], v3, s[44:47], s33 offen offset:0
v_pk_fma_f32 v[114:115], v[58:59], v[58:59], v[92:93] neg_lo:[1,0,0] neg_hi:[1,0,0]
v_pk_fma_f32 v[116:117], v[84:85], v[84:85], v[92:93] neg_lo:[1,0,0] neg_hi:[1,0,0]
v_pk_fma_f32 v[118:119], v[86:87], v[86:87], v[92:93] neg_lo:[1,0,0] neg_hi:[1,0,0]
v_pk_mul_f32 v[112:113], v[112:113], v[56:57]
v_pk_mul_f32 v[114:115], v[114:115], v[58:59]
buffer_load_dwordx4 v[228:231], v150, s[44:47], s21 offen offset:1024 sc1
v_pk_mul_f32 v[116:117], v[116:117], v[84:85]
v_pk_mul_f32 v[118:119], v[118:119], v[86:87]
v_exp_f32 v112, v112
v_exp_f32 v113, v113
v_exp_f32 v114, v114
s_add_u32 s33, s32, 68608
buffer_load_dwordx4 v[244:247], v3, s[44:47], s33 offen offset:0
v_exp_f32 v115, v115
v_exp_f32 v116, v116
v_exp_f32 v117, v117
v_exp_f32 v118, v118
v_exp_f32 v119, v119
buffer_load_dwordx4 v[216:219], v150, s[44:47], s22 offen offset:1024 sc1
v_pk_fma_f32 v[112:113], v[112:113], s[56:57], s[56:57]
v_pk_fma_f32 v[114:115], v[114:115], s[56:57], s[56:57]
v_pk_fma_f32 v[116:117], v[116:117], s[56:57], s[56:57]
v_pk_fma_f32 v[118:119], v[118:119], s[56:57], s[56:57]
v_rcp_f32 v112, v112
s_add_u32 s33, s32, 69632
buffer_load_dwordx4 v[248:251], v3, s[44:47], s33 offen offset:0
v_rcp_f32 v113, v113
v_rcp_f32 v114, v114
v_rcp_f32 v115, v115
v_rcp_f32 v116, v116
v_rcp_f32 v117, v117
buffer_load_dwordx4 v[220:223], v150, s[44:47], s23 offen offset:1024 sc1
v_rcp_f32 v118, v118
v_rcp_f32 v119, v119
v_pk_mul_f32 v[112:113], v[112:113], v[56:57]
v_pk_mul_f32 v[114:115], v[114:115], v[58:59]
v_pk_mul_f32 v[116:117], v[116:117], v[84:85]
s_add_u32 s33, s32, 70656
buffer_load_dwordx4 v[252:255], v3, s[44:47], s33 offen offset:0
v_pk_mul_f32 v[118:119], v[118:119], v[86:87]
v_cvt_pk_bf16_f32 v120, v112, v113
v_cvt_pk_bf16_f32 v121, v114, v115
v_cvt_pk_bf16_f32 v122, v116, v117
v_cvt_pk_bf16_f32 v123, v118, v119
v_cndmask_b32 v120, 0, v120, s[58:59]
v_cndmask_b32 v121, 0, v121, s[58:59]
v_cndmask_b32 v122, 0, v122, s[58:59]
v_cndmask_b32 v123, 0, v123, s[58:59]
buffer_store_dwordx2 v[120:121], v3, s[44:47], s28 offen
buffer_store_dwordx2 v[122:123], v3, s[44:47], s29 offen
s_waitcnt vmcnt(18)
v_mfma_f32_16x16x32_bf16 v[32:35], a[0:3], v[184:187], 0
buffer_load_dwordx4 v[176:179], v150, s[44:47], s20 offen offset:2048 sc1
s_mul_i32 s8, s5, 5120
v_mfma_f32_16x16x32_bf16 v[36:39], a[4:7], v[184:187], 0
s_add_u32 s8, s8, 143360
v_add_u32 v4, s8, v3
v_mfma_f32_16x16x32_bf16 v[40:43], a[8:11], v[184:187], 0
s_add_u32 s8, s5, 3
s_and_b32 s8, s8, 3
v_mfma_f32_16x16x32_bf16 v[44:47], a[12:15], v[184:187], 0
s_mul_i32 s8, s8, 5120
s_add_u32 s8, s8, 143360
v_mfma_f32_16x16x32_bf16 v[48:51], a[16:19], v[184:187], 0
buffer_load_dwordx4 v[180:183], v150, s[44:47], s21 offen offset:2048 sc1
s_waitcnt vmcnt(18)
v_mfma_f32_16x16x32_bf16 v[52:55], a[0:3], v[188:191], 0
v_add_u32 v5, s8, v3
v_mfma_f32_16x16x32_bf16 v[56:59], a[4:7], v[188:191], 0
v_mfma_f32_16x16x32_bf16 v[60:63], a[8:11], v[188:191], 0
v_mfma_f32_16x16x32_bf16 v[64:67], a[12:15], v[188:191], 0
buffer_load_dwordx4 v[200:203], v150, s[44:47], s22 offen offset:2048 sc1
v_mfma_f32_16x16x32_bf16 v[68:71], a[16:19], v[188:191], 0
s_waitcnt vmcnt(17)
v_mfma_f32_16x16x32_bf16 v[72:75], a[0:3], v[192:195], 0
v_mfma_f32_16x16x32_bf16 v[76:79], a[4:7], v[192:195], 0
v_mfma_f32_16x16x32_bf16 v[80:83], a[8:11], v[192:195], 0
buffer_load_dwordx4 v[204:207], v150, s[44:47], s23 offen offset:2048 sc1
v_mfma_f32_16x16x32_bf16 v[84:87], a[12:15], v[192:195], 0
v_mfma_f32_16x16x32_bf16 v[88:91], a[16:19], v[192:195], 0
s_waitcnt vmcnt(16)
v_mfma_f32_16x16x32_bf16 v[92:95], a[0:3], v[196:199], 0
v_mfma_f32_16x16x32_bf16 v[96:99], a[4:7], v[196:199], 0
buffer_load_dwordx4 v[208:211], v150, s[44:47], s20 offen offset:3072 sc1
v_mfma_f32_16x16x32_bf16 v[100:103], a[8:11], v[196:199], 0
v_mfma_f32_16x16x32_bf16 v[104:107], a[12:15], v[196:199], 0
v_mfma_f32_16x16x32_bf16 v[108:111], a[16:19], v[196:199], 0
s_waitcnt vmcnt(14)
v_mfma_f32_16x16x32_bf16 v[32:35], a[20:23], v[224:227], v[32:35]
buffer_load_dword v7, v31, s[44:47], s12 offen offset:256 sc1
v_mfma_f32_16x16x32_bf16 v[36:39], a[24:27], v[224:227], v[36:39]
buffer_load_dwordx4 v[212:215], v150, s[44:47], s21 offen offset:3072 sc1
s_lshl_b32 s8, s64, 1
v_mfma_f32_16x16x32_bf16 v[40:43], a[28:31], v[224:227], v[40:43]
s_add_u32 s8, s8, s66
s_lshl_b32 s8, s8, 2
v_mfma_f32_16x16x32_bf16 v[44:47], a[32:35], v[224:227], v[44:47]
s_add_u32 s8, s8, s5
s_lshl_b32 s8, s8, 11
v_mfma_f32_16x16x32_bf16 v[48:51], a[36:39], v[224:227], v[48:51]
s_add_u32 s17, s8, 0x20000
s_waitcnt vmcnt(14)
v_mfma_f32_16x16x32_bf16 v[52:55], a[20:23], v[228:231], v[52:55]
buffer_load_dwordx4 v[184:187], v150, s[44:47], s22 offen offset:3072 sc1
s_lshl_b32 s33, s67, 8
v_mfma_f32_16x16x32_bf16 v[56:59], a[24:27], v[228:231], v[56:59]
s_add_u32 s33, s33, s17
v_mfma_f32_16x16x32_bf16 v[60:63], a[28:31], v[228:231], v[60:63]
v_mfma_f32_16x16x32_bf16 v[64:67], a[32:35], v[228:231], v[64:67]
v_mfma_f32_16x16x32_bf16 v[68:71], a[36:39], v[228:231], v[68:71]
buffer_load_dwordx4 v[188:191], v150, s[44:47], s23 offen offset:3072 sc1
s_waitcnt vmcnt(14)
v_mfma_f32_16x16x32_bf16 v[72:75], a[20:23], v[216:219], v[72:75]
s_waitcnt vmcnt(9)
s_cmp_lg_u32 s7, 0
s_cbranch_scc1 postc_66
buffer_store_dword v2, off, s[44:47], s13 offset:512
postb_67:
v_mfma_f32_16x16x32_bf16 v[76:79], a[24:27], v[216:219], v[76:79]
v_lshlrev_b32 v152, 16, v8
v_and_b32 v153, s14, v8
v_mfma_f32_16x16x32_bf16 v[80:83], a[28:31], v[216:219], v[80:83]
v_lshlrev_b32 v172, 16, v136
v_and_b32 v173, s14, v136
v_mfma_f32_16x16x32_bf16 v[84:87], a[32:35], v[216:219], v[84:87]
v_add_f32 v152, v152, v172
v_add_f32 v153, v153, v173
v_mfma_f32_16x16x32_bf16 v[88:91], a[36:39], v[216:219], v[88:91]
v_lshlrev_b32 v154, 16, v9
v_mfma_f32_16x16x32_bf16 v[92:95], a[20:23], v[220:223], v[92:95]
v_and_b32 v155, s14, v9
v_lshlrev_b32 v174, 16, v137
v_mfma_f32_16x16x32_bf16 v[96:99], a[24:27], v[220:223], v[96:99]
v_and_b32 v175, s14, v137
v_add_f32 v154, v154, v174
v_mfma_f32_16x16x32_bf16 v[100:103], a[28:31], v[220:223], v[100:103]
v_add_f32 v155, v155, v175
v_lshlrev_b32 v156, 16, v10
v_mfma_f32_16x16x32_bf16 v[104:107], a[32:35], v[220:223], v[104:107]
v_and_b32 v157, s14, v10
v_lshlrev_b32 v172, 16, v138
v_mfma_f32_16x16x32_bf16 v[108:111], a[36:39], v[220:223], v[108:111]
v_and_b32 v173, s14, v138
s_waitcnt vmcnt(9)
v_mfma_f32_16x16x32_bf16 v[32:35], a[40:43], v[176:179], v[32:35]
s_waitcnt vmcnt(4)
v_cmp_ne_u32 vcc, s99, v7
v_mfma_f32_16x16x32_bf16 v[36:39], a[44:47], v[176:179], v[36:39]
v_add_f32 v156, v156, v172
v_add_f32 v157, v157, v173
v_mfma_f32_16x16x32_bf16 v[40:43], a[48:51], v[176:179], v[40:43]
v_lshlrev_b32 v158, 16, v11
v_and_b32 v159, s14, v11
v_mfma_f32_16x16x32_bf16 v[44:47], a[52:55], v[176:179], v[44:47]
s_cbranch_vccnz chkc_68
chkb_69:
v_mfma_f32_16x16x32_bf16 v[48:51], a[56:59], v[176:179], v[48:51]
buffer_load_dwordx4 v[192:195], v148, s[44:47], s22 offen offset:0 sc1
v_mfma_f32_16x16x32_bf16 v[52:55], a[40:43], v[180:183], v[52:55]
v_lshlrev_b32 v174, 16, v139
v_and_b32 v175, s14, v139
v_mfma_f32_16x16x32_bf16 v[56:59], a[44:47], v[180:183], v[56:59]
v_add_f32 v158, v158, v174
v_add_f32 v159, v159, v175
v_mfma_f32_16x16x32_bf16 v[60:63], a[48:51], v[180:183], v[60:63]
v_lshlrev_b32 v160, 16, v12
v_and_b32 v161, s14, v12
v_mfma_f32_16x16x32_bf16 v[64:67], a[52:55], v[180:183], v[64:67]
buffer_load_dwordx4 v[196:199], v148, s[44:47], s23 offen offset:0 sc1
v_lshlrev_b32 v172, 16, v140
v_mfma_f32_16x16x32_bf16 v[68:71], a[56:59], v[180:183], v[68:71]
v_and_b32 v173, s14, v140
v_mfma_f32_16x16x32_bf16 v[72:75], a[40:43], v[200:203], v[72:75]
v_add_f32 v160, v160, v172
v_add_f32 v161, v161, v173
v_mfma_f32_16x16x32_bf16 v[76:79], a[44:47], v[200:203], v[76:79]
v_lshlrev_b32 v162, 16, v13
v_and_b32 v163, s14, v13
v_mfma_f32_16x16x32_bf16 v[80:83], a[48:51], v[200:203], v[80:83]
buffer_load_dwordx4 v[224:227], v148, s[44:47], s22 offen offset:1024 sc1
v_lshlrev_b32 v174, 16, v141
v_mfma_f32_16x16x32_bf16 v[84:87], a[52:55], v[200:203], v[84:87]
v_and_b32 v175, s14, v141
v_add_f32 v162, v162, v174
v_mfma_f32_16x16x32_bf16 v[88:91], a[56:59], v[200:203], v[88:91]
v_add_f32 v163, v163, v175
v_mfma_f32_16x16x32_bf16 v[92:95], a[40:43], v[204:207], v[92:95]
v_lshlrev_b32 v164, 16, v14
v_and_b32 v165, s14, v14
v_mfma_f32_16x16x32_bf16 v[96:99], a[44:47], v[204:207], v[96:99]
buffer_load_dwordx4 v[228:231], v148, s[44:47], s23 offen offset:1024 sc1
v_lshlrev_b32 v172, 16, v142
v_mfma_f32_16x16x32_bf16 v[100:103], a[48:51], v[204:207], v[100:103]
v_and_b32 v173, s14, v142
v_add_f32 v164, v164, v172
v_mfma_f32_16x16x32_bf16 v[104:107], a[52:55], v[204:207], v[104:107]
v_add_f32 v165, v165, v173
v_lshlrev_b32 v166, 16, v15
v_mfma_f32_16x16x32_bf16 v[108:111], a[56:59], v[204:207], v[108:111]
v_and_b32 v167, s14, v15
v_mfma_f32_16x16x32_bf16 v[32:35], a[60:63], v[208:211], v[32:35]
buffer_load_dword v30, v31, s[44:47], s12 offen offset:512 sc1
v_mfma_f32_16x16x32_bf16 v[36:39], a[64:67], v[208:211], v[36:39]
buffer_load_dwordx4 v[216:219], v148, s[44:47], s22 offen offset:2048 sc1
v_lshlrev_b32 v174, 16, v143
v_mfma_f32_16x16x32_bf16 v[40:43], a[68:71], v[208:211], v[40:43]
v_and_b32 v175, s14, v143
v_add_f32 v166, v166, v174
v_mfma_f32_16x16x32_bf16 v[44:47], a[72:75], v[208:211], v[44:47]
v_add_f32 v167, v167, v175
v_lshlrev_b32 v168, 16, v16
v_mfma_f32_16x16x32_bf16 v[48:51], a[76:79], v[208:211], v[48:51]
v_and_b32 v169, s14, v16
s_waitcnt vmcnt(9)
v_mfma_f32_16x16x32_bf16 v[52:55], a[60:63], v[212:215], v[52:55]
buffer_load_dwordx4 v[220:223], v148, s[44:47], s23 offen offset:2048 sc1
v_lshlrev_b32 v172, 16, v144
v_mfma_f32_16x16x32_bf16 v[56:59], a[64:67], v[212:215], v[56:59]
v_and_b32 v173, s14, v144
v_add_f32 v168, v168, v172
v_mfma_f32_16x16x32_bf16 v[60:63], a[68:71], v[212:215], v[60:63]
v_add_f32 v169, v169, v173
v_lshlrev_b32 v170, 16, v17
v_mfma_f32_16x16x32_bf16 v[64:67], a[72:75], v[212:215], v[64:67]
v_and_b32 v171, s14, v17
v_lshlrev_b32 v174, 16, v145
v_mfma_f32_16x16x32_bf16 v[68:71], a[76:79], v[212:215], v[68:71]
buffer_load_dwordx4 v[176:179], v148, s[44:47], s22 offen offset:3072 sc1
s_waitcnt vmcnt(10)
v_mfma_f32_16x16x32_bf16 v[72:75], a[60:63], v[184:187], v[72:75]
v_and_b32 v175, s14, v145
v_add_f32 v170, v170, v174
v_mfma_f32_16x16x32_bf16 v[76:79], a[64:67], v[184:187], v[76:79]
v_add_f32 v171, v171, v175
v_mfma_f32_16x16x32_bf16 v[80:83], a[68:71], v[184:187], v[80:83]
v_mfma_f32_16x16x32_bf16 v[84:87], a[72:75], v[184:187], v[84:87]
buffer_load_dwordx4 v[180:183], v148, s[44:47], s23 offen offset:3072 sc1
v_mfma_f32_16x16x32_bf16 v[88:91], a[76:79], v[184:187], v[88:91]
s_waitcnt vmcnt(10)
v_mfma_f32_16x16x32_bf16 v[92:95], a[60:63], v[188:191], v[92:95]
v_mfma_f32_16x16x32_bf16 v[96:99], a[64:67], v[188:191], v[96:99]
v_mfma_f32_16x16x32_bf16 v[100:103], a[68:71], v[188:191], v[100:103]
v_mfma_f32_16x16x32_bf16 v[104:107], a[72:75], v[188:191], v[104:107]
v_mfma_f32_16x16x32_bf16 v[108:111], a[76:79], v[188:191], v[108:111]
s_waitcnt vmcnt(8)
v_mfma_f32_16x16x32_bf16 v[72:75], a[80:83], v[192:195], v[72:75]
v_mfma_f32_16x16x32_bf16 v[76:79], a[84:87], v[192:195], v[76:79]
v_mfma_f32_16x16x32_bf16 v[80:83], a[88:91], v[192:195], v[80:83]
v_mfma_f32_16x16x32_bf16 v[84:87], a[92:95], v[192:195], v[84:87]
v_mfma_f32_16x16x32_bf16 v[88:91], a[96:99], v[192:195], v[88:91]
s_waitcnt vmcnt(7)
v_mfma_f32_16x16x32_bf16 v[92:95], a[80:83], v[196:199], v[92:95]
v_mfma_f32_16x16x32_bf16 v[96:99], a[84:87], v[196:199], v[96:99]
v_mfma_f32_16x16x32_bf16 v[100:103], a[88:91], v[196:199], v[100:103]
v_mfma_f32_16x16x32_bf16 v[104:107], a[92:95], v[196:199], v[104:107]
v_mfma_f32_16x16x32_bf16 v[108:111], a[96:99], v[196:199], v[108:111]
s_waitcnt vmcnt(6)
v_mfma_f32_16x16x32_bf16 v[72:75], a[100:103], v[224:227], v[72:75]
s_waitcnt vmcnt(4)
v_cmp_ne_u32 vcc, s99, v30
v_mfma_f32_16x16x32_bf16 v[76:79], a[104:107], v[224:227], v[76:79]
v_mfma_f32_16x16x32_bf16 v[80:83], a[108:111], v[224:227], v[80:83]
v_mfma_f32_16x16x32_bf16 v[84:87], a[112:115], v[224:227], v[84:87]
s_nop 0
s_cbranch_vccnz chkc_70
chkb_71:
v_mfma_f32_16x16x32_bf16 v[88:91], a[116:119], v[224:227], v[88:91]
buffer_load_dwordx4 v[200:203], v148, s[44:47], s97 offen offset:0 sc1
v_mfma_f32_16x16x32_bf16 v[92:95], a[100:103], v[228:231], v[92:95]
v_mfma_f32_16x16x32_bf16 v[96:99], a[104:107], v[228:231], v[96:99]
v_mfma_f32_16x16x32_bf16 v[100:103], a[108:111], v[228:231], v[100:103]
v_mfma_f32_16x16x32_bf16 v[104:107], a[112:115], v[228:231], v[104:107]
buffer_load_dwordx4 v[204:207], v148, s[44:47], s97 offen offset:1024 sc1
v_mfma_f32_16x16x32_bf16 v[108:111], a[116:119], v[228:231], v[108:111]
s_waitcnt vmcnt(5)
v_mfma_f32_16x16x32_bf16 v[72:75], a[120:123], v[216:219], v[72:75]
v_mfma_f32_16x16x32_bf16 v[76:79], a[124:127], v[216:219], v[76:79]
v_mfma_f32_16x16x32_bf16 v[80:83], a[128:131], v[216:219], v[80:83]
buffer_load_dwordx4 v[208:211], v148, s[44:47], s97 offen offset:2048 sc1
v_mfma_f32_16x16x32_bf16 v[84:87], a[132:135], v[216:219], v[84:87]
v_mfma_f32_16x16x32_bf16 v[88:91], a[136:139], v[216:219], v[88:91]
s_waitcnt vmcnt(5)
v_mfma_f32_16x16x32_bf16 v[92:95], a[120:123], v[220:223], v[92:95]
v_mfma_f32_16x16x32_bf16 v[96:99], a[124:127], v[220:223], v[96:99]
buffer_load_dwordx4 v[212:215], v148, s[44:47], s97 offen offset:3072 sc1
v_mfma_f32_16x16x32_bf16 v[100:103], a[128:131], v[220:223], v[100:103]
v_mfma_f32_16x16x32_bf16 v[104:107], a[132:135], v[220:223], v[104:107]
v_mfma_f32_16x16x32_bf16 v[108:111], a[136:139], v[220:223], v[108:111]
s_waitcnt vmcnt(5)
v_mfma_f32_16x16x32_bf16 v[72:75], a[140:143], v[176:179], v[72:75]
buffer_load_dwordx4 v[184:187], v149, s[44:47], s23 offen offset:0 sc1
v_mfma_f32_16x16x32_bf16 v[76:79], a[144:147], v[176:179], v[76:79]
v_mfma_f32_16x16x32_bf16 v[80:83], a[148:151], v[176:179], v[80:83]
v_mfma_f32_16x16x32_bf16 v[84:87], a[152:155], v[176:179], v[84:87]
v_mfma_f32_16x16x32_bf16 v[88:91], a[156:159], v[176:179], v[88:91]
buffer_load_dwordx4 v[188:191], v149, s[44:47], s97 offen offset:0 sc1
s_waitcnt vmcnt(6)
v_mfma_f32_16x16x32_bf16 v[92:95], a[140:143], v[180:183], v[92:95]
v_mfma_f32_16x16x32_bf16 v[96:99], a[144:147], v[180:183], v[96:99]
v_mfma_f32_16x16x32_bf16 v[100:103], a[148:151], v[180:183], v[100:103]
v_mfma_f32_16x16x32_bf16 v[104:107], a[152:155], v[180:183], v[104:107]
buffer_load_dwordx4 v[192:195], v148, s[44:47], s96 offen offset:0 sc1
v_mfma_f32_16x16x32_bf16 v[108:111], a[156:159], v[180:183], v[108:111]
s_waitcnt vmcnt(6)
v_mfma_f32_16x16x32_bf16 v[92:95], a[160:163], v[200:203], v[92:95]
v_mfma_f32_16x16x32_bf16 v[96:99], a[164:167], v[200:203], v[96:99]
v_mfma_f32_16x16x32_bf16 v[100:103], a[168:171], v[200:203], v[100:103]
buffer_load_dwordx4 v[196:199], v148, s[44:47], s96 offen offset:1024 sc1
v_mfma_f32_16x16x32_bf16 v[104:107], a[172:175], v[200:203], v[104:107]
v_mfma_f32_16x16x32_bf16 v[108:111], a[176:179], v[200:203], v[108:111]
s_waitcnt vmcnt(6)
v_mfma_f32_16x16x32_bf16 v[92:95], a[180:183], v[204:207], v[92:95]
v_mfma_f32_16x16x32_bf16 v[96:99], a[184:187], v[204:207], v[96:99]
buffer_load_dwordx4 v[224:227], v148, s[44:47], s96 offen offset:2048 sc1
v_mfma_f32_16x16x32_bf16 v[100:103], a[188:191], v[204:207], v[100:103]
v_mfma_f32_16x16x32_bf16 v[104:107], a[192:195], v[204:207], v[104:107]
v_mfma_f32_16x16x32_bf16 v[108:111], a[196:199], v[204:207], v[108:111]
s_waitcnt vmcnt(6)
v_mfma_f32_16x16x32_bf16 v[92:95], a[200:203], v[208:211], v[92:95]
buffer_load_dwordx4 v[228:231], v148, s[44:47], s96 offen offset:3072 sc1
v_mfma_f32_16x16x32_bf16 v[96:99], a[204:207], v[208:211], v[96:99]
v_mfma_f32_16x16x32_bf16 v[100:103], a[208:211], v[208:211], v[100:103]
v_mfma_f32_16x16x32_bf16 v[104:107], a[212:215], v[208:211], v[104:107]
v_mfma_f32_16x16x32_bf16 v[108:111], a[216:219], v[208:211], v[108:111]
buffer_load_dwordx4 v[216:219], v149, s[44:47], s22 offen offset:0 sc1
s_waitcnt vmcnt(7)
v_mfma_f32_16x16x32_bf16 v[92:95], a[220:223], v[212:215], v[92:95]
v_mfma_f32_16x16x32_bf16 v[96:99], a[224:227], v[212:215], v[96:99]
v_mfma_f32_16x16x32_bf16 v[100:103], a[228:231], v[212:215], v[100:103]
v_mfma_f32_16x16x32_bf16 v[104:107], a[232:235], v[212:215], v[104:107]
buffer_load_dwordx4 v[220:223], v149, s[44:47], s96 offen offset:0 sc1
v_mfma_f32_16x16x32_bf16 v[108:111], a[236:239], v[212:215], v[108:111]
s_waitcnt vmcnt(7)
v_mfma_f32_16x16x32_bf16 v[92:95], a[240:243], v[184:187], v[92:95]
v_mfma_f32_16x16x32_bf16 v[96:99], a[244:247], v[184:187], v[96:99]
v_mfma_f32_16x16x32_bf16 v[100:103], a[248:251], v[184:187], v[100:103]
buffer_load_dwordx4 v[176:179], v148, s[44:47], s21 offen offset:0 sc1
v_mfma_f32_16x16x32_bf16 v[104:107], a[252:255], v[184:187], v[104:107]
v_mfma_f32_16x16x32_bf16 v[108:111], v[232:235], v[184:187], v[108:111]
s_waitcnt vmcnt(7)
v_mfma_f32_16x16x32_bf16 v[92:95], v[236:239], v[188:191], v[92:95]
v_mfma_f32_16x16x32_bf16 v[96:99], v[240:243], v[188:191], v[96:99]
buffer_load_dwordx4 v[180:183], v148, s[44:47], s21 offen offset:1024 sc1
v_mfma_f32_16x16x32_bf16 v[100:103], v[244:247], v[188:191], v[100:103]
v_mfma_f32_16x16x32_bf16 v[104:107], v[248:251], v[188:191], v[104:107]
v_mfma_f32_16x16x32_bf16 v[108:111], v[252:255], v[188:191], v[108:111]
s_waitcnt vmcnt(7)
v_mfma_f32_16x16x32_bf16 v[72:75], a[160:163], v[192:195], v[72:75]
buffer_load_dwordx4 v[200:203], v148, s[44:47], s21 offen offset:2048 sc1
v_mfma_f32_16x16x32_bf16 v[76:79], a[164:167], v[192:195], v[76:79]
ds_write_b128 v4, v[92:95] offset:0
v_mfma_f32_16x16x32_bf16 v[80:83], a[168:171], v[192:195], v[80:83]
v_mfma_f32_16x16x32_bf16 v[84:87], a[172:175], v[192:195], v[84:87]
ds_write_b128 v4, v[96:99] offset:1024
v_mfma_f32_16x16x32_bf16 v[88:91], a[176:179], v[192:195], v[88:91]
buffer_load_dwordx4 v[204:207], v148, s[44:47], s21 offen offset:3072 sc1
s_waitcnt vmcnt(8)
v_mfma_f32_16x16x32_bf16 v[72:75], a[180:183], v[196:199], v[72:75]
v_mfma_f32_16x16x32_bf16 v[76:79], a[184:187], v[196:199], v[76:79]
ds_write_b128 v4, v[100:103] offset:2048
v_mfma_f32_16x16x32_bf16 v[80:83], a[188:191], v[196:199], v[80:83]
v_mfma_f32_16x16x32_bf16 v[84:87], a[192:195], v[196:199], v[84:87]
buffer_load_dwordx4 v[208:211], v148, s[44:47], s43 offen offset:0 sc1
v_mfma_f32_16x16x32_bf16 v[88:91], a[196:199], v[196:199], v[88:91]
s_waitcnt vmcnt(8)
v_mfma_f32_16x16x32_bf16 v[72:75], a[200:203], v[224:227], v[72:75]
ds_write_b128 v4, v[104:107] offset:3072
v_mfma_f32_16x16x32_bf16 v[76:79], a[204:207], v[224:227], v[76:79]
v_mfma_f32_16x16x32_bf16 v[80:83], a[208:211], v[224:227], v[80:83]
buffer_load_dwordx4 v[212:215], v148, s[44:47], s43 offen offset:1024 sc1
v_mfma_f32_16x16x32_bf16 v[84:87], a[212:215], v[224:227], v[84:87]
ds_write_b128 v4, v[108:111] offset:4096
v_mfma_f32_16x16x32_bf16 v[88:91], a[216:219], v[224:227], v[88:91]
s_waitcnt vmcnt(8)
v_mfma_f32_16x16x32_bf16 v[72:75], a[220:223], v[228:231], v[72:75]
v_mfma_f32_16x16x32_bf16 v[76:79], a[224:227], v[228:231], v[76:79]
buffer_load_dwordx4 v[184:187], v148, s[44:47], s43 offen offset:2048 sc1
v_mfma_f32_16x16x32_bf16 v[80:83], a[228:231], v[228:231], v[80:83]
v_mfma_f32_16x16x32_bf16 v[84:87], a[232:235], v[228:231], v[84:87]
s_waitcnt lgkmcnt(0)
s_barrier
v_mfma_f32_16x16x32_bf16 v[88:91], a[236:239], v[228:231], v[88:91]
ds_read_b128 v[112:115], v5 offset:0
s_waitcnt vmcnt(8)
v_mfma_f32_16x16x32_bf16 v[72:75], a[240:243], v[216:219], v[72:75]
buffer_load_dwordx4 v[188:191], v148, s[44:47], s43 offen offset:3072 sc1
ds_read_b128 v[116:119], v5 offset:1024
v_mfma_f32_16x16x32_bf16 v[76:79], a[244:247], v[216:219], v[76:79]
ds_read_b128 v[120:123], v5 offset:2048
ds_read_b128 v[124:127], v5 offset:3072
v_mfma_f32_16x16x32_bf16 v[80:83], a[248:251], v[216:219], v[80:83]
ds_read_b128 v[128:131], v5 offset:4096
v_mfma_f32_16x16x32_bf16 v[84:87], a[252:255], v[216:219], v[84:87]
v_mfma_f32_16x16x32_bf16 v[88:91], v[232:235], v[216:219], v[88:91]
buffer_load_dwordx4 v[192:195], v149, s[44:47], s21 offen offset:0 sc1
s_waitcnt vmcnt(9)
v_mfma_f32_16x16x32_bf16 v[72:75], v[236:239], v[220:223], v[72:75]
v_mfma_f32_16x16x32_bf16 v[76:79], v[240:243], v[220:223], v[76:79]
v_mfma_f32_16x16x32_bf16 v[80:83], v[244:247], v[220:223], v[80:83]
v_mfma_f32_16x16x32_bf16 v[84:87], v[248:251], v[220:223], v[84:87]
buffer_load_dwordx4 v[196:199], v149, s[44:47], s43 offen offset:0 sc1
v_mfma_f32_16x16x32_bf16 v[88:91], v[252:255], v[220:223], v[88:91]
s_waitcnt vmcnt(9)
v_mfma_f32_16x16x32_bf16 v[52:55], a[80:83], v[176:179], v[52:55]
v_mfma_f32_16x16x32_bf16 v[56:59], a[84:87], v[176:179], v[56:59]
s_waitcnt lgkmcnt(0)
v_add_f32 v72, v72, v112
v_mfma_f32_16x16x32_bf16 v[60:63], a[88:91], v[176:179], v[60:63]
buffer_load_dwordx4 v[224:227], v148, s[44:47], s20 offen offset:0 sc1
v_add_f32 v73, v73, v113
v_mfma_f32_16x16x32_bf16 v[64:67], a[92:95], v[176:179], v[64:67]
v_add_f32 v74, v74, v114
v_add_f32 v75, v75, v115
v_mfma_f32_16x16x32_bf16 v[68:71], a[96:99], v[176:179], v[68:71]
v_add_f32 v76, v76, v116
s_waitcnt vmcnt(9)
v_mfma_f32_16x16x32_bf16 v[52:55], a[100:103], v[180:183], v[52:55]
v_add_f32 v77, v77, v117
v_add_f32 v78, v78, v118
v_mfma_f32_16x16x32_bf16 v[56:59], a[104:107], v[180:183], v[56:59]
buffer_load_dwordx4 v[228:231], v148, s[44:47], s20 offen offset:1024 sc1
v_add_f32 v79, v79, v119
v_mfma_f32_16x16x32_bf16 v[60:63], a[108:111], v[180:183], v[60:63]
v_add_f32 v80, v80, v120
v_add_f32 v81, v81, v121
v_mfma_f32_16x16x32_bf16 v[64:67], a[112:115], v[180:183], v[64:67]
v_add_f32 v82, v82, v122
v_add_f32 v83, v83, v123
v_mfma_f32_16x16x32_bf16 v[68:71], a[116:119], v[180:183], v[68:71]
v_add_f32 v84, v84, v124
s_waitcnt vmcnt(9)
v_mfma_f32_16x16x32_bf16 v[52:55], a[120:123], v[200:203], v[52:55]
buffer_load_dwordx4 v[216:219], v148, s[44:47], s20 offen offset:2048 sc1
v_add_f32 v85, v85, v125
v_mfma_f32_16x16x32_bf16 v[56:59], a[124:127], v[200:203], v[56:59]
v_add_f32 v86, v86, v126
v_add_f32 v87, v87, v127
v_mfma_f32_16x16x32_bf16 v[60:63], a[128:131], v[200:203], v[60:63]
v_add_f32 v88, v88, v128
v_add_f32 v89, v89, v129
v_mfma_f32_16x16x32_bf16 v[64:67], a[132:135], v[200:203], v[64:67]
v_add_f32 v90, v90, v130
v_add_f32 v91, v91, v131
v_mfma_f32_16x16x32_bf16 v[68:71], a[136:139], v[200:203], v[68:71]
buffer_load_dwordx4 v[220:223], v148, s[44:47], s20 offen offset:3072 sc1
s_waitcnt vmcnt(10)
v_mfma_f32_16x16x32_bf16 v[52:55], a[140:143], v[204:207], v[52:55]
s_barrier
v_mfma_f32_16x16x32_bf16 v[56:59], a[144:147], v[204:207], v[56:59]
ds_write_b128 v4, v[72:75] offset:0
v_mfma_f32_16x16x32_bf16 v[60:63], a[148:151], v[204:207], v[60:63]
v_mfma_f32_16x16x32_bf16 v[64:67], a[152:155], v[204:207], v[64:67]
buffer_load_dwordx4 v[176:179], v148, s[44:47], s42 offen offset:0 sc1
v_mfma_f32_16x16x32_bf16 v[68:71], a[156:159], v[204:207], v[68:71]
s_waitcnt vmcnt(10)
v_mfma_f32_16x16x32_bf16 v[52:55], a[160:163], v[208:211], v[52:55]
ds_write_b128 v4, v[76:79] offset:1024
v_mfma_f32_16x16x32_bf16 v[56:59], a[164:167], v[208:211], v[56:59]
v_mfma_f32_16x16x32_bf16 v[60:63], a[168:171], v[208:211], v[60:63]
buffer_load_dwordx4 v[180:183], v148, s[44:47], s42 offen offset:1024 sc1
v_mfma_f32_16x16x32_bf16 v[64:67], a[172:175], v[208:211], v[64:67]
ds_write_b128 v4, v[80:83] offset:2048
v_mfma_f32_16x16x32_bf16 v[68:71], a[176:179], v[208:211], v[68:71]
s_waitcnt vmcnt(10)
v_mfma_f32_16x16x32_bf16 v[52:55], a[180:183], v[212:215], v[52:55]
v_mfma_f32_16x16x32_bf16 v[56:59], a[184:187], v[212:215], v[56:59]
buffer_load_dwordx4 v[200:203], v148, s[44:47], s42 offen offset:2048 sc1
v_mfma_f32_16x16x32_bf16 v[60:63], a[188:191], v[212:215], v[60:63]
ds_write_b128 v4, v[84:87] offset:3072
v_mfma_f32_16x16x32_bf16 v[64:67], a[192:195], v[212:215], v[64:67]
v_mfma_f32_16x16x32_bf16 v[68:71], a[196:199], v[212:215], v[68:71]
s_waitcnt vmcnt(10)
v_mfma_f32_16x16x32_bf16 v[52:55], a[200:203], v[184:187], v[52:55]
buffer_load_dwordx4 v[204:207], v148, s[44:47], s42 offen offset:3072 sc1
v_mfma_f32_16x16x32_bf16 v[56:59], a[204:207], v[184:187], v[56:59]
ds_write_b128 v4, v[88:91] offset:4096
v_mfma_f32_16x16x32_bf16 v[60:63], a[208:211], v[184:187], v[60:63]
v_mfma_f32_16x16x32_bf16 v[64:67], a[212:215], v[184:187], v[64:67]
v_mfma_f32_16x16x32_bf16 v[68:71], a[216:219], v[184:187], v[68:71]
buffer_load_dwordx4 v[208:211], v149, s[44:47], s20 offen offset:0 sc1
s_waitcnt vmcnt(11)
v_mfma_f32_16x16x32_bf16 v[52:55], a[220:223], v[188:191], v[52:55]
v_mfma_f32_16x16x32_bf16 v[56:59], a[224:227], v[188:191], v[56:59]
v_mfma_f32_16x16x32_bf16 v[60:63], a[228:231], v[188:191], v[60:63]
v_mfma_f32_16x16x32_bf16 v[64:67], a[232:235], v[188:191], v[64:67]
buffer_load_dwordx4 v[212:215], v149, s[44:47], s42 offen offset:0 sc1
s_waitcnt lgkmcnt(0)
v_mfma_f32_16x16x32_bf16 v[68:71], a[236:239], v[188:191], v[68:71]
s_barrier
s_waitcnt vmcnt(11)
v_mfma_f32_16x16x32_bf16 v[52:55], a[240:243], v[192:195], v[52:55]
ds_read_b128 v[112:115], v5 offset:0
ds_read_b128 v[116:119], v5 offset:1024
v_mfma_f32_16x16x32_bf16 v[56:59], a[244:247], v[192:195], v[56:59]
ds_read_b128 v[120:123], v5 offset:2048
ds_read_b128 v[124:127], v5 offset:3072
v_mfma_f32_16x16x32_bf16 v[60:63], a[248:251], v[192:195], v[60:63]
ds_read_b128 v[128:131], v5 offset:4096
v_mfma_f32_16x16x32_bf16 v[64:67], a[252:255], v[192:195], v[64:67]
v_mfma_f32_16x16x32_bf16 v[68:71], v[232:235], v[192:195], v[68:71]
s_waitcnt vmcnt(10)
v_mfma_f32_16x16x32_bf16 v[52:55], v[236:239], v[196:199], v[52:55]
v_mfma_f32_16x16x32_bf16 v[56:59], v[240:243], v[196:199], v[56:59]
v_mfma_f32_16x16x32_bf16 v[60:63], v[244:247], v[196:199], v[60:63]
v_mfma_f32_16x16x32_bf16 v[64:67], v[248:251], v[196:199], v[64:67]
v_mfma_f32_16x16x32_bf16 v[68:71], v[252:255], v[196:199], v[68:71]
s_waitcnt vmcnt(9)
v_mfma_f32_16x16x32_bf16 v[32:35], a[80:83], v[224:227], v[32:35]
v_mfma_f32_16x16x32_bf16 v[36:39], a[84:87], v[224:227], v[36:39]
s_waitcnt lgkmcnt(0)
v_add_f32 v52, v52, v112
v_mfma_f32_16x16x32_bf16 v[40:43], a[88:91], v[224:227], v[40:43]
v_add_f32 v53, v53, v113
v_add_f32 v54, v54, v114
v_mfma_f32_16x16x32_bf16 v[44:47], a[92:95], v[224:227], v[44:47]
v_add_f32 v55, v55, v115
v_add_f32 v56, v56, v116
v_mfma_f32_16x16x32_bf16 v[48:51], a[96:99], v[224:227], v[48:51]
v_add_f32 v57, v57, v117
s_waitcnt vmcnt(8)
v_mfma_f32_16x16x32_bf16 v[32:35], a[100:103], v[228:231], v[32:35]
v_add_f32 v58, v58, v118
v_add_f32 v59, v59, v119
v_mfma_f32_16x16x32_bf16 v[36:39], a[104:107], v[228:231], v[36:39]
v_add_f32 v60, v60, v120
v_add_f32 v61, v61, v121
v_mfma_f32_16x16x32_bf16 v[40:43], a[108:111], v[228:231], v[40:43]
v_add_f32 v62, v62, v122
v_add_f32 v63, v63, v123
v_mfma_f32_16x16x32_bf16 v[44:47], a[112:115], v[228:231], v[44:47]
v_add_f32 v64, v64, v124
v_add_f32 v65, v65, v125
v_mfma_f32_16x16x32_bf16 v[48:51], a[116:119], v[228:231], v[48:51]
v_add_f32 v66, v66, v126
s_waitcnt vmcnt(7)
v_mfma_f32_16x16x32_bf16 v[32:35], a[120:123], v[216:219], v[32:35]
v_add_f32 v67, v67, v127
v_add_f32 v68, v68, v128
v_mfma_f32_16x16x32_bf16 v[36:39], a[124:127], v[216:219], v[36:39]
v_add_f32 v69, v69, v129
v_add_f32 v70, v70, v130
v_mfma_f32_16x16x32_bf16 v[40:43], a[128:131], v[216:219], v[40:43]
v_add_f32 v71, v71, v131
s_barrier
v_mfma_f32_16x16x32_bf16 v[44:47], a[132:135], v[216:219], v[44:47]
ds_write_b128 v4, v[52:55] offset:0
v_mfma_f32_16x16x32_bf16 v[48:51], a[136:139], v[216:219], v[48:51]
s_waitcnt vmcnt(6)
v_mfma_f32_16x16x32_bf16 v[32:35], a[140:143], v[220:223], v[32:35]
v_mfma_f32_16x16x32_bf16 v[36:39], a[144:147], v[220:223], v[36:39]
ds_write_b128 v4, v[56:59] offset:1024
v_mfma_f32_16x16x32_bf16 v[40:43], a[148:151], v[220:223], v[40:43]
v_mfma_f32_16x16x32_bf16 v[44:47], a[152:155], v[220:223], v[44:47]
ds_write_b128 v4, v[60:63] offset:2048
v_mfma_f32_16x16x32_bf16 v[48:51], a[156:159], v[220:223], v[48:51]
s_waitcnt vmcnt(5)
v_mfma_f32_16x16x32_bf16 v[32:35], a[160:163], v[176:179], v[32:35]
v_mfma_f32_16x16x32_bf16 v[36:39], a[164:167], v[176:179], v[36:39]
ds_write_b128 v4, v[64:67] offset:3072
v_mfma_f32_16x16x32_bf16 v[40:43], a[168:171], v[176:179], v[40:43]
v_mfma_f32_16x16x32_bf16 v[44:47], a[172:175], v[176:179], v[44:47]
ds_write_b128 v4, v[68:71] offset:4096
v_mfma_f32_16x16x32_bf16 v[48:51], a[176:179], v[176:179], v[48:51]
s_waitcnt vmcnt(4)
v_mfma_f32_16x16x32_bf16 v[32:35], a[180:183], v[180:183], v[32:35]
v_mfma_f32_16x16x32_bf16 v[36:39], a[184:187], v[180:183], v[36:39]
v_mfma_f32_16x16x32_bf16 v[40:43], a[188:191], v[180:183], v[40:43]
v_mfma_f32_16x16x32_bf16 v[44:47], a[192:195], v[180:183], v[44:47]
v_mfma_f32_16x16x32_bf16 v[48:51], a[196:199], v[180:183], v[48:51]
s_waitcnt vmcnt(3)
v_mfma_f32_16x16x32_bf16 v[32:35], a[200:203], v[200:203], v[32:35]
v_mfma_f32_16x16x32_bf16 v[36:39], a[204:207], v[200:203], v[36:39]
v_mfma_f32_16x16x32_bf16 v[40:43], a[208:211], v[200:203], v[40:43]
v_mfma_f32_16x16x32_bf16 v[44:47], a[212:215], v[200:203], v[44:47]
v_mfma_f32_16x16x32_bf16 v[48:51], a[216:219], v[200:203], v[48:51]
s_waitcnt vmcnt(2)
v_mfma_f32_16x16x32_bf16 v[32:35], a[220:223], v[204:207], v[32:35]
v_mfma_f32_16x16x32_bf16 v[36:39], a[224:227], v[204:207], v[36:39]
v_mfma_f32_16x16x32_bf16 v[40:43], a[228:231], v[204:207], v[40:43]
v_mfma_f32_16x16x32_bf16 v[44:47], a[232:235], v[204:207], v[44:47]
s_waitcnt lgkmcnt(0)
s_barrier
v_mfma_f32_16x16x32_bf16 v[48:51], a[236:239], v[204:207], v[48:51]
ds_read_b128 v[112:115], v5 offset:0
s_waitcnt vmcnt(1)
v_mfma_f32_16x16x32_bf16 v[32:35], a[240:243], v[208:211], v[32:35]
ds_read_b128 v[116:119], v5 offset:1024
ds_read_b128 v[120:123], v5 offset:2048
v_mfma_f32_16x16x32_bf16 v[36:39], a[244:247], v[208:211], v[36:39]
ds_read_b128 v[124:127], v5 offset:3072
ds_read_b128 v[128:131], v5 offset:4096
v_mfma_f32_16x16x32_bf16 v[40:43], a[248:251], v[208:211], v[40:43]
v_mfma_f32_16x16x32_bf16 v[44:47], a[252:255], v[208:211], v[44:47]
v_mfma_f32_16x16x32_bf16 v[48:51], v[232:235], v[208:211], v[48:51]
s_waitcnt vmcnt(0)
v_mfma_f32_16x16x32_bf16 v[32:35], v[236:239], v[212:215], v[32:35]
v_mfma_f32_16x16x32_bf16 v[36:39], v[240:243], v[212:215], v[36:39]
v_mfma_f32_16x16x32_bf16 v[40:43], v[244:247], v[212:215], v[40:43]
v_mfma_f32_16x16x32_bf16 v[44:47], v[248:251], v[212:215], v[44:47]
v_mfma_f32_16x16x32_bf16 v[48:51], v[252:255], v[212:215], v[48:51]
s_waitcnt lgkmcnt(0)
v_pk_add_f32 v[152:153], v[152:153], v[112:113]
v_pk_add_f32 v[154:155], v[154:155], v[114:115]
v_pk_add_f32 v[156:157], v[156:157], v[116:117]
v_pk_add_f32 v[158:159], v[158:159], v[118:119]
v_pk_add_f32 v[160:161], v[160:161], v[120:121]
v_pk_add_f32 v[162:163], v[162:163], v[122:123]
v_pk_add_f32 v[164:165], v[164:165], v[124:125]
v_pk_add_f32 v[166:167], v[166:167], v[126:127]
v_pk_add_f32 v[168:169], v[168:169], v[128:129]
v_pk_add_f32 v[170:171], v[170:171], v[130:131]
v_pk_add_f32 v[152:153], v[152:153], v[32:33]
v_pk_add_f32 v[154:155], v[154:155], v[34:35]
v_pk_add_f32 v[156:157], v[156:157], v[36:37]
v_pk_add_f32 v[158:159], v[158:159], v[38:39]
v_pk_add_f32 v[160:161], v[160:161], v[40:41]
v_pk_add_f32 v[162:163], v[162:163], v[42:43]
v_pk_add_f32 v[164:165], v[164:165], v[44:45]
v_pk_add_f32 v[166:167], v[166:167], v[46:47]
v_pk_add_f32 v[168:169], v[168:169], v[48:49]
v_pk_add_f32 v[170:171], v[170:171], v[50:51]
v_pk_add_f32 v[208:209], v[152:153], v[154:155]
v_pk_mul_f32 v[210:211], v[152:153], v[152:153]
v_pk_add_f32 v[212:213], v[156:157], v[158:159]
v_pk_mul_f32 v[214:215], v[154:155], v[154:155]
v_pk_fma_f32 v[210:211], v[156:157], v[156:157], v[210:211]
v_pk_fma_f32 v[214:215], v[158:159], v[158:159], v[214:215]
v_pk_add_f32 v[208:209], v[208:209], v[160:161]
v_pk_fma_f32 v[210:211], v[160:161], v[160:161], v[210:211]
v_pk_add_f32 v[212:213], v[212:213], v[162:163]
v_pk_fma_f32 v[214:215], v[162:163], v[162:163], v[214:215]
v_pk_add_f32 v[208:209], v[208:209], v[164:165]
v_pk_fma_f32 v[210:211], v[164:165], v[164:165], v[210:211]
v_pk_add_f32 v[212:213], v[212:213], v[166:167]
v_pk_fma_f32 v[214:215], v[166:167], v[166:167], v[214:215]
v_pk_add_f32 v[208:209], v[208:209], v[168:169]
v_pk_fma_f32 v[210:211], v[168:169], v[168:169], v[210:211]
v_pk_add_f32 v[212:213], v[212:213], v[170:171]
v_pk_fma_f32 v[214:215], v[170:171], v[170:171], v[214:215]
v_pk_add_f32 v[208:209], v[208:209], v[212:213]
v_pk_add_f32 v[210:211], v[210:211], v[214:215]
v_add_f32 v208, v208, v209
v_add_f32 v209, v210, v211
v_mov_b32 v210, v208
v_mov_b32 v211, v209
s_nop 0
v_permlane16_swap_b32 v208, v210
v_permlane16_swap_b32 v209, v211
v_add_f32 v208, v208, v210
v_add_f32 v209, v209, v211
v_mov_b32 v210, v208
v_mov_b32 v211, v209
s_nop 0
v_permlane32_swap_b32 v208, v210
v_permlane32_swap_b32 v209, v211
v_add_f32 v208, v208, v210
v_add_f32 v209, v209, v211
v_mov_b32 v210, s6
v_mov_b32 v211, s6
s_mov_b64 exec, 0xffff
s_cmp_lg_u32 s7, 0
s_cbranch_scc1 exs_72
buffer_store_dwordx4 v[208:211], v3, s[44:47], s33 offen
s_branch exd_73
exs_72:
buffer_store_dwordx4 v[208:211], v3, s[44:47], s33 offen sc1
exd_73:
s_mov_b64 exec, -1
v_lshlrev_b32 v72, 16, v18
v_and_b32 v73, s14, v18
v_lshlrev_b32 v74, 16, v19
v_and_b32 v75, s14, v19
v_lshlrev_b32 v76, 16, v20
v_and_b32 v77, s14, v20
v_lshlrev_b32 v78, 16, v21
v_and_b32 v79, s14, v21
v_lshlrev_b32 v80, 16, v22
v_and_b32 v81, s14, v22
v_lshlrev_b32 v82, 16, v23
v_and_b32 v83, s14, v23
v_lshlrev_b32 v84, 16, v24
v_and_b32 v85, s14, v24
v_lshlrev_b32 v86, 16, v25
v_and_b32 v87, s14, v25
v_lshlrev_b32 v88, 16, v26
v_and_b32 v89, s14, v26
v_lshlrev_b32 v90, 16, v27
v_and_b32 v91, s14, v27
poll_74:
buffer_load_dwordx4 v[212:215], v3, s[44:47], s17 offen sc1
buffer_load_dwordx4 v[216:219], v3, s[44:47], s17 offen offset:1024 sc1
s_waitcnt vmcnt(0)
v_cmp_eq_u32 vcc, s6, v214
v_cmp_eq_u32 s[10:11], s6, v218
s_nop 3
s_and_b64 vcc, vcc, s[10:11]
s_cmp_eq_u64 vcc, -1
s_cbranch_scc1 pollok_75
s_sub_u32 s98, s98, 1
s_cbranch_scc0 poll_74
s_mov_b32 s98, 0
pollok_75:
v_add_f32 v208, v212, v216
v_add_f32 v209, v213, v217
v_mov_b32 v210, v208
v_mov_b32 v211, v209
s_nop 0
v_permlane16_swap_b32 v208, v210
v_permlane16_swap_b32 v209, v211
v_add_f32 v208, v208, v210
v_add_f32 v209, v209, v211
v_mov_b32 v210, v208
v_mov_b32 v211, v209
s_nop 0
v_permlane32_swap_b32 v208, v210
v_permlane32_swap_b32 v209, v211
v_add_f32 v208, v208, v210
v_add_f32 v209, v209, v211
v_mul_f32 v208, 0x3acccccd, v208
v_mul_f32 v209, 0x3acccccd, v209
v_fma_f32 v209, -v208, v208, v209
v_max_f32 v209, 0, v209
v_add_f32 v209, 0x3727c5ac, v209
v_rsq_f32 v210, v209
s_nop 0
v_mul_f32 v211, -v208, v210
v_pk_fma_f32 v[32:33], v[152:153], v[210:211], v[210:211] op_sel:[0,0,1] op_sel_hi:[1,0,1]
v_pk_fma_f32 v[34:35], v[154:155], v[210:211], v[210:211] op_sel:[0,0,1] op_sel_hi:[1,0,1]
v_pk_fma_f32 v[36:37], v[156:157], v[210:211], v[210:211] op_sel:[0,0,1] op_sel_hi:[1,0,1]
v_pk_fma_f32 v[38:39], v[158:159], v[210:211], v[210:211] op_sel:[0,0,1] op_sel_hi:[1,0,1]
v_pk_fma_f32 v[40:41], v[160:161], v[210:211], v[210:211] op_sel:[0,0,1] op_sel_hi:[1,0,1]
v_pk_fma_f32 v[42:43], v[162:163], v[210:211], v[210:211] op_sel:[0,0,1] op_sel_hi:[1,0,1]
v_pk_fma_f32 v[44:45], v[164:165], v[210:211], v[210:211] op_sel:[0,0,1] op_sel_hi:[1,0,1]
v_pk_fma_f32 v[46:47], v[166:167], v[210:211], v[210:211] op_sel:[0,0,1] op_sel_hi:[1,0,1]
v_pk_fma_f32 v[48:49], v[168:169], v[210:211], v[210:211] op_sel:[0,0,1] op_sel_hi:[1,0,1]
v_pk_fma_f32 v[50:51], v[170:171], v[210:211], v[210:211] op_sel:[0,0,1] op_sel_hi:[1,0,1]
v_pk_fma_f32 v[32:33], v[32:33], v[72:73], v[152:153]
v_pk_fma_f32 v[34:35], v[34:35], v[74:75], v[154:155]
v_pk_fma_f32 v[36:37], v[36:37], v[76:77], v[156:157]
v_pk_fma_f32 v[38:39], v[38:39], v[78:79], v[158:159]
v_pk_fma_f32 v[40:41], v[40:41], v[80:81], v[160:161]
v_pk_fma_f32 v[42:43], v[42:43], v[82:83], v[162:163]
v_pk_fma_f32 v[44:45], v[44:45], v[84:85], v[164:165]
v_pk_fma_f32 v[46:47], v[46:47], v[86:87], v[166:167]
v_pk_fma_f32 v[48:49], v[48:49], v[88:89], v[168:169]
v_pk_fma_f32 v[50:51], v[50:51], v[90:91], v[170:171]
v_cvt_pk_bf16_f32 v8, v32, v33
v_cvt_pk_bf16_f32 v9, v34, v35
v_cvt_pk_bf16_f32 v10, v36, v37
v_cvt_pk_bf16_f32 v11, v38, v39
v_cvt_pk_bf16_f32 v12, v40, v41
v_cvt_pk_bf16_f32 v13, v42, v43
v_cvt_pk_bf16_f32 v14, v44, v45
v_cvt_pk_bf16_f32 v15, v46, v47
v_cvt_pk_bf16_f32 v16, v48, v49
v_cvt_pk_bf16_f32 v17, v50, v51
s_add_u32 s8, s25, 0xac0000
buffer_store_dwordx2 v[8:9], v28, s[44:47], s8 offen offset:0 nt
buffer_store_dwordx2 v[10:11], v28, s[44:47], s8 offen offset:256 nt
buffer_store_dwordx2 v[12:13], v28, s[44:47], s8 offen offset:2048 nt
buffer_store_dwordx2 v[14:15], v28, s[44:47], s8 offen offset:2304 nt
buffer_store_dwordx2 v[16:17], v29, s[44:47], s8 offen nt
v_lshrrev_b32 v4, 2, v1
v_mul_u32_u24 v4, 224, v4
v_and_b32 v5, 3, v1
v_lshl_add_u32 v4, v5, 3, v4
v_lshrrev_b32 v5, 4, v1
v_mul_u32_u24 v5, 896, v5
ds_read_b64_tr_b16 v[96:97], v4 offset:0
ds_read_b64_tr_b16 v[98:99], v4 offset:3584
ds_read_b64_tr_b16 v[100:101], v4 offset:32
ds_read_b64_tr_b16 v[102:103], v4 offset:3616
ds_read_b64_tr_b16 v[104:105], v4 offset:64
ds_read_b64_tr_b16 v[106:107], v4 offset:3648
ds_read_b64_tr_b16 v[108:109], v4 offset:96
ds_read_b64_tr_b16 v[110:111], v4 offset:3680
ds_read_b64_tr_b16 v[112:113], v4 offset:128
ds_read_b64_tr_b16 v[114:115], v4 offset:3712
ds_read_b64_tr_b16 v[116:117], v4 offset:160
ds_read_b64_tr_b16 v[118:119], v4 offset:3744
ds_read_b64_tr_b16 v[120:121], v4 offset:192
ds_read_b64_tr_b16 v[122:123], v4 offset:3776
s_mov_b32 s15, 1
s_lshl_b32 s8, s64, 2
s_add_u32 s8, s8, s5
s_mul_i32 s16, s8, 40960
s_add_u32 s16, s16, 0xac0000
s_and_b32 s8, s64, 1
s_mul_i32 s8, s8, 20480
s_sub_u32 s24, s16, s8
s_add_u32 s16, s16, s8
s_mov_b32 s18, 0x1240000
s_lshl_b32 s19, s64, 10
s_add_u32 s19, s19, 0xa000
s_lshl_b32 s8, s64, 2
s_add_u32 s8, s8, s5
s_lshl_b32 s8, s8, 12
s_add_u32 s34, s8, 0x80000
s_lshl_b32 s8, s64, 1
s_add_u32 s8, s8, s66
s_lshl_b32 s8, s8, 2
s_add_u32 s8, s8, s5
s_lshl_b32 s8, s8, 11
s_add_u32 s35, s8, 0x20000
s_lshl_b32 s10, s67, 8
s_add_u32 s10, s10, s35
s_add_u32 s35, s10, 0x60000
v_and_b32 v30, 0x2f0, v3
v_and_b32 v6, 0x200, v3
v_add_u32 v30, v30, v6
v_and_b32 v6, 0x100, v3
v_lshl_add_u32 v30, v6, 3, v30
s_mov_b32 s100, 0x70000000
v_mov_b32 v18, 0
v_mov_b32 v19, 0
s_lshl_b32 s8, s64, 1
s_add_u32 s8, s8, s66
s_lshl_b32 s8, s8, 1
s_lshr_b32 s9, s5, 1
s_add_u32 s8, s8, s9
s_lshl_b32 s8, s8, 3
s_add_u32 s8, s8, s67
s_lshl_b32 s8, s8, 1
s_and_b32 s9, s5, 1
s_add_u32 s8, s8, s9
s_lshl_b32 s8, s8, 2
s_add_u32 s33, s8, 0xe000
s_add_u32 s12, s12, 0x4000
s_add_u32 s13, s13, 0x4000
v_and_b32 v6, 15, v1
v_lshlrev_b32 v6, 2, v6
s_lshl_b32 s8, s64, 2
s_add_u32 s8, s8, s5
s_lshl_b32 s8, s8, 6
s_add_u32 s9, s8, 0xe000
s_waitcnt vmcnt(0)
s_mov_b64 exec, 1
s_cmp_lg_u32 s7, 0
s_cbranch_scc1 slow_76
buffer_store_dword v2, off, s[44:47], s33
s_branch flagdone_77
slow_76:
buffer_wbl2 sc1
s_waitcnt vmcnt(0)
buffer_store_dword v2, off, s[44:47], s33 sc1
flagdone_77:
s_mov_b64 exec, -1
poll_78:
buffer_load_dword v7, v6, s[44:47], s9 offen sc1
s_waitcnt vmcnt(0)
v_cmp_eq_u32 vcc, s6, v7
s_nop 3
s_cmp_eq_u64 vcc, -1
s_cbranch_scc1 pollok_79
s_sub_u32 s98, s98, 1
s_cbranch_scc0 poll_78
s_mov_b32 s98, 0
pollok_79:
s_cmp_eq_u32 s7, 0
s_cbranch_scc1 noinv_80
buffer_inv sc1
s_waitcnt vmcnt(0)
noinv_80:
s_add_u32 s17, s16, 0
buffer_load_dwordx4 v[152:155], v3, s[44:47], s17 offen offset:0 sc1
buffer_load_dwordx4 v[156:159], v3, s[44:47], s17 offen offset:1024 sc1
buffer_load_dwordx4 v[160:163], v3, s[44:47], s17 offen offset:2048 sc1
buffer_load_dwordx4 v[164:167], v3, s[44:47], s17 offen offset:3072 sc1
s_add_u32 s17, s16, 4096
buffer_load_dwordx4 v[168:171], v3, s[44:47], s17 offen offset:0 sc1
buffer_load_dwordx4 v[172:175], v3, s[44:47], s17 offen offset:1024 sc1
buffer_load_dwordx4 v[176:179], v3, s[44:47], s17 offen offset:2048 sc1
buffer_load_dwordx4 v[180:183], v3, s[44:47], s17 offen offset:3072 sc1
s_add_u32 s17, s16, 8192
buffer_load_dwordx4 v[184:187], v3, s[44:47], s17 offen offset:0 sc1
buffer_load_dwordx4 v[188:191], v3, s[44:47], s17 offen offset:1024 sc1
buffer_load_dwordx4 v[192:195], v3, s[44:47], s17 offen offset:2048 sc1
buffer_load_dwordx4 v[196:199], v3, s[44:47], s17 offen offset:3072 sc1
s_waitcnt vmcnt(10) lgkmcnt(0)
v_mfma_f32_16x16x32_bf16 v[60:63], v[96:99], v[154:157], 0
s_add_u32 s17, s16, 12288
ds_read_b64_tr_b16 v[124:125], v4 offset:7168
v_mfma_f32_16x16x32_bf16 v[64:67], v[100:103], v[154:157], 0
buffer_load_dwordx4 v[200:203], v3, s[44:47], s17 offen offset:0 sc1
v_mfma_f32_16x16x32_bf16 v[68:71], v[104:107], v[154:157], 0
ds_read_b64_tr_b16 v[126:127], v4 offset:10752
ds_read_b64_tr_b16 v[128:129], v4 offset:7200
v_mfma_f32_16x16x32_bf16 v[72:75], v[108:111], v[154:157], 0
ds_read_b64_tr_b16 v[130:131], v4 offset:10784
ds_read_b64_tr_b16 v[132:133], v4 offset:7232
v_mfma_f32_16x16x32_bf16 v[76:79], v[112:115], v[154:157], 0
v_mov_b64 v[26:27], v[158:159]
v_mov_b64 v[24:25], v[152:153]
v_mfma_f32_16x16x32_bf16 v[80:83], v[116:119], v[154:157], 0
buffer_load_dwordx4 v[204:207], v3, s[44:47], s17 offen offset:1024 sc1
v_mfma_f32_16x16x32_bf16 v[84:87], v[120:123], v[154:157], 0
ds_read_b64_tr_b16 v[134:135], v4 offset:10816
ds_read_b64_tr_b16 v[136:137], v4 offset:7264
v_mfma_f32_16x16x32_bf16 v[32:35], v[96:99], v[24:27], 0
ds_read_b64_tr_b16 v[138:139], v4 offset:10848
ds_read_b64_tr_b16 v[140:141], v4 offset:7296
v_mfma_f32_16x16x32_bf16 v[36:39], v[100:103], v[24:27], 0
ds_read_b64_tr_b16 v[142:143], v4 offset:10880
ds_read_b64_tr_b16 v[144:145], v4 offset:7328
v_mfma_f32_16x16x32_bf16 v[40:43], v[104:107], v[24:27], 0
buffer_load_dwordx4 v[208:211], v3, s[44:47], s17 offen offset:2048 sc1
v_mfma_f32_16x16x32_bf16 v[44:47], v[108:111], v[24:27], 0
ds_read_b64_tr_b16 v[146:147], v4 offset:10912
ds_read_b64_tr_b16 v[148:149], v4 offset:7360
v_mfma_f32_16x16x32_bf16 v[48:51], v[112:115], v[24:27], 0
ds_read_b64_tr_b16 v[150:151], v4 offset:10944
v_mov_b32 v224, 0x3f803f80
v_mfma_f32_16x16x32_bf16 v[52:55], v[116:119], v[24:27], 0
v_mov_b32 v225, 0x3f803f80
v_mov_b32 v226, 0x3f803f80
v_mfma_f32_16x16x32_bf16 v[56:59], v[120:123], v[24:27], 0
buffer_load_dwordx4 v[212:215], v3, s[44:47], s17 offen offset:3072 sc1
v_mov_b32 v227, 0x3f803f80
v_mov_b32 v22, 0
v_mov_b32 v23, 0
v_mov_b64 v[20:21], v[16:17]
v_mfma_f32_16x16x32_bf16 v[88:91], v[8:11], v[8:11], 0
v_mfma_f32_16x16x32_bf16 v[92:95], v[224:227], v[8:11], 0
v_mfma_f32_16x16x32_bf16 v[88:91], v[12:15], v[12:15], v[88:91]
v_mfma_f32_16x16x32_bf16 v[92:95], v[224:227], v[12:15], v[92:95]
v_mfma_f32_16x16x32_bf16 v[88:91], v[20:23], v[20:23], v[88:91]
v_mfma_f32_16x16x32_bf16 v[92:95], v[224:227], v[20:23], v[92:95]
s_waitcnt vmcnt(12) lgkmcnt(0)
v_mfma_f32_16x16x32_bf16 v[60:63], v[124:127], v[162:165], v[60:63]
ds_read_b64_tr_b16 v[96:97], v4 offset:14336
ds_read_b64_tr_b16 v[98:99], v4 offset:17920
v_mfma_f32_16x16x32_bf16 v[64:67], v[128:131], v[162:165], v[64:67]
ds_read_b64_tr_b16 v[100:101], v4 offset:14368
ds_read_b64_tr_b16 v[102:103], v4 offset:17952
v_mfma_f32_16x16x32_bf16 v[68:71], v[132:135], v[162:165], v[68:71]
ds_read_b64_tr_b16 v[104:105], v4 offset:14400
ds_read_b64_tr_b16 v[106:107], v4 offset:17984
v_mfma_f32_16x16x32_bf16 v[72:75], v[136:139], v[162:165], v[72:75]
ds_read_b64_tr_b16 v[108:109], v4 offset:14432
ds_read_b64_tr_b16 v[110:111], v4 offset:18016
v_mfma_f32_16x16x32_bf16 v[76:79], v[140:143], v[162:165], v[76:79]
ds_read_b64_tr_b16 v[112:113], v4 offset:14464
ds_read_b64_tr_b16 v[114:115], v4 offset:18048
v_mfma_f32_16x16x32_bf16 v[80:83], v[144:147], v[162:165], v[80:83]
v_mov_b64 v[26:27], v[166:167]
v_mov_b64 v[24:25], v[160:161]
v_mfma_f32_16x16x32_bf16 v[84:87], v[148:151], v[162:165], v[84:87]
ds_read_b64_tr_b16 v[116:117], v4 offset:14496
ds_read_b64_tr_b16 v[118:119], v4 offset:18080
v_mfma_f32_16x16x32_bf16 v[32:35], v[124:127], v[24:27], v[32:35]
s_add_u32 s17, s16, 16384
ds_read_b64_tr_b16 v[120:121], v4 offset:14528
v_mfma_f32_16x16x32_bf16 v[36:39], v[128:131], v[24:27], v[36:39]
buffer_load_dwordx4 v[152:155], v3, s[44:47], s17 offen offset:0 sc1
v_mfma_f32_16x16x32_bf16 v[40:43], v[132:135], v[24:27], v[40:43]
ds_read_b64_tr_b16 v[122:123], v4 offset:18112
v_and_b32 v21, 0xf0, v3
v_mfma_f32_16x16x32_bf16 v[44:47], v[136:139], v[24:27], v[44:47]
v_mov_b32 v94, s6
v_mov_b32 v95, s6
v_mfma_f32_16x16x32_bf16 v[48:51], v[140:143], v[24:27], v[48:51]
v_cndmask_b32 v93, v88, v89, s[50:51]
v_cndmask_b32 v93, v93, v90, s[52:53]
v_mfma_f32_16x16x32_bf16 v[52:55], v[144:147], v[24:27], v[52:55]
buffer_load_dwordx4 v[156:159], v3, s[44:47], s17 offen offset:1024 sc1
v_mfma_f32_16x16x32_bf16 v[56:59], v[148:151], v[24:27], v[56:59]
v_cndmask_b32 v93, v93, v91, s[54:55]
s_cmp_lg_u32 s7, 0
s_mov_b32 exec_lo, 0xf0000f
s_mov_b32 exec_hi, 0xf0000f00
s_cbranch_scc1 gstc_81
buffer_store_dwordx4 v[92:95], v21, s[44:47], s35 offen
gstb_82:
s_mov_b64 exec, -1
s_waitcnt vmcnt(13) lgkmcnt(0)
v_mfma_f32_16x16x32_bf16 v[60:63], v[96:99], v[170:173], v[60:63]
ds_read_b64_tr_b16 v[124:125], v4 offset:21504
ds_read_b64_tr_b16 v[126:127], v4 offset:25088
v_mfma_f32_16x16x32_bf16 v[64:67], v[100:103], v[170:173], v[64:67]
ds_read_b64_tr_b16 v[128:129], v4 offset:21536
ds_read_b64_tr_b16 v[130:131], v4 offset:25120
v_mfma_f32_16x16x32_bf16 v[68:71], v[104:107], v[170:173], v[68:71]
ds_read_b64_tr_b16 v[132:133], v4 offset:21568
ds_read_b64_tr_b16 v[134:135], v4 offset:25152
v_mfma_f32_16x16x32_bf16 v[72:75], v[108:111], v[170:173], v[72:75]
ds_read_b64_tr_b16 v[136:137], v4 offset:21600
ds_read_b64_tr_b16 v[138:139], v4 offset:25184
v_mfma_f32_16x16x32_bf16 v[76:79], v[112:115], v[170:173], v[76:79]
ds_read_b64_tr_b16 v[140:141], v4 offset:21632
ds_read_b64_tr_b16 v[142:143], v4 offset:25216
v_mfma_f32_16x16x32_bf16 v[80:83], v[116:119], v[170:173], v[80:83]
v_mov_b64 v[26:27], v[174:175]
v_mov_b64 v[24:25], v[168:169]
v_mfma_f32_16x16x32_bf16 v[84:87], v[120:123], v[170:173], v[84:87]
ds_read_b64_tr_b16 v[144:145], v4 offset:21664
ds_read_b64_tr_b16 v[146:147], v4 offset:25248
v_mfma_f32_16x16x32_bf16 v[32:35], v[96:99], v[24:27], v[32:35]
ds_read_b64_tr_b16 v[148:149], v4 offset:21696
ds_read_b64_tr_b16 v[150:151], v4 offset:25280
v_mfma_f32_16x16x32_bf16 v[36:39], v[100:103], v[24:27], v[36:39]
buffer_load_dwordx4 v[160:163], v3, s[44:47], s17 offen offset:2048 sc1
v_mfma_f32_16x16x32_bf16 v[40:43], v[104:107], v[24:27], v[40:43]
v_mfma_f32_16x16x32_bf16 v[44:47], v[108:111], v[24:27], v[44:47]
v_mfma_f32_16x16x32_bf16 v[48:51], v[112:115], v[24:27], v[48:51]
v_mfma_f32_16x16x32_bf16 v[52:55], v[116:119], v[24:27], v[52:55]
buffer_load_dwordx4 v[164:167], v3, s[44:47], s17 offen offset:3072 sc1
v_mfma_f32_16x16x32_bf16 v[56:59], v[120:123], v[24:27], v[56:59]
s_waitcnt vmcnt(13) lgkmcnt(0)
v_mfma_f32_16x16x32_bf16 v[60:63], v[124:127], v[178:181], v[60:63]
ds_read_b64_tr_b16 v[96:97], v4 offset:28672
ds_read_b64_tr_b16 v[98:99], v4 offset:32256
v_mfma_f32_16x16x32_bf16 v[64:67], v[128:131], v[178:181], v[64:67]
ds_read_b64_tr_b16 v[100:101], v4 offset:28704
ds_read_b64_tr_b16 v[102:103], v4 offset:32288
v_mfma_f32_16x16x32_bf16 v[68:71], v[132:135], v[178:181], v[68:71]
ds_read_b64_tr_b16 v[104:105], v4 offset:28736
ds_read_b64_tr_b16 v[106:107], v4 offset:32320
v_mfma_f32_16x16x32_bf16 v[72:75], v[136:139], v[178:181], v[72:75]
ds_read_b64_tr_b16 v[108:109], v4 offset:28768
ds_read_b64_tr_b16 v[110:111], v4 offset:32352
v_mfma_f32_16x16x32_bf16 v[76:79], v[140:143], v[178:181], v[76:79]
ds_read_b64_tr_b16 v[112:113], v4 offset:28800
ds_read_b64_tr_b16 v[114:115], v4 offset:32384
v_mfma_f32_16x16x32_bf16 v[80:83], v[144:147], v[178:181], v[80:83]
v_mov_b64 v[26:27], v[182:183]
v_mov_b64 v[24:25], v[176:177]
v_mfma_f32_16x16x32_bf16 v[84:87], v[148:151], v[178:181], v[84:87]
ds_read_b64_tr_b16 v[116:117], v4 offset:28832
ds_read_b64_tr_b16 v[118:119], v4 offset:32416
v_mfma_f32_16x16x32_bf16 v[32:35], v[124:127], v[24:27], v[32:35]
s_add_u32 s17, s24, 20480
ds_read_b64_tr_b16 v[120:121], v4 offset:28864
v_mfma_f32_16x16x32_bf16 v[36:39], v[128:131], v[24:27], v[36:39]
buffer_load_dwordx4 v[168:171], v3, s[44:47], s17 offen offset:0 sc1
v_mfma_f32_16x16x32_bf16 v[40:43], v[132:135], v[24:27], v[40:43]
ds_read_b64_tr_b16 v[122:123], v4 offset:32448
v_mfma_f32_16x16x32_bf16 v[44:47], v[136:139], v[24:27], v[44:47]
v_mfma_f32_16x16x32_bf16 v[48:51], v[140:143], v[24:27], v[48:51]
v_mfma_f32_16x16x32_bf16 v[52:55], v[144:147], v[24:27], v[52:55]
buffer_load_dwordx4 v[172:175], v3, s[44:47], s17 offen offset:1024 sc1
v_mfma_f32_16x16x32_bf16 v[56:59], v[148:151], v[24:27], v[56:59]
s_waitcnt vmcnt(13) lgkmcnt(0)
v_mfma_f32_16x16x32_bf16 v[60:63], v[96:99], v[186:189], v[60:63]
ds_read_b64_tr_b16 v[124:125], v4 offset:35840
ds_read_b64_tr_b16 v[126:127], v4 offset:39424
v_mfma_f32_16x16x32_bf16 v[64:67], v[100:103], v[186:189], v[64:67]
ds_read_b64_tr_b16 v[128:129], v4 offset:35872
ds_read_b64_tr_b16 v[130:131], v4 offset:39456
v_mfma_f32_16x16x32_bf16 v[68:71], v[104:107], v[186:189], v[68:71]
ds_read_b64_tr_b16 v[132:133], v4 offset:35904
ds_read_b64_tr_b16 v[134:135], v4 offset:39488
v_mfma_f32_16x16x32_bf16 v[72:75], v[108:111], v[186:189], v[72:75]
ds_read_b64_tr_b16 v[136:137], v4 offset:35936
ds_read_b64_tr_b16 v[138:139], v4 offset:39520
v_mfma_f32_16x16x32_bf16 v[76:79], v[112:115], v[186:189], v[76:79]
v_mov_b64 v[26:27], v[190:191]
v_mov_b64 v[24:25], v[184:185]
v_mfma_f32_16x16x32_bf16 v[80:83], v[116:119], v[186:189], v[80:83]
buffer_load_dwordx4 v[176:179], v3, s[44:47], s17 offen offset:2048 sc1
v_mfma_f32_16x16x32_bf16 v[84:87], v[120:123], v[186:189], v[84:87]
ds_read_b64_tr_b16 v[140:141], v4 offset:35968
ds_read_b64_tr_b16 v[142:143], v4 offset:39552
v_mfma_f32_16x16x32_bf16 v[32:35], v[96:99], v[24:27], v[32:35]
ds_read_b64_tr_b16 v[144:145], v4 offset:36000
ds_read_b64_tr_b16 v[146:147], v4 offset:39584
v_mfma_f32_16x16x32_bf16 v[36:39], v[100:103], v[24:27], v[36:39]
ds_read_b64_tr_b16 v[148:149], v4 offset:36032
ds_read_b64_tr_b16 v[150:151], v4 offset:39616
v_mfma_f32_16x16x32_bf16 v[40:43], v[104:107], v[24:27], v[40:43]
buffer_load_dwordx4 v[180:183], v3, s[44:47], s17 offen offset:3072 sc1
v_mfma_f32_16x16x32_bf16 v[44:47], v[108:111], v[24:27], v[44:47]
v_mfma_f32_16x16x32_bf16 v[48:51], v[112:115], v[24:27], v[48:51]
v_mfma_f32_16x16x32_bf16 v[52:55], v[116:119], v[24:27], v[52:55]
v_mfma_f32_16x16x32_bf16 v[56:59], v[120:123], v[24:27], v[56:59]
buffer_load_dwordx4 v[216:219], v30, s[44:47], s34 offen offset:0 sc1
s_waitcnt vmcnt(14) lgkmcnt(0)
v_mfma_f32_16x16x32_bf16 v[60:63], v[124:127], v[194:197], v[60:63]
ds_read_b64_tr_b16 v[96:97], v4 offset:43008
ds_read_b64_tr_b16 v[98:99], v4 offset:46592
v_mfma_f32_16x16x32_bf16 v[64:67], v[128:131], v[194:197], v[64:67]
ds_read_b64_tr_b16 v[100:101], v4 offset:43040
ds_read_b64_tr_b16 v[102:103], v4 offset:46624
v_mfma_f32_16x16x32_bf16 v[68:71], v[132:135], v[194:197], v[68:71]
ds_read_b64_tr_b16 v[104:105], v4 offset:43072
ds_read_b64_tr_b16 v[106:107], v4 offset:46656
v_mfma_f32_16x16x32_bf16 v[72:75], v[136:139], v[194:197], v[72:75]
v_mov_b64 v[24:25], v[192:193]
ds_read_b64_tr_b16 v[108:109], v4 offset:43104
v_mfma_f32_16x16x32_bf16 v[76:79], v[140:143], v[194:197], v[76:79]
s_add_u32 s17, s24, 24576
v_mov_b64 v[26:27], v[198:199]
v_mfma_f32_16x16x32_bf16 v[80:83], v[144:147], v[194:197], v[80:83]
buffer_load_dwordx4 v[184:187], v3, s[44:47], s17 offen offset:0 sc1
v_mfma_f32_16x16x32_bf16 v[84:87], v[148:151], v[194:197], v[84:87]
ds_read_b64_tr_b16 v[110:111], v4 offset:46688
ds_read_b64_tr_b16 v[112:113], v4 offset:43136
v_mfma_f32_16x16x32_bf16 v[32:35], v[124:127], v[24:27], v[32:35]
ds_read_b64_tr_b16 v[114:115], v4 offset:46720
ds_read_b64_tr_b16 v[116:117], v4 offset:43168
v_mfma_f32_16x16x32_bf16 v[36:39], v[128:131], v[24:27], v[36:39]
ds_read_b64_tr_b16 v[118:119], v4 offset:46752
ds_read_b64_tr_b16 v[120:121], v4 offset:43200
v_mfma_f32_16x16x32_bf16 v[40:43], v[132:135], v[24:27], v[40:43]
buffer_load_dwordx4 v[188:191], v3, s[44:47], s17 offen offset:1024 sc1
v_mfma_f32_16x16x32_bf16 v[44:47], v[136:139], v[24:27], v[44:47]
ds_read_b64_tr_b16 v[122:123], v4 offset:46784
v_mfma_f32_16x16x32_bf16 v[48:51], v[140:143], v[24:27], v[48:51]
v_mfma_f32_16x16x32_bf16 v[52:55], v[144:147], v[24:27], v[52:55]
v_mfma_f32_16x16x32_bf16 v[56:59], v[148:151], v[24:27], v[56:59]
buffer_load_dwordx4 v[220:223], v30, s[44:47], s34 offen offset:256 sc1
s_waitcnt vmcnt(15) lgkmcnt(0)
v_mfma_f32_16x16x32_bf16 v[60:63], v[96:99], v[202:205], v[60:63]
ds_read_b64_tr_b16 v[124:125], v4 offset:50176
ds_read_b64_tr_b16 v[126:127], v4 offset:53760
v_mfma_f32_16x16x32_bf16 v[64:67], v[100:103], v[202:205], v[64:67]
ds_read_b64_tr_b16 v[128:129], v4 offset:50208
ds_read_b64_tr_b16 v[130:131], v4 offset:53792
v_mfma_f32_16x16x32_bf16 v[68:71], v[104:107], v[202:205], v[68:71]
ds_read_b64_tr_b16 v[132:133], v4 offset:50240
ds_read_b64_tr_b16 v[134:135], v4 offset:53824
v_mfma_f32_16x16x32_bf16 v[72:75], v[108:111], v[202:205], v[72:75]
ds_read_b64_tr_b16 v[136:137], v4 offset:50272
ds_read_b64_tr_b16 v[138:139], v4 offset:53856
v_mfma_f32_16x16x32_bf16 v[76:79], v[112:115], v[202:205], v[76:79]
v_mov_b64 v[26:27], v[206:207]
v_mov_b64 v[24:25], v[200:201]
v_mfma_f32_16x16x32_bf16 v[80:83], v[116:119], v[202:205], v[80:83]
buffer_load_dwordx4 v[192:195], v3, s[44:47], s17 offen offset:2048 sc1
v_mfma_f32_16x16x32_bf16 v[84:87], v[120:123], v[202:205], v[84:87]
ds_read_b64_tr_b16 v[140:141], v4 offset:50304
ds_read_b64_tr_b16 v[142:143], v4 offset:53888
v_mfma_f32_16x16x32_bf16 v[32:35], v[96:99], v[24:27], v[32:35]
ds_read_b64_tr_b16 v[144:145], v4 offset:50336
ds_read_b64_tr_b16 v[146:147], v4 offset:53920
v_mfma_f32_16x16x32_bf16 v[36:39], v[100:103], v[24:27], v[36:39]
ds_read_b64_tr_b16 v[148:149], v4 offset:50368
ds_read_b64_tr_b16 v[150:151], v4 offset:53952
v_mfma_f32_16x16x32_bf16 v[40:43], v[104:107], v[24:27], v[40:43]
buffer_load_dwordx4 v[196:199], v3, s[44:47], s17 offen offset:3072 sc1
v_mfma_f32_16x16x32_bf16 v[44:47], v[108:111], v[24:27], v[44:47]
v_mfma_f32_16x16x32_bf16 v[48:51], v[112:115], v[24:27], v[48:51]
v_mfma_f32_16x16x32_bf16 v[52:55], v[116:119], v[24:27], v[52:55]
v_mfma_f32_16x16x32_bf16 v[56:59], v[120:123], v[24:27], v[56:59]
buffer_load_dwordx4 v[224:227], v30, s[44:47], s34 offen offset:512 sc1
s_waitcnt vmcnt(16) lgkmcnt(0)
v_add_u32 v4, 0xe000, v4
v_mfma_f32_16x16x32_bf16 v[60:63], v[124:127], v[210:213], v[60:63]
ds_read_b64_tr_b16 v[96:97], v4 offset:0
ds_read_b64_tr_b16 v[98:99], v4 offset:3584
v_mfma_f32_16x16x32_bf16 v[64:67], v[128:131], v[210:213], v[64:67]
ds_read_b64_tr_b16 v[100:101], v4 offset:32
ds_read_b64_tr_b16 v[102:103], v4 offset:3616
v_mfma_f32_16x16x32_bf16 v[68:71], v[132:135], v[210:213], v[68:71]
ds_read_b64_tr_b16 v[104:105], v4 offset:64
ds_read_b64_tr_b16 v[106:107], v4 offset:3648
v_mfma_f32_16x16x32_bf16 v[72:75], v[136:139], v[210:213], v[72:75]
v_mov_b64 v[24:25], v[208:209]
ds_read_b64_tr_b16 v[108:109], v4 offset:96
v_mfma_f32_16x16x32_bf16 v[76:79], v[140:143], v[210:213], v[76:79]
s_add_u32 s17, s24, 28672
v_mov_b64 v[26:27], v[214:215]
v_mfma_f32_16x16x32_bf16 v[80:83], v[144:147], v[210:213], v[80:83]
buffer_load_dwordx4 v[200:203], v3, s[44:47], s17 offen offset:0 sc1
v_mfma_f32_16x16x32_bf16 v[84:87], v[148:151], v[210:213], v[84:87]
ds_read_b64_tr_b16 v[110:111], v4 offset:3680
ds_read_b64_tr_b16 v[112:113], v4 offset:128
v_mfma_f32_16x16x32_bf16 v[32:35], v[124:127], v[24:27], v[32:35]
ds_read_b64_tr_b16 v[114:115], v4 offset:3712
ds_read_b64_tr_b16 v[116:117], v4 offset:160
v_mfma_f32_16x16x32_bf16 v[36:39], v[128:131], v[24:27], v[36:39]
ds_read_b64_tr_b16 v[118:119], v4 offset:3744
ds_read_b64_tr_b16 v[120:121], v4 offset:192
v_mfma_f32_16x16x32_bf16 v[40:43], v[132:135], v[24:27], v[40:43]
buffer_load_dwordx4 v[204:207], v3, s[44:47], s17 offen offset:1024 sc1
v_mfma_f32_16x16x32_bf16 v[44:47], v[136:139], v[24:27], v[44:47]
ds_read_b64_tr_b16 v[122:123], v4 offset:3776
v_mfma_f32_16x16x32_bf16 v[48:51], v[140:143], v[24:27], v[48:51]
v_mfma_f32_16x16x32_bf16 v[52:55], v[144:147], v[24:27], v[52:55]
v_mfma_f32_16x16x32_bf16 v[56:59], v[148:151], v[24:27], v[56:59]
buffer_load_dwordx4 v[228:231], v30, s[44:47], s34 offen offset:768 sc1
s_waitcnt vmcnt(17) lgkmcnt(0)
v_mfma_f32_16x16x32_bf16 v[60:63], v[96:99], v[154:157], v[60:63]
ds_read_b64_tr_b16 v[124:125], v4 offset:7168
ds_read_b64_tr_b16 v[126:127], v4 offset:10752
v_mfma_f32_16x16x32_bf16 v[64:67], v[100:103], v[154:157], v[64:67]
ds_read_b64_tr_b16 v[128:129], v4 offset:7200
ds_read_b64_tr_b16 v[130:131], v4 offset:10784
v_mfma_f32_16x16x32_bf16 v[68:71], v[104:107], v[154:157], v[68:71]
ds_read_b64_tr_b16 v[132:133], v4 offset:7232
ds_read_b64_tr_b16 v[134:135], v4 offset:10816
v_mfma_f32_16x16x32_bf16 v[72:75], v[108:111], v[154:157], v[72:75]
ds_read_b64_tr_b16 v[136:137], v4 offset:7264
ds_read_b64_tr_b16 v[138:139], v4 offset:10848
v_mfma_f32_16x16x32_bf16 v[76:79], v[112:115], v[154:157], v[76:79]
ds_read_b64_tr_b16 v[140:141], v4 offset:7296
ds_read_b64_tr_b16 v[142:143], v4 offset:10880
v_mfma_f32_16x16x32_bf16 v[80:83], v[116:119], v[154:157], v[80:83]
v_mov_b64 v[26:27], v[158:159]
v_mov_b64 v[24:25], v[152:153]
v_mfma_f32_16x16x32_bf16 v[84:87], v[120:123], v[154:157], v[84:87]
ds_read_b64_tr_b16 v[144:145], v4 offset:7328
ds_read_b64_tr_b16 v[146:147], v4 offset:10912
v_mfma_f32_16x16x32_bf16 v[32:35], v[96:99], v[24:27], v[32:35]
ds_read_b64_tr_b16 v[148:149], v4 offset:7360
ds_read_b64_tr_b16 v[150:151], v4 offset:10944
v_mfma_f32_16x16x32_bf16 v[36:39], v[100:103], v[24:27], v[36:39]
buffer_load_dwordx4 v[208:211], v3, s[44:47], s17 offen offset:2048 sc1
v_mfma_f32_16x16x32_bf16 v[40:43], v[104:107], v[24:27], v[40:43]
v_mfma_f32_16x16x32_bf16 v[44:47], v[108:111], v[24:27], v[44:47]
v_mfma_f32_16x16x32_bf16 v[48:51], v[112:115], v[24:27], v[48:51]
v_mfma_f32_16x16x32_bf16 v[52:55], v[116:119], v[24:27], v[52:55]
buffer_load_dwordx4 v[212:215], v3, s[44:47], s17 offen offset:3072 sc1
v_mfma_f32_16x16x32_bf16 v[56:59], v[120:123], v[24:27], v[56:59]
s_waitcnt vmcnt(16) lgkmcnt(0)
v_mfma_f32_16x16x32_bf16 v[60:63], v[124:127], v[162:165], v[60:63]
ds_read_b64_tr_b16 v[96:97], v4 offset:14336
ds_read_b64_tr_b16 v[98:99], v4 offset:17920
v_mfma_f32_16x16x32_bf16 v[64:67], v[128:131], v[162:165], v[64:67]
ds_read_b64_tr_b16 v[100:101], v4 offset:14368
ds_read_b64_tr_b16 v[102:103], v4 offset:17952
v_mfma_f32_16x16x32_bf16 v[68:71], v[132:135], v[162:165], v[68:71]
ds_read_b64_tr_b16 v[104:105], v4 offset:14400
ds_read_b64_tr_b16 v[106:107], v4 offset:17984
v_mfma_f32_16x16x32_bf16 v[72:75], v[136:139], v[162:165], v[72:75]
ds_read_b64_tr_b16 v[108:109], v4 offset:14432
ds_read_b64_tr_b16 v[110:111], v4 offset:18016
v_mfma_f32_16x16x32_bf16 v[76:79], v[140:143], v[162:165], v[76:79]
ds_read_b64_tr_b16 v[112:113], v4 offset:14464
ds_read_b64_tr_b16 v[114:115], v4 offset:18048
v_mfma_f32_16x16x32_bf16 v[80:83], v[144:147], v[162:165], v[80:83]
v_mov_b64 v[26:27], v[166:167]
v_mov_b64 v[24:25], v[160:161]
v_mfma_f32_16x16x32_bf16 v[84:87], v[148:151], v[162:165], v[84:87]
ds_read_b64_tr_b16 v[116:117], v4 offset:14496
ds_read_b64_tr_b16 v[118:119], v4 offset:18080
v_mfma_f32_16x16x32_bf16 v[32:35], v[124:127], v[24:27], v[32:35]
s_add_u32 s17, s24, 32768
ds_read_b64_tr_b16 v[120:121], v4 offset:14528
v_mfma_f32_16x16x32_bf16 v[36:39], v[128:131], v[24:27], v[36:39]
buffer_load_dwordx4 v[152:155], v3, s[44:47], s17 offen offset:0 sc1
v_mfma_f32_16x16x32_bf16 v[40:43], v[132:135], v[24:27], v[40:43]
ds_read_b64_tr_b16 v[122:123], v4 offset:18112
s_waitcnt vmcnt(3)
v_xor_b32 v20, v218, v222
v_mfma_f32_16x16x32_bf16 v[44:47], v[136:139], v[24:27], v[44:47]
v_xor_b32 v21, v226, v230
v_xor_b32 v22, s6, v218
v_mfma_f32_16x16x32_bf16 v[48:51], v[140:143], v[24:27], v[48:51]
v_or3_b32 v20, v20, v21, v22
v_xor_b32 v22, s6, v226
v_mfma_f32_16x16x32_bf16 v[52:55], v[144:147], v[24:27], v[52:55]
buffer_load_dwordx4 v[156:159], v3, s[44:47], s17 offen offset:1024 sc1
v_mfma_f32_16x16x32_bf16 v[56:59], v[148:151], v[24:27], v[56:59]
v_or_b32 v20, v20, v22
s_waitcnt lgkmcnt(0)
v_mfma_f32_16x16x32_bf16 v[60:63], v[96:99], v[170:173], v[60:63]
ds_read_b64_tr_b16 v[124:125], v4 offset:21504
ds_read_b64_tr_b16 v[126:127], v4 offset:25088
v_mfma_f32_16x16x32_bf16 v[64:67], v[100:103], v[170:173], v[64:67]
ds_read_b64_tr_b16 v[128:129], v4 offset:21536
ds_read_b64_tr_b16 v[130:131], v4 offset:25120
v_mfma_f32_16x16x32_bf16 v[68:71], v[104:107], v[170:173], v[68:71]
ds_read_b64_tr_b16 v[132:133], v4 offset:21568
ds_read_b64_tr_b16 v[134:135], v4 offset:25152
v_mfma_f32_16x16x32_bf16 v[72:75], v[108:111], v[170:173], v[72:75]
ds_read_b64_tr_b16 v[136:137], v4 offset:21600
ds_read_b64_tr_b16 v[138:139], v4 offset:25184
v_mfma_f32_16x16x32_bf16 v[76:79], v[112:115], v[170:173], v[76:79]
ds_read_b64_tr_b16 v[140:141], v4 offset:21632
ds_read_b64_tr_b16 v[142:143], v4 offset:25216
v_mfma_f32_16x16x32_bf16 v[80:83], v[116:119], v[170:173], v[80:83]
v_mov_b64 v[26:27], v[174:175]
v_mov_b64 v[24:25], v[168:169]
v_mfma_f32_16x16x32_bf16 v[84:87], v[120:123], v[170:173], v[84:87]
ds_read_b64_tr_b16 v[144:145], v4 offset:21664
ds_read_b64_tr_b16 v[146:147], v4 offset:25248
v_mfma_f32_16x16x32_bf16 v[32:35], v[96:99], v[24:27], v[32:35]
ds_read_b64_tr_b16 v[148:149], v4 offset:21696
ds_read_b64_tr_b16 v[150:151], v4 offset:25280
v_mfma_f32_16x16x32_bf16 v[36:39], v[100:103], v[24:27], v[36:39]
buffer_load_dwordx4 v[160:163], v3, s[44:47], s17 offen offset:2048 sc1
v_mfma_f32_16x16x32_bf16 v[40:43], v[104:107], v[24:27], v[40:43]
v_cmp_ne_u32 vcc, 0, v20
v_mfma_f32_16x16x32_bf16 v[44:47], v[108:111], v[24:27], v[44:47]
v_mfma_f32_16x16x32_bf16 v[48:51], v[112:115], v[24:27], v[48:51]
s_nop 1
s_cbranch_vccnz gsc_83
gsb_84:
v_mfma_f32_16x16x32_bf16 v[52:55], v[116:119], v[24:27], v[52:55]
buffer_load_dwordx4 v[164:167], v3, s[44:47], s17 offen offset:3072 sc1
v_mfma_f32_16x16x32_bf16 v[56:59], v[120:123], v[24:27], v[56:59]
v_add_f32 v224, v224, v228
s_waitcnt lgkmcnt(0)
v_mfma_f32_16x16x32_bf16 v[60:63], v[124:127], v[178:181], v[60:63]
ds_read_b64_tr_b16 v[96:97], v4 offset:28672
ds_read_b64_tr_b16 v[98:99], v4 offset:32256
v_mfma_f32_16x16x32_bf16 v[64:67], v[128:131], v[178:181], v[64:67]
ds_read_b64_tr_b16 v[100:101], v4 offset:28704
ds_read_b64_tr_b16 v[102:103], v4 offset:32288
v_mfma_f32_16x16x32_bf16 v[68:71], v[132:135], v[178:181], v[68:71]
ds_read_b64_tr_b16 v[104:105], v4 offset:28736
ds_read_b64_tr_b16 v[106:107], v4 offset:32320
v_mfma_f32_16x16x32_bf16 v[72:75], v[136:139], v[178:181], v[72:75]
ds_read_b64_tr_b16 v[108:109], v4 offset:28768
ds_read_b64_tr_b16 v[110:111], v4 offset:32352
v_mfma_f32_16x16x32_bf16 v[76:79], v[140:143], v[178:181], v[76:79]
ds_read_b64_tr_b16 v[112:113], v4 offset:28800
ds_read_b64_tr_b16 v[114:115], v4 offset:32384
v_mfma_f32_16x16x32_bf16 v[80:83], v[144:147], v[178:181], v[80:83]
v_mov_b64 v[26:27], v[182:183]
v_mov_b64 v[24:25], v[176:177]
v_mfma_f32_16x16x32_bf16 v[84:87], v[148:151], v[178:181], v[84:87]
ds_read_b64_tr_b16 v[116:117], v4 offset:28832
ds_read_b64_tr_b16 v[118:119], v4 offset:32416
v_mfma_f32_16x16x32_bf16 v[32:35], v[124:127], v[24:27], v[32:35]
s_add_u32 s17, s24, 36864
ds_read_b64_tr_b16 v[120:121], v4 offset:28864
v_mfma_f32_16x16x32_bf16 v[36:39], v[128:131], v[24:27], v[36:39]
buffer_load_dwordx4 v[168:171], v3, s[44:47], s17 offen offset:0 sc1
v_mfma_f32_16x16x32_bf16 v[40:43], v[132:135], v[24:27], v[40:43]
ds_read_b64_tr_b16 v[122:123], v4 offset:32448
v_add_f32 v225, v225, v229
v_mfma_f32_16x16x32_bf16 v[44:47], v[136:139], v[24:27], v[44:47]
v_add_f32 v216, v216, v220
v_add_f32 v217, v217, v221
v_mfma_f32_16x16x32_bf16 v[48:51], v[140:143], v[24:27], v[48:51]
v_add_f32 v224, v224, v216
v_add_f32 v225, v225, v217
v_mfma_f32_16x16x32_bf16 v[52:55], v[144:147], v[24:27], v[52:55]
buffer_load_dwordx4 v[172:175], v3, s[44:47], s17 offen offset:1024 sc1
v_mfma_f32_16x16x32_bf16 v[56:59], v[148:151], v[24:27], v[56:59]
s_waitcnt lgkmcnt(0)
v_mfma_f32_16x16x32_bf16 v[60:63], v[96:99], v[186:189], v[60:63]
ds_read_b64_tr_b16 v[124:125], v4 offset:35840
ds_read_b64_tr_b16 v[126:127], v4 offset:39424
v_mfma_f32_16x16x32_bf16 v[64:67], v[100:103], v[186:189], v[64:67]
ds_read_b64_tr_b16 v[128:129], v4 offset:35872
ds_read_b64_tr_b16 v[130:131], v4 offset:39456
v_mfma_f32_16x16x32_bf16 v[68:71], v[104:107], v[186:189], v[68:71]
ds_read_b64_tr_b16 v[132:133], v4 offset:35904
ds_read_b64_tr_b16 v[134:135], v4 offset:39488
v_mfma_f32_16x16x32_bf16 v[72:75], v[108:111], v[186:189], v[72:75]
ds_read_b64_tr_b16 v[136:137], v4 offset:35936
ds_read_b64_tr_b16 v[138:139], v4 offset:39520
v_mfma_f32_16x16x32_bf16 v[76:79], v[112:115], v[186:189], v[76:79]
ds_read_b64_tr_b16 v[140:141], v4 offset:35968
ds_read_b64_tr_b16 v[142:143], v4 offset:39552
v_mfma_f32_16x16x32_bf16 v[80:83], v[116:119], v[186:189], v[80:83]
v_mov_b64 v[26:27], v[190:191]
v_mov_b64 v[24:25], v[184:185]
v_mfma_f32_16x16x32_bf16 v[84:87], v[120:123], v[186:189], v[84:87]
ds_read_b64_tr_b16 v[144:145], v4 offset:36000
ds_read_b64_tr_b16 v[146:147], v4 offset:39584
v_mfma_f32_16x16x32_bf16 v[32:35], v[96:99], v[24:27], v[32:35]
ds_read_b64_tr_b16 v[148:149], v4 offset:36032
ds_read_b64_tr_b16 v[150:151], v4 offset:39616
v_mfma_f32_16x16x32_bf16 v[36:39], v[100:103], v[24:27], v[36:39]
buffer_load_dwordx4 v[176:179], v3, s[44:47], s17 offen offset:2048 sc1
v_mfma_f32_16x16x32_bf16 v[40:43], v[104:107], v[24:27], v[40:43]
v_mov_b32 v226, v224
v_mov_b32 v227, v225
v_mfma_f32_16x16x32_bf16 v[44:47], v[108:111], v[24:27], v[44:47]
v_mov_b32 v92, 0xc09d30fc
v_mov_b32 v93, 0xc09d30fc
v_mfma_f32_16x16x32_bf16 v[48:51], v[112:115], v[24:27], v[48:51]
v_permlane32_swap_b32 v224, v226
v_permlane32_swap_b32 v225, v227
v_mfma_f32_16x16x32_bf16 v[52:55], v[116:119], v[24:27], v[52:55]
buffer_load_dwordx4 v[180:183], v3, s[44:47], s17 offen offset:3072 sc1
v_mfma_f32_16x16x32_bf16 v[56:59], v[120:123], v[24:27], v[56:59]
v_add_f32 v224, v224, v226
s_waitcnt lgkmcnt(0)
v_add_u32 v23, 0xe000, v4
v_mfma_f32_16x16x32_bf16 v[60:63], v[124:127], v[194:197], v[60:63]
ds_read_b64_tr_b16 v[96:97], v4 offset:43008
ds_read_b64_tr_b16 v[98:99], v4 offset:46592
v_mfma_f32_16x16x32_bf16 v[64:67], v[128:131], v[194:197], v[64:67]
ds_read_b64_tr_b16 v[100:101], v4 offset:43040
ds_read_b64_tr_b16 v[102:103], v4 offset:46624
v_mfma_f32_16x16x32_bf16 v[68:71], v[132:135], v[194:197], v[68:71]
ds_read_b64_tr_b16 v[104:105], v4 offset:43200
ds_read_b64_tr_b16 v[106:107], v4 offset:46784
v_mfma_f32_16x16x32_bf16 v[72:75], v[136:139], v[194:197], v[72:75]
ds_read_b64_tr_b16 v[108:109], v4 offset:50176
ds_read_b64_tr_b16 v[110:111], v4 offset:53760
v_mfma_f32_16x16x32_bf16 v[76:79], v[140:143], v[194:197], v[76:79]
ds_read_b64_tr_b16 v[112:113], v4 offset:50208
ds_read_b64_tr_b16 v[114:115], v4 offset:53792
v_mfma_f32_16x16x32_bf16 v[80:83], v[144:147], v[194:197], v[80:83]
v_mov_b64 v[26:27], v[198:199]
v_mov_b64 v[24:25], v[192:193]
v_mfma_f32_16x16x32_bf16 v[84:87], v[148:151], v[194:197], v[84:87]
ds_read_b64_tr_b16 v[116:117], v4 offset:50368
ds_read_b64_tr_b16 v[118:119], v4 offset:53952
v_mfma_f32_16x16x32_bf16 v[32:35], v[124:127], v[24:27], v[32:35]
ds_read_b64_tr_b16 v[120:121], v23 offset:0
ds_read_b64_tr_b16 v[122:123], v23 offset:3584
v_mfma_f32_16x16x32_bf16 v[36:39], v[128:131], v[24:27], v[36:39]
v_add_f32 v225, v225, v227
v_mul_f32 v224, 0x3acccccd, v224
v_mfma_f32_16x16x32_bf16 v[40:43], v[132:135], v[24:27], v[40:43]
v_mul_f32 v225, 0x3acccccd, v225
v_fma_f32 v225, -v224, v224, v225
v_mfma_f32_16x16x32_bf16 v[44:47], v[136:139], v[24:27], v[44:47]
v_max_f32 v225, 0, v225
v_add_f32 v226, 0x3727c5ac, v225
v_mfma_f32_16x16x32_bf16 v[48:51], v[140:143], v[24:27], v[48:51]
v_rsq_f32 v226, v226
v_mfma_f32_16x16x32_bf16 v[52:55], v[144:147], v[24:27], v[52:55]
v_mul_f32 v225, v225, v226
v_fmaak_f32 v225, v225, v226, 0x3727c5ac
v_mfma_f32_16x16x32_bf16 v[56:59], v[148:151], v[24:27], v[56:59]
v_rsq_f32 v225, v225
s_waitcnt lgkmcnt(8)
v_mfma_f32_16x16x32_bf16 v[60:63], v[96:99], v[202:205], v[60:63]
v_mov_b64 v[24:25], v[200:201]
ds_read_b64_tr_b16 v[124:125], v23 offset:32
v_mfma_f32_16x16x32_bf16 v[64:67], v[100:103], v[202:205], v[64:67]
v_mov_b64 v[26:27], v[206:207]
ds_read_b64_tr_b16 v[126:127], v23 offset:3616
v_mfma_f32_16x16x32_bf16 v[84:87], v[104:107], v[202:205], v[84:87]
ds_read_b64_tr_b16 v[128:129], v23 offset:192
ds_read_b64_tr_b16 v[130:131], v23 offset:3776
v_mfma_f32_16x16x32_bf16 v[32:35], v[96:99], v[24:27], v[32:35]
ds_read_b64_tr_b16 v[132:133], v23 offset:7168
ds_read_b64_tr_b16 v[134:135], v23 offset:10752
v_mfma_f32_16x16x32_bf16 v[36:39], v[100:103], v[24:27], v[36:39]
ds_read_b64_tr_b16 v[136:137], v23 offset:7200
ds_read_b64_tr_b16 v[138:139], v23 offset:10784
v_mfma_f32_16x16x32_bf16 v[56:59], v[104:107], v[24:27], v[56:59]
ds_read_b64_tr_b16 v[140:141], v23 offset:7360
s_waitcnt vmcnt(8) lgkmcnt(11)
v_mfma_f32_16x16x32_bf16 v[60:63], v[108:111], v[210:213], v[60:63]
v_mov_b64 v[24:25], v[208:209]
ds_read_b64_tr_b16 v[142:143], v23 offset:10944
v_mfma_f32_16x16x32_bf16 v[64:67], v[112:115], v[210:213], v[64:67]
v_mov_b64 v[26:27], v[214:215]
ds_read_b64_tr_b16 v[144:145], v23 offset:14336
v_mfma_f32_16x16x32_bf16 v[84:87], v[116:119], v[210:213], v[84:87]
ds_read_b64_tr_b16 v[146:147], v23 offset:17920
ds_read_b64_tr_b16 v[148:149], v23 offset:14368
v_mfma_f32_16x16x32_bf16 v[32:35], v[108:111], v[24:27], v[32:35]
ds_read_b64_tr_b16 v[150:151], v23 offset:17952
ds_read_b64_tr_b16 v[96:97], v23 offset:14528
v_mfma_f32_16x16x32_bf16 v[36:39], v[112:115], v[24:27], v[36:39]
ds_read_b64_tr_b16 v[98:99], v23 offset:18112
ds_read_b64_tr_b16 v[112:113], v23 offset:21504
v_mfma_f32_16x16x32_bf16 v[56:59], v[116:119], v[24:27], v[56:59]
ds_read_b64_tr_b16 v[114:115], v23 offset:25088
s_waitcnt vmcnt(6) lgkmcnt(14)
v_mfma_f32_16x16x32_bf16 v[60:63], v[120:123], v[154:157], v[60:63]
v_mov_b64 v[24:25], v[152:153]
ds_read_b64_tr_b16 v[116:117], v23 offset:21536
v_mfma_f32_16x16x32_bf16 v[64:67], v[124:127], v[154:157], v[64:67]
v_mov_b64 v[26:27], v[158:159]
ds_read_b64_tr_b16 v[118:119], v23 offset:25120
v_mfma_f32_16x16x32_bf16 v[84:87], v[128:131], v[154:157], v[84:87]
ds_read_b64_tr_b16 v[100:101], v23 offset:21696
ds_read_b64_tr_b16 v[102:103], v23 offset:25280
v_mfma_f32_16x16x32_bf16 v[32:35], v[120:123], v[24:27], v[32:35]
ds_read_b64_tr_b16 v[104:105], v4 offset:43072
ds_read_b64_tr_b16 v[106:107], v4 offset:46656
v_mfma_f32_16x16x32_bf16 v[36:39], v[124:127], v[24:27], v[36:39]
ds_read_b64_tr_b16 v[108:109], v4 offset:43104
ds_read_b64_tr_b16 v[110:111], v4 offset:46688
v_mfma_f32_16x16x32_bf16 v[56:59], v[128:131], v[24:27], v[56:59]
v_add_u32 v6, 0, v5
s_waitcnt vmcnt(4) lgkmcnt(15)
v_mfma_f32_16x16x32_bf16 v[60:63], v[132:135], v[162:165], v[60:63]
v_mov_b64 v[24:25], v[160:161]
ds_read2_b32 v[184:185], v6 offset0:55 offset1:111
v_mfma_f32_16x16x32_bf16 v[64:67], v[136:139], v[162:165], v[64:67]
v_mov_b64 v[26:27], v[166:167]
ds_read2_b32 v[186:187], v6 offset0:167 offset1:223
v_mfma_f32_16x16x32_bf16 v[84:87], v[140:143], v[162:165], v[84:87]
v_add_u32 v7, 25088, v5
ds_read2_b32 v[188:189], v7 offset0:55 offset1:111
v_mfma_f32_16x16x32_bf16 v[32:35], v[132:135], v[24:27], v[32:35]
ds_read2_b32 v[190:191], v7 offset0:167 offset1:223
v_add_u32 v6, 3584, v5
v_mfma_f32_16x16x32_bf16 v[36:39], v[136:139], v[24:27], v[36:39]
ds_read_b64_tr_b16 v[136:137], v4 offset:43136
ds_read_b64_tr_b16 v[138:139], v4 offset:46720
v_mfma_f32_16x16x32_bf16 v[56:59], v[140:143], v[24:27], v[56:59]
ds_read_b64_tr_b16 v[140:141], v4 offset:43168
s_waitcnt vmcnt(2) lgkmcnt(15)
v_mfma_f32_16x16x32_bf16 v[60:63], v[144:147], v[170:173], v[60:63]
v_mov_b64 v[24:25], v[168:169]
ds_read_b64_tr_b16 v[142:143], v4 offset:46752
v_mfma_f32_16x16x32_bf16 v[64:67], v[148:151], v[170:173], v[64:67]
v_mov_b64 v[26:27], v[174:175]
ds_read2_b32 v[192:193], v6 offset0:55 offset1:111
v_mfma_f32_16x16x32_bf16 v[84:87], v[96:99], v[170:173], v[84:87]
ds_read2_b32 v[194:195], v6 offset0:167 offset1:223
v_add_u32 v7, 28672, v5
v_mfma_f32_16x16x32_bf16 v[32:35], v[144:147], v[24:27], v[32:35]
ds_read_b64_tr_b16 v[144:145], v4 offset:50240
ds_read_b64_tr_b16 v[146:147], v4 offset:53824
v_mfma_f32_16x16x32_bf16 v[36:39], v[148:151], v[24:27], v[36:39]
ds_read_b64_tr_b16 v[148:149], v4 offset:50272
ds_read_b64_tr_b16 v[150:151], v4 offset:53856
v_mfma_f32_16x16x32_bf16 v[56:59], v[96:99], v[24:27], v[56:59]
ds_read_b64_tr_b16 v[96:97], v4 offset:50304
s_waitcnt vmcnt(0) lgkmcnt(15)
v_mfma_f32_16x16x32_bf16 v[60:63], v[112:115], v[178:181], v[60:63]
v_mov_b64 v[24:25], v[176:177]
ds_read_b64_tr_b16 v[98:99], v4 offset:53888
v_mfma_f32_16x16x32_bf16 v[64:67], v[116:119], v[178:181], v[64:67]
v_mov_b64 v[26:27], v[182:183]
ds_read2_b32 v[196:197], v7 offset0:55 offset1:111
v_mfma_f32_16x16x32_bf16 v[84:87], v[100:103], v[178:181], v[84:87]
ds_read2_b32 v[198:199], v7 offset0:167 offset1:223
v_mul_f32 v226, s56, v226
v_mfma_f32_16x16x32_bf16 v[32:35], v[112:115], v[24:27], v[32:35]
v_mul_f32 v88, v225, v226
v_mul_f32 v89, -v224, v88
v_mfma_f32_16x16x32_bf16 v[36:39], v[116:119], v[24:27], v[36:39]
v_mov_b32 v90, v88
v_mov_b32 v91, v89
v_mfma_f32_16x16x32_bf16 v[56:59], v[100:103], v[24:27], v[56:59]
ds_read_b64_tr_b16 v[100:101], v4 offset:50336
s_waitcnt lgkmcnt(11)
v_permlane16_swap_b32 v88, v90
v_permlane16_swap_b32 v89, v91
s_waitcnt lgkmcnt(1)
v_pk_fma_f32 v[112:113], v[184:185], v[88:89], v[188:189] op_sel:[0,1,0] op_sel_hi:[1,1,1]
v_pk_fma_f32 v[114:115], v[186:187], v[88:89], v[190:191] op_sel:[0,1,0] op_sel_hi:[1,1,1]
v_pk_fma_f32 v[116:117], v[192:193], v[88:89], v[196:197] op_sel:[0,1,0] op_sel_hi:[1,1,1]
v_pk_fma_f32 v[118:119], v[194:195], v[88:89], v[198:199] op_sel:[0,1,0] op_sel_hi:[1,1,1]
v_pk_fma_f32 v[32:33], v[32:33], v[88:89], v[112:113] op_sel_hi:[1,0,1]
v_pk_fma_f32 v[34:35], v[34:35], v[88:89], v[114:115] op_sel_hi:[1,0,1]
v_pk_fma_f32 v[36:37], v[36:37], v[88:89], v[116:117] op_sel_hi:[1,0,1]
v_pk_fma_f32 v[38:39], v[38:39], v[88:89], v[118:119] op_sel_hi:[1,0,1]
v_pk_fma_f32 v[112:113], v[32:33], v[32:33], v[92:93] neg_lo:[1,0,0] neg_hi:[1,0,0]
v_pk_fma_f32 v[114:115], v[34:35], v[34:35], v[92:93] neg_lo:[1,0,0] neg_hi:[1,0,0]
v_pk_fma_f32 v[116:117], v[36:37], v[36:37], v[92:93] neg_lo:[1,0,0] neg_hi:[1,0,0]
v_pk_fma_f32 v[118:119], v[38:39], v[38:39], v[92:93] neg_lo:[1,0,0] neg_hi:[1,0,0]
v_pk_mul_f32 v[112:113], v[112:113], v[32:33]
v_pk_mul_f32 v[114:115], v[114:115], v[34:35]
v_pk_mul_f32 v[116:117], v[116:117], v[36:37]
v_pk_mul_f32 v[118:119], v[118:119], v[38:39]
v_exp_f32 v112, v112
v_exp_f32 v113, v113
v_exp_f32 v114, v114
v_exp_f32 v115, v115
v_exp_f32 v116, v116
v_exp_f32 v117, v117
v_exp_f32 v118, v118
v_exp_f32 v119, v119
v_pk_fma_f32 v[112:113], v[112:113], s[56:57], s[56:57]
v_pk_fma_f32 v[114:115], v[114:115], s[56:57], s[56:57]
v_pk_fma_f32 v[116:117], v[116:117], s[56:57], s[56:57]
v_pk_fma_f32 v[118:119], v[118:119], s[56:57], s[56:57]
v_rcp_f32 v112, v112
v_rcp_f32 v113, v113
v_rcp_f32 v114, v114
v_rcp_f32 v115, v115
v_rcp_f32 v116, v116
v_rcp_f32 v117, v117
v_rcp_f32 v118, v118
v_rcp_f32 v119, v119
v_pk_mul_f32 v[112:113], v[112:113], v[32:33]
v_pk_mul_f32 v[114:115], v[114:115], v[34:35]
v_pk_mul_f32 v[116:117], v[116:117], v[36:37]
v_pk_mul_f32 v[118:119], v[118:119], v[38:39]
v_cvt_pk_bf16_f32 v120, v112, v113
v_cvt_pk_bf16_f32 v121, v114, v115
v_cvt_pk_bf16_f32 v122, v116, v117
v_cvt_pk_bf16_f32 v123, v118, v119
s_add_u32 s8, s26, 0x1140000
buffer_store_dwordx4 v[120:123], v3, s[44:47], s8 offen sc1
v_pk_fma_f32 v[124:125], v[184:185], v[90:91], v[188:189] op_sel:[0,1,0] op_sel_hi:[1,1,1]
v_pk_fma_f32 v[126:127], v[186:187], v[90:91], v[190:191] op_sel:[0,1,0] op_sel_hi:[1,1,1]
v_pk_fma_f32 v[128:129], v[192:193], v[90:91], v[196:197] op_sel:[0,1,0] op_sel_hi:[1,1,1]
v_pk_fma_f32 v[130:131], v[194:195], v[90:91], v[198:199] op_sel:[0,1,0] op_sel_hi:[1,1,1]
v_pk_fma_f32 v[60:61], v[60:61], v[90:91], v[124:125] op_sel_hi:[1,0,1]
v_pk_fma_f32 v[62:63], v[62:63], v[90:91], v[126:127] op_sel_hi:[1,0,1]
v_pk_fma_f32 v[64:65], v[64:65], v[90:91], v[128:129] op_sel_hi:[1,0,1]
v_pk_fma_f32 v[66:67], v[66:67], v[90:91], v[130:131] op_sel_hi:[1,0,1]
v_pk_fma_f32 v[124:125], v[60:61], v[60:61], v[92:93] neg_lo:[1,0,0] neg_hi:[1,0,0]
v_pk_fma_f32 v[126:127], v[62:63], v[62:63], v[92:93] neg_lo:[1,0,0] neg_hi:[1,0,0]
v_pk_fma_f32 v[128:129], v[64:65], v[64:65], v[92:93] neg_lo:[1,0,0] neg_hi:[1,0,0]
v_pk_fma_f32 v[130:131], v[66:67], v[66:67], v[92:93] neg_lo:[1,0,0] neg_hi:[1,0,0]
v_pk_mul_f32 v[124:125], v[124:125], v[60:61]
v_pk_mul_f32 v[126:127], v[126:127], v[62:63]
v_pk_mul_f32 v[128:129], v[128:129], v[64:65]
v_pk_mul_f32 v[130:131], v[130:131], v[66:67]
v_exp_f32 v124, v124
v_exp_f32 v125, v125
v_exp_f32 v126, v126
v_exp_f32 v127, v127
v_exp_f32 v128, v128
v_exp_f32 v129, v129
v_exp_f32 v130, v130
v_exp_f32 v131, v131
v_pk_fma_f32 v[124:125], v[124:125], s[56:57], s[56:57]
v_pk_fma_f32 v[126:127], v[126:127], s[56:57], s[56:57]
v_pk_fma_f32 v[128:129], v[128:129], s[56:57], s[56:57]
v_pk_fma_f32 v[130:131], v[130:131], s[56:57], s[56:57]
v_rcp_f32 v124, v124
v_rcp_f32 v125, v125
v_rcp_f32 v126, v126
v_rcp_f32 v127, v127
v_rcp_f32 v128, v128
v_rcp_f32 v129, v129
v_rcp_f32 v130, v130
v_rcp_f32 v131, v131
v_pk_mul_f32 v[124:125], v[124:125], v[60:61]
v_pk_mul_f32 v[126:127], v[126:127], v[62:63]
v_pk_mul_f32 v[128:129], v[128:129], v[64:65]
v_pk_mul_f32 v[130:131], v[130:131], v[66:67]
v_cvt_pk_bf16_f32 v132, v124, v125
v_cvt_pk_bf16_f32 v133, v126, v127
v_cvt_pk_bf16_f32 v134, v128, v129
v_cvt_pk_bf16_f32 v135, v130, v131
s_add_u32 s8, s27, 0x1140000
buffer_store_dwordx4 v[132:135], v3, s[44:47], s8 offen sc1
v_mfma_f32_16x16x32_bf16 v[68:71], v[104:107], v[202:205], v[68:71]
v_mov_b64 v[24:25], v[200:201]
ds_read_b64_tr_b16 v[102:103], v4 offset:53920
v_mfma_f32_16x16x32_bf16 v[72:75], v[108:111], v[202:205], v[72:75]
v_mov_b64 v[26:27], v[206:207]
ds_read_b64_tr_b16 v[120:121], v23 offset:64
v_mfma_f32_16x16x32_bf16 v[76:79], v[136:139], v[202:205], v[76:79]
ds_read_b64_tr_b16 v[122:123], v23 offset:3648
ds_read_b64_tr_b16 v[124:125], v23 offset:96
v_mfma_f32_16x16x32_bf16 v[80:83], v[140:143], v[202:205], v[80:83]
ds_read_b64_tr_b16 v[126:127], v23 offset:3680
ds_read_b64_tr_b16 v[128:129], v23 offset:128
v_mfma_f32_16x16x32_bf16 v[40:43], v[104:107], v[24:27], v[40:43]
ds_read_b64_tr_b16 v[130:131], v23 offset:3712
ds_read_b64_tr_b16 v[132:133], v23 offset:160
v_mfma_f32_16x16x32_bf16 v[44:47], v[108:111], v[24:27], v[44:47]
ds_read_b64_tr_b16 v[134:135], v23 offset:3744
ds_read_b64_tr_b16 v[112:113], v23 offset:7232
v_mfma_f32_16x16x32_bf16 v[48:51], v[136:139], v[24:27], v[48:51]
ds_read_b64_tr_b16 v[114:115], v23 offset:10816
ds_read_b64_tr_b16 v[116:117], v23 offset:7264
v_mfma_f32_16x16x32_bf16 v[52:55], v[140:143], v[24:27], v[52:55]
ds_read_b64_tr_b16 v[118:119], v23 offset:10848
s_waitcnt lgkmcnt(12)
v_mfma_f32_16x16x32_bf16 v[68:71], v[144:147], v[210:213], v[68:71]
v_mov_b64 v[24:25], v[208:209]
ds_read_b64_tr_b16 v[104:105], v23 offset:7296
v_mfma_f32_16x16x32_bf16 v[72:75], v[148:151], v[210:213], v[72:75]
v_mov_b64 v[26:27], v[214:215]
ds_read_b64_tr_b16 v[106:107], v23 offset:10880
v_mfma_f32_16x16x32_bf16 v[76:79], v[96:99], v[210:213], v[76:79]
ds_read_b64_tr_b16 v[108:109], v23 offset:7328
ds_read_b64_tr_b16 v[110:111], v23 offset:10912
v_mfma_f32_16x16x32_bf16 v[80:83], v[100:103], v[210:213], v[80:83]
ds_read_b64_tr_b16 v[136:137], v23 offset:14400
ds_read_b64_tr_b16 v[138:139], v23 offset:17984
v_mfma_f32_16x16x32_bf16 v[40:43], v[144:147], v[24:27], v[40:43]
ds_read_b64_tr_b16 v[140:141], v23 offset:14432
ds_read_b64_tr_b16 v[142:143], v23 offset:18016
v_mfma_f32_16x16x32_bf16 v[44:47], v[148:151], v[24:27], v[44:47]
ds_read_b64_tr_b16 v[144:145], v23 offset:14464
ds_read_b64_tr_b16 v[146:147], v23 offset:18048
v_mfma_f32_16x16x32_bf16 v[48:51], v[96:99], v[24:27], v[48:51]
ds_read_b64_tr_b16 v[148:149], v23 offset:14496
ds_read_b64_tr_b16 v[150:151], v23 offset:18080
v_mfma_f32_16x16x32_bf16 v[52:55], v[100:103], v[24:27], v[52:55]
ds_read_b64_tr_b16 v[96:97], v23 offset:21568
s_waitcnt lgkmcnt(15)
v_mfma_f32_16x16x32_bf16 v[68:71], v[120:123], v[154:157], v[68:71]
v_mov_b64 v[24:25], v[152:153]
ds_read_b64_tr_b16 v[98:99], v23 offset:25152
v_mfma_f32_16x16x32_bf16 v[72:75], v[124:127], v[154:157], v[72:75]
v_mov_b64 v[26:27], v[158:159]
ds_read_b64_tr_b16 v[100:101], v23 offset:21600
v_mfma_f32_16x16x32_bf16 v[76:79], v[128:131], v[154:157], v[76:79]
ds_read_b64_tr_b16 v[102:103], v23 offset:25184
v_add_u32 v6, 7168, v5
v_mfma_f32_16x16x32_bf16 v[80:83], v[132:135], v[154:157], v[80:83]
ds_read2_b32 v[200:201], v6 offset0:55 offset1:111
ds_read2_b32 v[202:203], v6 offset0:167 offset1:223
v_mfma_f32_16x16x32_bf16 v[40:43], v[120:123], v[24:27], v[40:43]
ds_read_b64_tr_b16 v[120:121], v23 offset:21632
ds_read_b64_tr_b16 v[122:123], v23 offset:25216
v_mfma_f32_16x16x32_bf16 v[44:47], v[124:127], v[24:27], v[44:47]
ds_read_b64_tr_b16 v[124:125], v23 offset:21664
ds_read_b64_tr_b16 v[126:127], v23 offset:25248
v_mfma_f32_16x16x32_bf16 v[48:51], v[128:131], v[24:27], v[48:51]
v_add_u32 v7, 32256, v5
ds_read2_b32 v[204:205], v7 offset0:55 offset1:111
v_mfma_f32_16x16x32_bf16 v[52:55], v[132:135], v[24:27], v[52:55]
ds_read2_b32 v[206:207], v7 offset0:167 offset1:223
s_waitcnt lgkmcnt(15)
v_mfma_f32_16x16x32_bf16 v[68:71], v[112:115], v[162:165], v[68:71]
v_mov_b64 v[24:25], v[160:161]
v_add_u32 v6, 10752, v5
v_mfma_f32_16x16x32_bf16 v[72:75], v[116:119], v[162:165], v[72:75]
v_mov_b64 v[26:27], v[166:167]
ds_read2_b32 v[208:209], v6 offset0:55 offset1:111
v_mfma_f32_16x16x32_bf16 v[76:79], v[104:107], v[162:165], v[76:79]
ds_read2_b32 v[210:211], v6 offset0:167 offset1:223
v_add_u32 v7, 35840, v5
v_mfma_f32_16x16x32_bf16 v[80:83], v[108:111], v[162:165], v[80:83]
ds_read2_b32 v[212:213], v7 offset0:55 offset1:111
ds_read2_b32 v[214:215], v7 offset0:167 offset1:223
v_mfma_f32_16x16x32_bf16 v[40:43], v[112:115], v[24:27], v[40:43]
v_add_u32 v6, 14336, v5
ds_read2_b32 v[152:153], v6 offset0:55 offset1:111
v_mfma_f32_16x16x32_bf16 v[44:47], v[116:119], v[24:27], v[44:47]
ds_read2_b32 v[154:155], v6 offset0:167 offset1:223
v_add_u32 v7, 39424, v5
v_mfma_f32_16x16x32_bf16 v[48:51], v[104:107], v[24:27], v[48:51]
ds_read2_b32 v[156:157], v7 offset0:55 offset1:111
ds_read2_b32 v[158:159], v7 offset0:167 offset1:223
v_mfma_f32_16x16x32_bf16 v[52:55], v[108:111], v[24:27], v[52:55]
s_waitcnt lgkmcnt(15)
v_mfma_f32_16x16x32_bf16 v[68:71], v[136:139], v[170:173], v[68:71]
v_mov_b64 v[24:25], v[168:169]
v_add_u32 v6, 17920, v5
v_mfma_f32_16x16x32_bf16 v[72:75], v[140:143], v[170:173], v[72:75]
v_mov_b64 v[26:27], v[174:175]
ds_read2_b32 v[160:161], v6 offset0:55 offset1:111
v_mfma_f32_16x16x32_bf16 v[76:79], v[144:147], v[170:173], v[76:79]
ds_read2_b32 v[162:163], v6 offset0:167 offset1:223
v_add_u32 v7, 43008, v5
v_mfma_f32_16x16x32_bf16 v[80:83], v[148:151], v[170:173], v[80:83]
ds_read2_b32 v[164:165], v7 offset0:55 offset1:111
ds_read2_b32 v[166:167], v7 offset0:167 offset1:223
v_mfma_f32_16x16x32_bf16 v[40:43], v[136:139], v[24:27], v[40:43]
v_mfma_f32_16x16x32_bf16 v[44:47], v[140:143], v[24:27], v[44:47]
v_mfma_f32_16x16x32_bf16 v[48:51], v[144:147], v[24:27], v[48:51]
v_mfma_f32_16x16x32_bf16 v[52:55], v[148:151], v[24:27], v[52:55]
s_waitcnt lgkmcnt(14)
v_mfma_f32_16x16x32_bf16 v[68:71], v[96:99], v[178:181], v[68:71]
v_mov_b64 v[24:25], v[176:177]
v_add_u32 v6, 21504, v5
v_mfma_f32_16x16x32_bf16 v[72:75], v[100:103], v[178:181], v[72:75]
v_mov_b64 v[26:27], v[182:183]
ds_read2_b32 v[168:169], v6 offset0:55 offset1:111
v_mfma_f32_16x16x32_bf16 v[76:79], v[120:123], v[178:181], v[76:79]
ds_read2_b32 v[170:171], v6 offset0:167 offset1:223
v_add_u32 v7, 46592, v5
v_mfma_f32_16x16x32_bf16 v[80:83], v[124:127], v[178:181], v[80:83]
ds_read2_b32 v[172:173], v7 offset0:55 offset1:111
ds_read2_b32 v[174:175], v7 offset0:167 offset1:223
v_mfma_f32_16x16x32_bf16 v[40:43], v[96:99], v[24:27], v[40:43]
s_waitcnt vmcnt(0)
s_cmp_lg_u32 s7, 0
s_cbranch_scc1 postc_85
buffer_store_dword v2, off, s[44:47], s13 offset:0
postb_86:
v_mfma_f32_16x16x32_bf16 v[44:47], v[100:103], v[24:27], v[44:47]
v_mfma_f32_16x16x32_bf16 v[48:51], v[120:123], v[24:27], v[48:51]
v_mfma_f32_16x16x32_bf16 v[52:55], v[124:127], v[24:27], v[52:55]
mid_87:
v_and_b32 v6, 48, v1
v_lshrrev_b32 v7, 1, v6
v_mov_b32 v148, v3
v_add_u32 v149, 4096, v3
v_add_u32 v150, 0x1140000, v3
s_waitcnt lgkmcnt(0)
v_pk_fma_f32 v[112:113], v[200:201], v[88:89], v[204:205] op_sel:[0,1,0] op_sel_hi:[1,1,1]
v_pk_fma_f32 v[114:115], v[202:203], v[88:89], v[206:207] op_sel:[0,1,0] op_sel_hi:[1,1,1]
v_pk_fma_f32 v[116:117], v[208:209], v[88:89], v[212:213] op_sel:[0,1,0] op_sel_hi:[1,1,1]
v_pk_fma_f32 v[118:119], v[210:211], v[88:89], v[214:215] op_sel:[0,1,0] op_sel_hi:[1,1,1]
v_pk_fma_f32 v[40:41], v[40:41], v[88:89], v[112:113] op_sel_hi:[1,0,1]
v_pk_fma_f32 v[42:43], v[42:43], v[88:89], v[114:115] op_sel_hi:[1,0,1]
v_pk_fma_f32 v[44:45], v[44:45], v[88:89], v[116:117] op_sel_hi:[1,0,1]
v_pk_fma_f32 v[46:47], v[46:47], v[88:89], v[118:119] op_sel_hi:[1,0,1]
v_pk_fma_f32 v[112:113], v[40:41], v[40:41], v[92:93] neg_lo:[1,0,0] neg_hi:[1,0,0]
v_pk_fma_f32 v[114:115], v[42:43], v[42:43], v[92:93] neg_lo:[1,0,0] neg_hi:[1,0,0]
v_pk_fma_f32 v[116:117], v[44:45], v[44:45], v[92:93] neg_lo:[1,0,0] neg_hi:[1,0,0]
v_pk_fma_f32 v[118:119], v[46:47], v[46:47], v[92:93] neg_lo:[1,0,0] neg_hi:[1,0,0]
v_pk_mul_f32 v[112:113], v[112:113], v[40:41]
v_pk_mul_f32 v[114:115], v[114:115], v[42:43]
v_pk_mul_f32 v[116:117], v[116:117], v[44:45]
v_pk_mul_f32 v[118:119], v[118:119], v[46:47]
v_exp_f32 v112, v112
v_exp_f32 v113, v113
v_exp_f32 v114, v114
v_exp_f32 v115, v115
v_exp_f32 v116, v116
v_exp_f32 v117, v117
buffer_load_dwordx4 v[136:139], v6, s[60:63], s30 offen
v_exp_f32 v118, v118
v_exp_f32 v119, v119
v_pk_fma_f32 v[112:113], v[112:113], s[56:57], s[56:57]
v_pk_fma_f32 v[114:115], v[114:115], s[56:57], s[56:57]
v_pk_fma_f32 v[116:117], v[116:117], s[56:57], s[56:57]
v_pk_fma_f32 v[118:119], v[118:119], s[56:57], s[56:57]
v_rcp_f32 v112, v112
v_rcp_f32 v113, v113
v_rcp_f32 v114, v114
v_rcp_f32 v115, v115
v_rcp_f32 v116, v116
v_rcp_f32 v117, v117
v_rcp_f32 v118, v118
v_rcp_f32 v119, v119
v_pk_mul_f32 v[112:113], v[112:113], v[40:41]
v_pk_mul_f32 v[114:115], v[114:115], v[42:43]
v_pk_mul_f32 v[116:117], v[116:117], v[44:45]
v_pk_mul_f32 v[118:119], v[118:119], v[46:47]
v_cvt_pk_bf16_f32 v120, v112, v113
v_cvt_pk_bf16_f32 v121, v114, v115
v_cvt_pk_bf16_f32 v122, v116, v117
v_cvt_pk_bf16_f32 v123, v118, v119
buffer_store_dwordx4 v[120:123], v3, s[44:47], s26 offen offset:0
v_pk_fma_f32 v[124:125], v[200:201], v[90:91], v[204:205] op_sel:[0,1,0] op_sel_hi:[1,1,1]
v_pk_fma_f32 v[126:127], v[202:203], v[90:91], v[206:207] op_sel:[0,1,0] op_sel_hi:[1,1,1]
v_pk_fma_f32 v[128:129], v[208:209], v[90:91], v[212:213] op_sel:[0,1,0] op_sel_hi:[1,1,1]
v_pk_fma_f32 v[130:131], v[210:211], v[90:91], v[214:215] op_sel:[0,1,0] op_sel_hi:[1,1,1]
v_pk_fma_f32 v[68:69], v[68:69], v[90:91], v[124:125] op_sel_hi:[1,0,1]
v_pk_fma_f32 v[70:71], v[70:71], v[90:91], v[126:127] op_sel_hi:[1,0,1]
v_pk_fma_f32 v[72:73], v[72:73], v[90:91], v[128:129] op_sel_hi:[1,0,1]
v_pk_fma_f32 v[74:75], v[74:75], v[90:91], v[130:131] op_sel_hi:[1,0,1]
v_pk_fma_f32 v[124:125], v[68:69], v[68:69], v[92:93] neg_lo:[1,0,0] neg_hi:[1,0,0]
v_pk_fma_f32 v[126:127], v[70:71], v[70:71], v[92:93] neg_lo:[1,0,0] neg_hi:[1,0,0]
v_pk_fma_f32 v[128:129], v[72:73], v[72:73], v[92:93] neg_lo:[1,0,0] neg_hi:[1,0,0]
v_pk_fma_f32 v[130:131], v[74:75], v[74:75], v[92:93] neg_lo:[1,0,0] neg_hi:[1,0,0]
v_pk_mul_f32 v[124:125], v[124:125], v[68:69]
v_pk_mul_f32 v[126:127], v[126:127], v[70:71]
v_pk_mul_f32 v[128:129], v[128:129], v[72:73]
v_pk_mul_f32 v[130:131], v[130:131], v[74:75]
v_exp_f32 v124, v124
v_exp_f32 v125, v125
v_exp_f32 v126, v126
v_exp_f32 v127, v127
v_exp_f32 v128, v128
v_exp_f32 v129, v129
buffer_load_dwordx4 v[140:143], v6, s[60:63], s30 offen offset:64
v_exp_f32 v130, v130
v_exp_f32 v131, v131
v_pk_fma_f32 v[124:125], v[124:125], s[56:57], s[56:57]
v_pk_fma_f32 v[126:127], v[126:127], s[56:57], s[56:57]
v_pk_fma_f32 v[128:129], v[128:129], s[56:57], s[56:57]
v_pk_fma_f32 v[130:131], v[130:131], s[56:57], s[56:57]
v_rcp_f32 v124, v124
v_rcp_f32 v125, v125
v_rcp_f32 v126, v126
v_rcp_f32 v127, v127
v_rcp_f32 v128, v128
v_rcp_f32 v129, v129
v_rcp_f32 v130, v130
v_rcp_f32 v131, v131
v_pk_mul_f32 v[124:125], v[124:125], v[68:69]
v_pk_mul_f32 v[126:127], v[126:127], v[70:71]
v_pk_mul_f32 v[128:129], v[128:129], v[72:73]
v_pk_mul_f32 v[130:131], v[130:131], v[74:75]
v_cvt_pk_bf16_f32 v132, v124, v125
v_cvt_pk_bf16_f32 v133, v126, v127
v_cvt_pk_bf16_f32 v134, v128, v129
v_cvt_pk_bf16_f32 v135, v130, v131
buffer_store_dwordx4 v[132:135], v3, s[44:47], s27 offen offset:0
buffer_load_dword v30, v31, s[44:47], s12 offen offset:0 sc1
v_pk_fma_f32 v[112:113], v[152:153], v[88:89], v[156:157] op_sel:[0,1,0] op_sel_hi:[1,1,1]
v_pk_fma_f32 v[114:115], v[154:155], v[88:89], v[158:159] op_sel:[0,1,0] op_sel_hi:[1,1,1]
v_pk_fma_f32 v[116:117], v[160:161], v[88:89], v[164:165] op_sel:[0,1,0] op_sel_hi:[1,1,1]
v_pk_fma_f32 v[118:119], v[162:163], v[88:89], v[166:167] op_sel:[0,1,0] op_sel_hi:[1,1,1]
v_pk_fma_f32 v[48:49], v[48:49], v[88:89], v[112:113] op_sel_hi:[1,0,1]
v_pk_fma_f32 v[50:51], v[50:51], v[88:89], v[114:115] op_sel_hi:[1,0,1]
v_pk_fma_f32 v[52:53], v[52:53], v[88:89], v[116:117] op_sel_hi:[1,0,1]
v_pk_fma_f32 v[54:55], v[54:55], v[88:89], v[118:119] op_sel_hi:[1,0,1]
v_pk_fma_f32 v[112:113], v[48:49], v[48:49], v[92:93] neg_lo:[1,0,0] neg_hi:[1,0,0]
v_pk_fma_f32 v[114:115], v[50:51], v[50:51], v[92:93] neg_lo:[1,0,0] neg_hi:[1,0,0]
v_pk_fma_f32 v[116:117], v[52:53], v[52:53], v[92:93] neg_lo:[1,0,0] neg_hi:[1,0,0]
v_pk_fma_f32 v[118:119], v[54:55], v[54:55], v[92:93] neg_lo:[1,0,0] neg_hi:[1,0,0]
v_pk_mul_f32 v[112:113], v[112:113], v[48:49]
v_pk_mul_f32 v[114:115], v[114:115], v[50:51]
v_pk_mul_f32 v[116:117], v[116:117], v[52:53]
v_pk_mul_f32 v[118:119], v[118:119], v[54:55]
v_exp_f32 v112, v112
v_exp_f32 v113, v113
v_exp_f32 v114, v114
v_exp_f32 v115, v115
v_exp_f32 v116, v116
v_exp_f32 v117, v117
buffer_load_dwordx2 v[144:145], v7, s[60:63], s30 offen offset:128
v_exp_f32 v118, v118
v_exp_f32 v119, v119
v_pk_fma_f32 v[112:113], v[112:113], s[56:57], s[56:57]
v_pk_fma_f32 v[114:115], v[114:115], s[56:57], s[56:57]
v_pk_fma_f32 v[116:117], v[116:117], s[56:57], s[56:57]
v_pk_fma_f32 v[118:119], v[118:119], s[56:57], s[56:57]
v_rcp_f32 v112, v112
v_rcp_f32 v113, v113
v_rcp_f32 v114, v114
v_rcp_f32 v115, v115
v_rcp_f32 v116, v116
v_rcp_f32 v117, v117
v_rcp_f32 v118, v118
v_rcp_f32 v119, v119
v_pk_mul_f32 v[112:113], v[112:113], v[48:49]
v_pk_mul_f32 v[114:115], v[114:115], v[50:51]
v_pk_mul_f32 v[116:117], v[116:117], v[52:53]
v_pk_mul_f32 v[118:119], v[118:119], v[54:55]
v_cvt_pk_bf16_f32 v120, v112, v113
v_cvt_pk_bf16_f32 v121, v114, v115
v_cvt_pk_bf16_f32 v122, v116, v117
v_cvt_pk_bf16_f32 v123, v118, v119
buffer_store_dwordx4 v[120:123], v3, s[44:47], s40 offen offset:0
s_waitcnt vmcnt(2)
v_cmp_ne_u32 vcc, s99, v30
s_nop 3
s_cbranch_vccnz chkc_88
chkb_89:
s_cmp_lg_u32 s7, 0
s_cbranch_scc1 postc_90
buffer_store_dword v2, off, s[44:47], s13 offset:256
postb_91:
v_pk_fma_f32 v[124:125], v[152:153], v[90:91], v[156:157] op_sel:[0,1,0] op_sel_hi:[1,1,1]
v_pk_fma_f32 v[126:127], v[154:155], v[90:91], v[158:159] op_sel:[0,1,0] op_sel_hi:[1,1,1]
v_pk_fma_f32 v[128:129], v[160:161], v[90:91], v[164:165] op_sel:[0,1,0] op_sel_hi:[1,1,1]
v_pk_fma_f32 v[130:131], v[162:163], v[90:91], v[166:167] op_sel:[0,1,0] op_sel_hi:[1,1,1]
v_pk_fma_f32 v[76:77], v[76:77], v[90:91], v[124:125] op_sel_hi:[1,0,1]
v_pk_fma_f32 v[78:79], v[78:79], v[90:91], v[126:127] op_sel_hi:[1,0,1]
v_pk_fma_f32 v[80:81], v[80:81], v[90:91], v[128:129] op_sel_hi:[1,0,1]
v_pk_fma_f32 v[82:83], v[82:83], v[90:91], v[130:131] op_sel_hi:[1,0,1]
buffer_load_dwordx4 v[184:187], v150, s[44:47], s20 offen offset:0 sc1
v_pk_fma_f32 v[124:125], v[76:77], v[76:77], v[92:93] neg_lo:[1,0,0] neg_hi:[1,0,0]
v_pk_fma_f32 v[126:127], v[78:79], v[78:79], v[92:93] neg_lo:[1,0,0] neg_hi:[1,0,0]
v_pk_fma_f32 v[128:129], v[80:81], v[80:81], v[92:93] neg_lo:[1,0,0] neg_hi:[1,0,0]
v_pk_fma_f32 v[130:131], v[82:83], v[82:83], v[92:93] neg_lo:[1,0,0] neg_hi:[1,0,0]
v_pk_mul_f32 v[124:125], v[124:125], v[76:77]
v_pk_mul_f32 v[126:127], v[126:127], v[78:79]
v_pk_mul_f32 v[128:129], v[128:129], v[80:81]
v_pk_mul_f32 v[130:131], v[130:131], v[82:83]
v_exp_f32 v124, v124
buffer_load_dwordx4 v[188:191], v150, s[44:47], s21 offen offset:0 sc1
v_exp_f32 v125, v125
v_exp_f32 v126, v126
v_exp_f32 v127, v127
v_exp_f32 v128, v128
v_exp_f32 v129, v129
v_exp_f32 v130, v130
v_exp_f32 v131, v131
v_pk_fma_f32 v[124:125], v[124:125], s[56:57], s[56:57]
v_pk_fma_f32 v[126:127], v[126:127], s[56:57], s[56:57]
buffer_load_dwordx4 v[192:195], v150, s[44:47], s22 offen offset:0 sc1
v_pk_fma_f32 v[128:129], v[128:129], s[56:57], s[56:57]
v_pk_fma_f32 v[130:131], v[130:131], s[56:57], s[56:57]
v_rcp_f32 v124, v124
v_rcp_f32 v125, v125
v_rcp_f32 v126, v126
v_rcp_f32 v127, v127
v_rcp_f32 v128, v128
v_rcp_f32 v129, v129
v_rcp_f32 v130, v130
buffer_load_dwordx4 v[196:199], v150, s[44:47], s23 offen offset:0 sc1
v_rcp_f32 v131, v131
v_pk_mul_f32 v[124:125], v[124:125], v[76:77]
v_pk_mul_f32 v[126:127], v[126:127], v[78:79]
v_pk_mul_f32 v[128:129], v[128:129], v[80:81]
v_pk_mul_f32 v[130:131], v[130:131], v[82:83]
v_cvt_pk_bf16_f32 v132, v124, v125
v_cvt_pk_bf16_f32 v133, v126, v127
v_cvt_pk_bf16_f32 v134, v128, v129
v_cvt_pk_bf16_f32 v135, v130, v131
buffer_store_dwordx4 v[132:135], v3, s[44:47], s41 offen offset:0
v_pk_fma_f32 v[112:113], v[168:169], v[88:89], v[172:173] op_sel:[0,1,0] op_sel_hi:[1,1,1]
v_pk_fma_f32 v[114:115], v[170:171], v[88:89], v[174:175] op_sel:[0,1,0] op_sel_hi:[1,1,1]
v_pk_fma_f32 v[116:117], v[168:169], v[90:91], v[172:173] op_sel:[0,1,0] op_sel_hi:[1,1,1]
v_pk_fma_f32 v[118:119], v[170:171], v[90:91], v[174:175] op_sel:[0,1,0] op_sel_hi:[1,1,1]
v_pk_fma_f32 v[56:57], v[56:57], v[88:89], v[112:113] op_sel_hi:[1,0,1]
v_pk_fma_f32 v[58:59], v[58:59], v[88:89], v[114:115] op_sel_hi:[1,0,1]
v_pk_fma_f32 v[84:85], v[84:85], v[90:91], v[116:117] op_sel_hi:[1,0,1]
v_pk_fma_f32 v[86:87], v[86:87], v[90:91], v[118:119] op_sel_hi:[1,0,1]
buffer_load_dwordx4 v[224:227], v150, s[44:47], s20 offen offset:1024 sc1
v_pk_fma_f32 v[112:113], v[56:57], v[56:57], v[92:93] neg_lo:[1,0,0] neg_hi:[1,0,0]
v_pk_fma_f32 v[114:115], v[58:59], v[58:59], v[92:93] neg_lo:[1,0,0] neg_hi:[1,0,0]
v_pk_fma_f32 v[116:117], v[84:85], v[84:85], v[92:93] neg_lo:[1,0,0] neg_hi:[1,0,0]
v_pk_fma_f32 v[118:119], v[86:87], v[86:87], v[92:93] neg_lo:[1,0,0] neg_hi:[1,0,0]
v_pk_mul_f32 v[112:113], v[112:113], v[56:57]
v_pk_mul_f32 v[114:115], v[114:115], v[58:59]
v_pk_mul_f32 v[116:117], v[116:117], v[84:85]
v_pk_mul_f32 v[118:119], v[118:119], v[86:87]
v_exp_f32 v112, v112
buffer_load_dwordx4 v[228:231], v150, s[44:47], s21 offen offset:1024 sc1
v_exp_f32 v113, v113
v_exp_f32 v114, v114
v_exp_f32 v115, v115
v_exp_f32 v116, v116
v_exp_f32 v117, v117
v_exp_f32 v118, v118
v_exp_f32 v119, v119
v_pk_fma_f32 v[112:113], v[112:113], s[56:57], s[56:57]
v_pk_fma_f32 v[114:115], v[114:115], s[56:57], s[56:57]
buffer_load_dwordx4 v[216:219], v150, s[44:47], s22 offen offset:1024 sc1
v_pk_fma_f32 v[116:117], v[116:117], s[56:57], s[56:57]
v_pk_fma_f32 v[118:119], v[118:119], s[56:57], s[56:57]
v_rcp_f32 v112, v112
v_rcp_f32 v113, v113
v_rcp_f32 v114, v114
v_rcp_f32 v115, v115
v_rcp_f32 v116, v116
v_rcp_f32 v117, v117
v_rcp_f32 v118, v118
buffer_load_dwordx4 v[220:223], v150, s[44:47], s23 offen offset:1024 sc1
v_rcp_f32 v119, v119
v_pk_mul_f32 v[112:113], v[112:113], v[56:57]
v_pk_mul_f32 v[114:115], v[114:115], v[58:59]
v_pk_mul_f32 v[116:117], v[116:117], v[84:85]
v_pk_mul_f32 v[118:119], v[118:119], v[86:87]
v_cvt_pk_bf16_f32 v120, v112, v113
v_cvt_pk_bf16_f32 v121, v114, v115
v_cvt_pk_bf16_f32 v122, v116, v117
v_cvt_pk_bf16_f32 v123, v118, v119
v_cndmask_b32 v120, 0, v120, s[58:59]
v_cndmask_b32 v121, 0, v121, s[58:59]
v_cndmask_b32 v122, 0, v122, s[58:59]
v_cndmask_b32 v123, 0, v123, s[58:59]
buffer_store_dwordx2 v[120:121], v3, s[44:47], s28 offen
buffer_store_dwordx2 v[122:123], v3, s[44:47], s29 offen
s_waitcnt vmcnt(10)
v_mfma_f32_16x16x32_bf16 v[32:35], a[0:3], v[184:187], 0
buffer_load_dwordx4 v[176:179], v150, s[44:47], s20 offen offset:2048 sc1
s_mul_i32 s8, s5, 5120
v_mfma_f32_16x16x32_bf16 v[36:39], a[4:7], v[184:187], 0
s_add_u32 s8, s8, 102400
v_add_u32 v4, s8, v3
v_mfma_f32_16x16x32_bf16 v[40:43], a[8:11], v[184:187], 0
s_add_u32 s8, s5, 3
s_and_b32 s8, s8, 3
v_mfma_f32_16x16x32_bf16 v[44:47], a[12:15], v[184:187], 0
s_mul_i32 s8, s8, 5120
s_add_u32 s8, s8, 102400
v_mfma_f32_16x16x32_bf16 v[48:51], a[16:19], v[184:187], 0
buffer_load_dwordx4 v[180:183], v150, s[44:47], s21 offen offset:2048 sc1
s_waitcnt vmcnt(11)
v_mfma_f32_16x16x32_bf16 v[52:55], a[0:3], v[188:191], 0
v_add_u32 v5, s8, v3
v_mfma_f32_16x16x32_bf16 v[56:59], a[4:7], v[188:191], 0
v_mfma_f32_16x16x32_bf16 v[60:63], a[8:11], v[188:191], 0
v_mfma_f32_16x16x32_bf16 v[64:67], a[12:15], v[188:191], 0
buffer_load_dwordx4 v[200:203], v150, s[44:47], s22 offen offset:2048 sc1
v_mfma_f32_16x16x32_bf16 v[68:71], a[16:19], v[188:191], 0
s_waitcnt vmcnt(11)
v_mfma_f32_16x16x32_bf16 v[72:75], a[0:3], v[192:195], 0
v_mfma_f32_16x16x32_bf16 v[76:79], a[4:7], v[192:195], 0
v_mfma_f32_16x16x32_bf16 v[80:83], a[8:11], v[192:195], 0
buffer_load_dwordx4 v[204:207], v150, s[44:47], s23 offen offset:2048 sc1
v_mfma_f32_16x16x32_bf16 v[84:87], a[12:15], v[192:195], 0
v_mfma_f32_16x16x32_bf16 v[88:91], a[16:19], v[192:195], 0
s_waitcnt vmcnt(11)
v_mfma_f32_16x16x32_bf16 v[92:95], a[0:3], v[196:199], 0
v_mfma_f32_16x16x32_bf16 v[96:99], a[4:7], v[196:199], 0
buffer_load_dwordx4 v[208:211], v150, s[44:47], s20 offen offset:3072 sc1
v_mfma_f32_16x16x32_bf16 v[100:103], a[8:11], v[196:199], 0
v_mfma_f32_16x16x32_bf16 v[104:107], a[12:15], v[196:199], 0
v_mfma_f32_16x16x32_bf16 v[108:111], a[16:19], v[196:199], 0
s_waitcnt vmcnt(10)
v_mfma_f32_16x16x32_bf16 v[32:35], a[20:23], v[224:227], v[32:35]
buffer_load_dword v7, v31, s[44:47], s12 offen offset:256 sc1
v_mfma_f32_16x16x32_bf16 v[36:39], a[24:27], v[224:227], v[36:39]
buffer_load_dwordx4 v[212:215], v150, s[44:47], s21 offen offset:3072 sc1
v_mfma_f32_16x16x32_bf16 v[40:43], a[28:31], v[224:227], v[40:43]
v_mfma_f32_16x16x32_bf16 v[44:47], a[32:35], v[224:227], v[44:47]
v_mfma_f32_16x16x32_bf16 v[48:51], a[36:39], v[224:227], v[48:51]
s_waitcnt vmcnt(11)
v_mfma_f32_16x16x32_bf16 v[52:55], a[20:23], v[228:231], v[52:55]
buffer_load_dwordx4 v[184:187], v150, s[44:47], s22 offen offset:3072 sc1
v_mfma_f32_16x16x32_bf16 v[56:59], a[24:27], v[228:231], v[56:59]
v_mfma_f32_16x16x32_bf16 v[60:63], a[28:31], v[228:231], v[60:63]
v_mfma_f32_16x16x32_bf16 v[64:67], a[32:35], v[228:231], v[64:67]
v_mfma_f32_16x16x32_bf16 v[68:71], a[36:39], v[228:231], v[68:71]
buffer_load_dwordx4 v[188:191], v150, s[44:47], s23 offen offset:3072 sc1
s_waitcnt vmcnt(12)
v_mfma_f32_16x16x32_bf16 v[72:75], a[20:23], v[216:219], v[72:75]
s_waitcnt vmcnt(9)
s_cmp_lg_u32 s7, 0
s_cbranch_scc1 postc_92
buffer_store_dword v2, off, s[44:47], s13 offset:512
postb_93:
v_mfma_f32_16x16x32_bf16 v[76:79], a[24:27], v[216:219], v[76:79]
v_lshlrev_b32 v152, 16, v8
v_and_b32 v153, s14, v8
v_mfma_f32_16x16x32_bf16 v[80:83], a[28:31], v[216:219], v[80:83]
v_lshlrev_b32 v172, 16, v136
v_and_b32 v173, s14, v136
v_mfma_f32_16x16x32_bf16 v[84:87], a[32:35], v[216:219], v[84:87]
v_add_f32 v152, v152, v172
v_add_f32 v153, v153, v173
v_mfma_f32_16x16x32_bf16 v[88:91], a[36:39], v[216:219], v[88:91]
v_lshlrev_b32 v154, 16, v9
v_mfma_f32_16x16x32_bf16 v[92:95], a[20:23], v[220:223], v[92:95]
v_and_b32 v155, s14, v9
v_lshlrev_b32 v174, 16, v137
v_mfma_f32_16x16x32_bf16 v[96:99], a[24:27], v[220:223], v[96:99]
v_and_b32 v175, s14, v137
v_add_f32 v154, v154, v174
v_mfma_f32_16x16x32_bf16 v[100:103], a[28:31], v[220:223], v[100:103]
v_add_f32 v155, v155, v175
v_lshlrev_b32 v156, 16, v10
v_mfma_f32_16x16x32_bf16 v[104:107], a[32:35], v[220:223], v[104:107]
v_and_b32 v157, s14, v10
v_lshlrev_b32 v172, 16, v138
v_mfma_f32_16x16x32_bf16 v[108:111], a[36:39], v[220:223], v[108:111]
v_and_b32 v173, s14, v138
s_waitcnt vmcnt(9)
v_mfma_f32_16x16x32_bf16 v[32:35], a[40:43], v[176:179], v[32:35]
s_waitcnt vmcnt(4)
v_cmp_ne_u32 vcc, s99, v7
v_mfma_f32_16x16x32_bf16 v[36:39], a[44:47], v[176:179], v[36:39]
v_add_f32 v156, v156, v172
v_add_f32 v157, v157, v173
v_mfma_f32_16x16x32_bf16 v[40:43], a[48:51], v[176:179], v[40:43]
v_lshlrev_b32 v158, 16, v11
v_and_b32 v159, s14, v11
v_mfma_f32_16x16x32_bf16 v[44:47], a[52:55], v[176:179], v[44:47]
s_cbranch_vccnz chkc_94
chkb_95:
v_mfma_f32_16x16x32_bf16 v[48:51], a[56:59], v[176:179], v[48:51]
buffer_load_dwordx4 v[192:195], v148, s[44:47], s22 offen offset:0 sc1
v_mfma_f32_16x16x32_bf16 v[52:55], a[40:43], v[180:183], v[52:55]
v_lshlrev_b32 v174, 16, v139
v_and_b32 v175, s14, v139
v_mfma_f32_16x16x32_bf16 v[56:59], a[44:47], v[180:183], v[56:59]
v_add_f32 v158, v158, v174
v_add_f32 v159, v159, v175
v_mfma_f32_16x16x32_bf16 v[60:63], a[48:51], v[180:183], v[60:63]
v_lshlrev_b32 v160, 16, v12
v_and_b32 v161, s14, v12
v_mfma_f32_16x16x32_bf16 v[64:67], a[52:55], v[180:183], v[64:67]
buffer_load_dwordx4 v[196:199], v148, s[44:47], s23 offen offset:0 sc1
v_lshlrev_b32 v172, 16, v140
v_mfma_f32_16x16x32_bf16 v[68:71], a[56:59], v[180:183], v[68:71]
v_and_b32 v173, s14, v140
v_mfma_f32_16x16x32_bf16 v[72:75], a[40:43], v[200:203], v[72:75]
v_add_f32 v160, v160, v172
v_add_f32 v161, v161, v173
v_mfma_f32_16x16x32_bf16 v[76:79], a[44:47], v[200:203], v[76:79]
v_lshlrev_b32 v162, 16, v13
v_and_b32 v163, s14, v13
v_mfma_f32_16x16x32_bf16 v[80:83], a[48:51], v[200:203], v[80:83]
buffer_load_dwordx4 v[224:227], v148, s[44:47], s22 offen offset:1024 sc1
v_lshlrev_b32 v174, 16, v141
v_mfma_f32_16x16x32_bf16 v[84:87], a[52:55], v[200:203], v[84:87]
v_and_b32 v175, s14, v141
v_add_f32 v162, v162, v174
v_mfma_f32_16x16x32_bf16 v[88:91], a[56:59], v[200:203], v[88:91]
v_add_f32 v163, v163, v175
v_mfma_f32_16x16x32_bf16 v[92:95], a[40:43], v[204:207], v[92:95]
v_lshlrev_b32 v164, 16, v14
v_and_b32 v165, s14, v14
v_mfma_f32_16x16x32_bf16 v[96:99], a[44:47], v[204:207], v[96:99]
buffer_load_dwordx4 v[228:231], v148, s[44:47], s23 offen offset:1024 sc1
v_lshlrev_b32 v172, 16, v142
v_mfma_f32_16x16x32_bf16 v[100:103], a[48:51], v[204:207], v[100:103]
v_and_b32 v173, s14, v142
v_add_f32 v164, v164, v172
v_mfma_f32_16x16x32_bf16 v[104:107], a[52:55], v[204:207], v[104:107]
v_add_f32 v165, v165, v173
v_lshlrev_b32 v166, 16, v15
v_mfma_f32_16x16x32_bf16 v[108:111], a[56:59], v[204:207], v[108:111]
v_and_b32 v167, s14, v15
v_mfma_f32_16x16x32_bf16 v[32:35], a[60:63], v[208:211], v[32:35]
buffer_load_dword v30, v31, s[44:47], s12 offen offset:512 sc1
v_mfma_f32_16x16x32_bf16 v[36:39], a[64:67], v[208:211], v[36:39]
buffer_load_dwordx4 v[216:219], v148, s[44:47], s22 offen offset:2048 sc1
v_lshlrev_b32 v174, 16, v143
v_mfma_f32_16x16x32_bf16 v[40:43], a[68:71], v[208:211], v[40:43]
v_and_b32 v175, s14, v143
v_add_f32 v166, v166, v174
v_mfma_f32_16x16x32_bf16 v[44:47], a[72:75], v[208:211], v[44:47]
v_add_f32 v167, v167, v175
v_lshlrev_b32 v168, 16, v16
v_mfma_f32_16x16x32_bf16 v[48:51], a[76:79], v[208:211], v[48:51]
v_and_b32 v169, s14, v16
s_waitcnt vmcnt(9)
v_mfma_f32_16x16x32_bf16 v[52:55], a[60:63], v[212:215], v[52:55]
buffer_load_dwordx4 v[220:223], v148, s[44:47], s23 offen offset:2048 sc1
v_lshlrev_b32 v172, 16, v144
v_mfma_f32_16x16x32_bf16 v[56:59], a[64:67], v[212:215], v[56:59]
v_and_b32 v173, s14, v144
v_add_f32 v168, v168, v172
v_mfma_f32_16x16x32_bf16 v[60:63], a[68:71], v[212:215], v[60:63]
v_add_f32 v169, v169, v173
v_lshlrev_b32 v170, 16, v17
v_mfma_f32_16x16x32_bf16 v[64:67], a[72:75], v[212:215], v[64:67]
v_and_b32 v171, s14, v17
v_lshlrev_b32 v174, 16, v145
v_mfma_f32_16x16x32_bf16 v[68:71], a[76:79], v[212:215], v[68:71]
buffer_load_dwordx4 v[176:179], v148, s[44:47], s22 offen offset:3072 sc1
s_waitcnt vmcnt(10)
v_mfma_f32_16x16x32_bf16 v[72:75], a[60:63], v[184:187], v[72:75]
v_and_b32 v175, s14, v145
v_add_f32 v170, v170, v174
v_mfma_f32_16x16x32_bf16 v[76:79], a[64:67], v[184:187], v[76:79]
v_add_f32 v171, v171, v175
v_mfma_f32_16x16x32_bf16 v[80:83], a[68:71], v[184:187], v[80:83]
v_mfma_f32_16x16x32_bf16 v[84:87], a[72:75], v[184:187], v[84:87]
buffer_load_dwordx4 v[180:183], v148, s[44:47], s23 offen offset:3072 sc1
v_mfma_f32_16x16x32_bf16 v[88:91], a[76:79], v[184:187], v[88:91]
s_waitcnt vmcnt(10)
v_mfma_f32_16x16x32_bf16 v[92:95], a[60:63], v[188:191], v[92:95]
v_mfma_f32_16x16x32_bf16 v[96:99], a[64:67], v[188:191], v[96:99]
v_mfma_f32_16x16x32_bf16 v[100:103], a[68:71], v[188:191], v[100:103]
v_mfma_f32_16x16x32_bf16 v[104:107], a[72:75], v[188:191], v[104:107]
v_mfma_f32_16x16x32_bf16 v[108:111], a[76:79], v[188:191], v[108:111]
s_waitcnt vmcnt(8)
v_mfma_f32_16x16x32_bf16 v[72:75], a[80:83], v[192:195], v[72:75]
v_mfma_f32_16x16x32_bf16 v[76:79], a[84:87], v[192:195], v[76:79]
v_mfma_f32_16x16x32_bf16 v[80:83], a[88:91], v[192:195], v[80:83]
v_mfma_f32_16x16x32_bf16 v[84:87], a[92:95], v[192:195], v[84:87]
v_mfma_f32_16x16x32_bf16 v[88:91], a[96:99], v[192:195], v[88:91]
s_waitcnt vmcnt(7)
v_mfma_f32_16x16x32_bf16 v[92:95], a[80:83], v[196:199], v[92:95]
v_mfma_f32_16x16x32_bf16 v[96:99], a[84:87], v[196:199], v[96:99]
v_mfma_f32_16x16x32_bf16 v[100:103], a[88:91], v[196:199], v[100:103]
v_mfma_f32_16x16x32_bf16 v[104:107], a[92:95], v[196:199], v[104:107]
v_mfma_f32_16x16x32_bf16 v[108:111], a[96:99], v[196:199], v[108:111]
s_waitcnt vmcnt(6)
v_mfma_f32_16x16x32_bf16 v[72:75], a[100:103], v[224:227], v[72:75]
s_waitcnt vmcnt(4)
v_cmp_ne_u32 vcc, s99, v30
v_mfma_f32_16x16x32_bf16 v[76:79], a[104:107], v[224:227], v[76:79]
v_mfma_f32_16x16x32_bf16 v[80:83], a[108:111], v[224:227], v[80:83]
v_mfma_f32_16x16x32_bf16 v[84:87], a[112:115], v[224:227], v[84:87]
s_nop 0
s_cbranch_vccnz chkc_96
chkb_97:
v_mfma_f32_16x16x32_bf16 v[88:91], a[116:119], v[224:227], v[88:91]
buffer_load_dwordx4 v[200:203], v148, s[44:47], s97 offen offset:0 sc1
v_mfma_f32_16x16x32_bf16 v[92:95], a[100:103], v[228:231], v[92:95]
v_mfma_f32_16x16x32_bf16 v[96:99], a[104:107], v[228:231], v[96:99]
v_mfma_f32_16x16x32_bf16 v[100:103], a[108:111], v[228:231], v[100:103]
v_mfma_f32_16x16x32_bf16 v[104:107], a[112:115], v[228:231], v[104:107]
buffer_load_dwordx4 v[204:207], v148, s[44:47], s97 offen offset:1024 sc1
v_mfma_f32_16x16x32_bf16 v[108:111], a[116:119], v[228:231], v[108:111]
s_waitcnt vmcnt(5)
v_mfma_f32_16x16x32_bf16 v[72:75], a[120:123], v[216:219], v[72:75]
v_mfma_f32_16x16x32_bf16 v[76:79], a[124:127], v[216:219], v[76:79]
v_mfma_f32_16x16x32_bf16 v[80:83], a[128:131], v[216:219], v[80:83]
buffer_load_dwordx4 v[208:211], v148, s[44:47], s97 offen offset:2048 sc1
v_mfma_f32_16x16x32_bf16 v[84:87], a[132:135], v[216:219], v[84:87]
v_mfma_f32_16x16x32_bf16 v[88:91], a[136:139], v[216:219], v[88:91]
s_waitcnt vmcnt(5)
v_mfma_f32_16x16x32_bf16 v[92:95], a[120:123], v[220:223], v[92:95]
v_mfma_f32_16x16x32_bf16 v[96:99], a[124:127], v[220:223], v[96:99]
buffer_load_dwordx4 v[212:215], v148, s[44:47], s97 offen offset:3072 sc1
v_mfma_f32_16x16x32_bf16 v[100:103], a[128:131], v[220:223], v[100:103]
v_mfma_f32_16x16x32_bf16 v[104:107], a[132:135], v[220:223], v[104:107]
v_mfma_f32_16x16x32_bf16 v[108:111], a[136:139], v[220:223], v[108:111]
s_waitcnt vmcnt(5)
v_mfma_f32_16x16x32_bf16 v[72:75], a[140:143], v[176:179], v[72:75]
buffer_load_dwordx4 v[184:187], v149, s[44:47], s23 offen offset:0 sc1
v_mfma_f32_16x16x32_bf16 v[76:79], a[144:147], v[176:179], v[76:79]
v_mfma_f32_16x16x32_bf16 v[80:83], a[148:151], v[176:179], v[80:83]
v_mfma_f32_16x16x32_bf16 v[84:87], a[152:155], v[176:179], v[84:87]
v_mfma_f32_16x16x32_bf16 v[88:91], a[156:159], v[176:179], v[88:91]
buffer_load_dwordx4 v[188:191], v149, s[44:47], s97 offen offset:0 sc1
s_waitcnt vmcnt(6)
v_mfma_f32_16x16x32_bf16 v[92:95], a[140:143], v[180:183], v[92:95]
v_mfma_f32_16x16x32_bf16 v[96:99], a[144:147], v[180:183], v[96:99]
v_mfma_f32_16x16x32_bf16 v[100:103], a[148:151], v[180:183], v[100:103]
v_mfma_f32_16x16x32_bf16 v[104:107], a[152:155], v[180:183], v[104:107]
buffer_load_dwordx4 v[192:195], v148, s[44:47], s96 offen offset:0 sc1
v_mfma_f32_16x16x32_bf16 v[108:111], a[156:159], v[180:183], v[108:111]
s_waitcnt vmcnt(6)
v_mfma_f32_16x16x32_bf16 v[92:95], a[160:163], v[200:203], v[92:95]
v_mfma_f32_16x16x32_bf16 v[96:99], a[164:167], v[200:203], v[96:99]
v_mfma_f32_16x16x32_bf16 v[100:103], a[168:171], v[200:203], v[100:103]
buffer_load_dwordx4 v[196:199], v148, s[44:47], s96 offen offset:1024 sc1
v_mfma_f32_16x16x32_bf16 v[104:107], a[172:175], v[200:203], v[104:107]
v_mfma_f32_16x16x32_bf16 v[108:111], a[176:179], v[200:203], v[108:111]
s_waitcnt vmcnt(6)
v_mfma_f32_16x16x32_bf16 v[92:95], a[180:183], v[204:207], v[92:95]
v_mfma_f32_16x16x32_bf16 v[96:99], a[184:187], v[204:207], v[96:99]
buffer_load_dwordx4 v[224:227], v148, s[44:47], s96 offen offset:2048 sc1
v_mfma_f32_16x16x32_bf16 v[100:103], a[188:191], v[204:207], v[100:103]
v_mfma_f32_16x16x32_bf16 v[104:107], a[192:195], v[204:207], v[104:107]
v_mfma_f32_16x16x32_bf16 v[108:111], a[196:199], v[204:207], v[108:111]
s_waitcnt vmcnt(6)
v_mfma_f32_16x16x32_bf16 v[92:95], a[200:203], v[208:211], v[92:95]
buffer_load_dwordx4 v[228:231], v148, s[44:47], s96 offen offset:3072 sc1
v_mfma_f32_16x16x32_bf16 v[96:99], a[204:207], v[208:211], v[96:99]
v_mfma_f32_16x16x32_bf16 v[100:103], a[208:211], v[208:211], v[100:103]
v_mfma_f32_16x16x32_bf16 v[104:107], a[212:215], v[208:211], v[104:107]
v_mfma_f32_16x16x32_bf16 v[108:111], a[216:219], v[208:211], v[108:111]
buffer_load_dwordx4 v[216:219], v149, s[44:47], s22 offen offset:0 sc1
s_waitcnt vmcnt(7)
v_mfma_f32_16x16x32_bf16 v[92:95], a[220:223], v[212:215], v[92:95]
v_mfma_f32_16x16x32_bf16 v[96:99], a[224:227], v[212:215], v[96:99]
v_mfma_f32_16x16x32_bf16 v[100:103], a[228:231], v[212:215], v[100:103]
v_mfma_f32_16x16x32_bf16 v[104:107], a[232:235], v[212:215], v[104:107]
buffer_load_dwordx4 v[220:223], v149, s[44:47], s96 offen offset:0 sc1
v_mfma_f32_16x16x32_bf16 v[108:111], a[236:239], v[212:215], v[108:111]
s_waitcnt vmcnt(7)
v_mfma_f32_16x16x32_bf16 v[92:95], a[240:243], v[184:187], v[92:95]
v_mfma_f32_16x16x32_bf16 v[96:99], a[244:247], v[184:187], v[96:99]
v_mfma_f32_16x16x32_bf16 v[100:103], a[248:251], v[184:187], v[100:103]
buffer_load_dwordx4 v[176:179], v148, s[44:47], s21 offen offset:0 sc1
v_mfma_f32_16x16x32_bf16 v[104:107], a[252:255], v[184:187], v[104:107]
v_mfma_f32_16x16x32_bf16 v[108:111], v[232:235], v[184:187], v[108:111]
s_waitcnt vmcnt(7)
v_mfma_f32_16x16x32_bf16 v[92:95], v[236:239], v[188:191], v[92:95]
v_mfma_f32_16x16x32_bf16 v[96:99], v[240:243], v[188:191], v[96:99]
buffer_load_dwordx4 v[180:183], v148, s[44:47], s21 offen offset:1024 sc1
v_mfma_f32_16x16x32_bf16 v[100:103], v[244:247], v[188:191], v[100:103]
v_mfma_f32_16x16x32_bf16 v[104:107], v[248:251], v[188:191], v[104:107]
v_mfma_f32_16x16x32_bf16 v[108:111], v[252:255], v[188:191], v[108:111]
s_waitcnt vmcnt(7)
v_mfma_f32_16x16x32_bf16 v[72:75], a[160:163], v[192:195], v[72:75]
buffer_load_dwordx4 v[200:203], v148, s[44:47], s21 offen offset:2048 sc1
v_mfma_f32_16x16x32_bf16 v[76:79], a[164:167], v[192:195], v[76:79]
ds_write_b128 v4, v[92:95] offset:40960
v_mfma_f32_16x16x32_bf16 v[80:83], a[168:171], v[192:195], v[80:83]
v_mfma_f32_16x16x32_bf16 v[84:87], a[172:175], v[192:195], v[84:87]
ds_write_b128 v4, v[96:99] offset:41984
v_mfma_f32_16x16x32_bf16 v[88:91], a[176:179], v[192:195], v[88:91]
buffer_load_dwordx4 v[204:207], v148, s[44:47], s21 offen offset:3072 sc1
s_waitcnt vmcnt(8)
v_mfma_f32_16x16x32_bf16 v[72:75], a[180:183], v[196:199], v[72:75]
v_mfma_f32_16x16x32_bf16 v[76:79], a[184:187], v[196:199], v[76:79]
ds_write_b128 v4, v[100:103] offset:43008
v_mfma_f32_16x16x32_bf16 v[80:83], a[188:191], v[196:199], v[80:83]
v_mfma_f32_16x16x32_bf16 v[84:87], a[192:195], v[196:199], v[84:87]
buffer_load_dwordx4 v[208:211], v148, s[44:47], s43 offen offset:0 sc1
v_mfma_f32_16x16x32_bf16 v[88:91], a[196:199], v[196:199], v[88:91]
s_waitcnt vmcnt(8)
v_mfma_f32_16x16x32_bf16 v[72:75], a[200:203], v[224:227], v[72:75]
ds_write_b128 v4, v[104:107] offset:44032
v_mfma_f32_16x16x32_bf16 v[76:79], a[204:207], v[224:227], v[76:79]
v_mfma_f32_16x16x32_bf16 v[80:83], a[208:211], v[224:227], v[80:83]
buffer_load_dwordx4 v[212:215], v148, s[44:47], s43 offen offset:1024 sc1
v_mfma_f32_16x16x32_bf16 v[84:87], a[212:215], v[224:227], v[84:87]
ds_write_b128 v4, v[108:111] offset:45056
v_mfma_f32_16x16x32_bf16 v[88:91], a[216:219], v[224:227], v[88:91]
s_waitcnt vmcnt(8)
v_mfma_f32_16x16x32_bf16 v[72:75], a[220:223], v[228:231], v[72:75]
v_mfma_f32_16x16x32_bf16 v[76:79], a[224:227], v[228:231], v[76:79]
buffer_load_dwordx4 v[184:187], v148, s[44:47], s43 offen offset:2048 sc1
v_mfma_f32_16x16x32_bf16 v[80:83], a[228:231], v[228:231], v[80:83]
v_mfma_f32_16x16x32_bf16 v[84:87], a[232:235], v[228:231], v[84:87]
s_waitcnt lgkmcnt(0)
s_barrier
v_mfma_f32_16x16x32_bf16 v[88:91], a[236:239], v[228:231], v[88:91]
ds_read_b128 v[112:115], v5 offset:40960
s_waitcnt vmcnt(8)
v_mfma_f32_16x16x32_bf16 v[72:75], a[240:243], v[216:219], v[72:75]
buffer_load_dwordx4 v[188:191], v148, s[44:47], s43 offen offset:3072 sc1
ds_read_b128 v[116:119], v5 offset:41984
v_mfma_f32_16x16x32_bf16 v[76:79], a[244:247], v[216:219], v[76:79]
ds_read_b128 v[120:123], v5 offset:43008
ds_read_b128 v[124:127], v5 offset:44032
v_mfma_f32_16x16x32_bf16 v[80:83], a[248:251], v[216:219], v[80:83]
ds_read_b128 v[128:131], v5 offset:45056
v_mfma_f32_16x16x32_bf16 v[84:87], a[252:255], v[216:219], v[84:87]
v_mfma_f32_16x16x32_bf16 v[88:91], v[232:235], v[216:219], v[88:91]
buffer_load_dwordx4 v[192:195], v149, s[44:47], s21 offen offset:0 sc1
s_waitcnt vmcnt(9)
v_mfma_f32_16x16x32_bf16 v[72:75], v[236:239], v[220:223], v[72:75]
v_mfma_f32_16x16x32_bf16 v[76:79], v[240:243], v[220:223], v[76:79]
v_mfma_f32_16x16x32_bf16 v[80:83], v[244:247], v[220:223], v[80:83]
v_mfma_f32_16x16x32_bf16 v[84:87], v[248:251], v[220:223], v[84:87]
buffer_load_dwordx4 v[196:199], v149, s[44:47], s43 offen offset:0 sc1
v_mfma_f32_16x16x32_bf16 v[88:91], v[252:255], v[220:223], v[88:91]
s_waitcnt vmcnt(9)
v_mfma_f32_16x16x32_bf16 v[52:55], a[80:83], v[176:179], v[52:55]
v_mfma_f32_16x16x32_bf16 v[56:59], a[84:87], v[176:179], v[56:59]
s_waitcnt lgkmcnt(0)
v_add_f32 v72, v72, v112
v_mfma_f32_16x16x32_bf16 v[60:63], a[88:91], v[176:179], v[60:63]
buffer_load_dwordx4 v[224:227], v148, s[44:47], s20 offen offset:0 sc1
v_add_f32 v73, v73, v113
v_mfma_f32_16x16x32_bf16 v[64:67], a[92:95], v[176:179], v[64:67]
v_add_f32 v74, v74, v114
v_add_f32 v75, v75, v115
v_mfma_f32_16x16x32_bf16 v[68:71], a[96:99], v[176:179], v[68:71]
v_add_f32 v76, v76, v116
s_waitcnt vmcnt(9)
v_mfma_f32_16x16x32_bf16 v[52:55], a[100:103], v[180:183], v[52:55]
v_add_f32 v77, v77, v117
v_add_f32 v78, v78, v118
v_mfma_f32_16x16x32_bf16 v[56:59], a[104:107], v[180:183], v[56:59]
buffer_load_dwordx4 v[228:231], v148, s[44:47], s20 offen offset:1024 sc1
v_add_f32 v79, v79, v119
v_mfma_f32_16x16x32_bf16 v[60:63], a[108:111], v[180:183], v[60:63]
v_add_f32 v80, v80, v120
v_add_f32 v81, v81, v121
v_mfma_f32_16x16x32_bf16 v[64:67], a[112:115], v[180:183], v[64:67]
v_add_f32 v82, v82, v122
v_add_f32 v83, v83, v123
v_mfma_f32_16x16x32_bf16 v[68:71], a[116:119], v[180:183], v[68:71]
v_add_f32 v84, v84, v124
s_waitcnt vmcnt(9)
v_mfma_f32_16x16x32_bf16 v[52:55], a[120:123], v[200:203], v[52:55]
buffer_load_dwordx4 v[216:219], v148, s[44:47], s20 offen offset:2048 sc1
v_add_f32 v85, v85, v125
v_mfma_f32_16x16x32_bf16 v[56:59], a[124:127], v[200:203], v[56:59]
v_add_f32 v86, v86, v126
v_add_f32 v87, v87, v127
v_mfma_f32_16x16x32_bf16 v[60:63], a[128:131], v[200:203], v[60:63]
v_add_f32 v88, v88, v128
v_add_f32 v89, v89, v129
v_mfma_f32_16x16x32_bf16 v[64:67], a[132:135], v[200:203], v[64:67]
v_add_f32 v90, v90, v130
v_add_f32 v91, v91, v131
v_mfma_f32_16x16x32_bf16 v[68:71], a[136:139], v[200:203], v[68:71]
buffer_load_dwordx4 v[220:223], v148, s[44:47], s20 offen offset:3072 sc1
s_waitcnt vmcnt(10)
v_mfma_f32_16x16x32_bf16 v[52:55], a[140:143], v[204:207], v[52:55]
ds_write_b128 v4, v[72:75] offset:20480
v_mfma_f32_16x16x32_bf16 v[56:59], a[144:147], v[204:207], v[56:59]
v_mfma_f32_16x16x32_bf16 v[60:63], a[148:151], v[204:207], v[60:63]
ds_write_b128 v4, v[76:79] offset:21504
v_mfma_f32_16x16x32_bf16 v[64:67], a[152:155], v[204:207], v[64:67]
buffer_load_dwordx4 v[176:179], v148, s[44:47], s42 offen offset:0 sc1
v_mfma_f32_16x16x32_bf16 v[68:71], a[156:159], v[204:207], v[68:71]
s_waitcnt vmcnt(10)
v_mfma_f32_16x16x32_bf16 v[52:55], a[160:163], v[208:211], v[52:55]
v_mfma_f32_16x16x32_bf16 v[56:59], a[164:167], v[208:211], v[56:59]
ds_write_b128 v4, v[80:83] offset:22528
v_mfma_f32_16x16x32_bf16 v[60:63], a[168:171], v[208:211], v[60:63]
buffer_load_dwordx4 v[180:183], v148, s[44:47], s42 offen offset:1024 sc1
v_mfma_f32_16x16x32_bf16 v[64:67], a[172:175], v[208:211], v[64:67]
v_mfma_f32_16x16x32_bf16 v[68:71], a[176:179], v[208:211], v[68:71]
s_waitcnt vmcnt(10)
v_mfma_f32_16x16x32_bf16 v[52:55], a[180:183], v[212:215], v[52:55]
ds_write_b128 v4, v[84:87] offset:23552
v_mfma_f32_16x16x32_bf16 v[56:59], a[184:187], v[212:215], v[56:59]
buffer_load_dwordx4 v[200:203], v148, s[44:47], s42 offen offset:2048 sc1
v_mfma_f32_16x16x32_bf16 v[60:63], a[188:191], v[212:215], v[60:63]
v_mfma_f32_16x16x32_bf16 v[64:67], a[192:195], v[212:215], v[64:67]
ds_write_b128 v4, v[88:91] offset:24576
v_mfma_f32_16x16x32_bf16 v[68:71], a[196:199], v[212:215], v[68:71]
s_waitcnt vmcnt(10)
v_mfma_f32_16x16x32_bf16 v[52:55], a[200:203], v[184:187], v[52:55]
buffer_load_dwordx4 v[204:207], v148, s[44:47], s42 offen offset:3072 sc1
v_mfma_f32_16x16x32_bf16 v[56:59], a[204:207], v[184:187], v[56:59]
v_mfma_f32_16x16x32_bf16 v[60:63], a[208:211], v[184:187], v[60:63]
v_mfma_f32_16x16x32_bf16 v[64:67], a[212:215], v[184:187], v[64:67]
v_mfma_f32_16x16x32_bf16 v[68:71], a[216:219], v[184:187], v[68:71]
buffer_load_dwordx4 v[208:211], v149, s[44:47], s20 offen offset:0 sc1
s_waitcnt vmcnt(11)
v_mfma_f32_16x16x32_bf16 v[52:55], a[220:223], v[188:191], v[52:55]
v_mfma_f32_16x16x32_bf16 v[56:59], a[224:227], v[188:191], v[56:59]
v_mfma_f32_16x16x32_bf16 v[60:63], a[228:231], v[188:191], v[60:63]
v_mfma_f32_16x16x32_bf16 v[64:67], a[232:235], v[188:191], v[64:67]
buffer_load_dwordx4 v[212:215], v149, s[44:47], s42 offen offset:0 sc1
s_waitcnt lgkmcnt(0)
v_mfma_f32_16x16x32_bf16 v[68:71], a[236:239], v[188:191], v[68:71]
s_barrier
s_waitcnt vmcnt(11)
v_mfma_f32_16x16x32_bf16 v[52:55], a[240:243], v[192:195], v[52:55]
ds_read_b128 v[112:115], v5 offset:20480
ds_read_b128 v[116:119], v5 offset:21504
v_mfma_f32_16x16x32_bf16 v[56:59], a[244:247], v[192:195], v[56:59]
ds_read_b128 v[120:123], v5 offset:22528
ds_read_b128 v[124:127], v5 offset:23552
v_mfma_f32_16x16x32_bf16 v[60:63], a[248:251], v[192:195], v[60:63]
ds_read_b128 v[128:131], v5 offset:24576
v_mfma_f32_16x16x32_bf16 v[64:67], a[252:255], v[192:195], v[64:67]
v_mfma_f32_16x16x32_bf16 v[68:71], v[232:235], v[192:195], v[68:71]
s_waitcnt vmcnt(10)
v_mfma_f32_16x16x32_bf16 v[52:55], v[236:239], v[196:199], v[52:55]
v_mfma_f32_16x16x32_bf16 v[56:59], v[240:243], v[196:199], v[56:59]
v_mfma_f32_16x16x32_bf16 v[60:63], v[244:247], v[196:199], v[60:63]
v_mfma_f32_16x16x32_bf16 v[64:67], v[248:251], v[196:199], v[64:67]
v_mfma_f32_16x16x32_bf16 v[68:71], v[252:255], v[196:199], v[68:71]
s_waitcnt vmcnt(9)
v_mfma_f32_16x16x32_bf16 v[32:35], a[80:83], v[224:227], v[32:35]
s_lshl_b32 s8, s4, 2
s_add_u32 s8, s8, s5
s_cmp_eq_u32 s8, 0
s_cbranch_scc1 wbc_98
s_mov_b64 exec, 1
buffer_load_dword v30, off, s[44:47], 0
s_mov_b64 exec, -1
s_branch wbb_99
wbc_98:
buffer_wbl2 sc1
wbb_99:
v_mfma_f32_16x16x32_bf16 v[36:39], a[84:87], v[224:227], v[36:39]
s_waitcnt lgkmcnt(0)
v_add_f32 v52, v52, v112
v_mfma_f32_16x16x32_bf16 v[40:43], a[88:91], v[224:227], v[40:43]
v_add_f32 v53, v53, v113
v_add_f32 v54, v54, v114
v_mfma_f32_16x16x32_bf16 v[44:47], a[92:95], v[224:227], v[44:47]
v_add_f32 v55, v55, v115
v_add_f32 v56, v56, v116
v_mfma_f32_16x16x32_bf16 v[48:51], a[96:99], v[224:227], v[48:51]
v_add_f32 v57, v57, v117
s_waitcnt vmcnt(9)
v_mfma_f32_16x16x32_bf16 v[32:35], a[100:103], v[228:231], v[32:35]
v_add_f32 v58, v58, v118
v_add_f32 v59, v59, v119
v_mfma_f32_16x16x32_bf16 v[36:39], a[104:107], v[228:231], v[36:39]
v_add_f32 v60, v60, v120
v_add_f32 v61, v61, v121
v_mfma_f32_16x16x32_bf16 v[40:43], a[108:111], v[228:231], v[40:43]
v_add_f32 v62, v62, v122
v_add_f32 v63, v63, v123
v_mfma_f32_16x16x32_bf16 v[44:47], a[112:115], v[228:231], v[44:47]
v_add_f32 v64, v64, v124
v_add_f32 v65, v65, v125
v_mfma_f32_16x16x32_bf16 v[48:51], a[116:119], v[228:231], v[48:51]
v_add_f32 v66, v66, v126
s_waitcnt vmcnt(8)
v_mfma_f32_16x16x32_bf16 v[32:35], a[120:123], v[216:219], v[32:35]
v_add_f32 v67, v67, v127
v_add_f32 v68, v68, v128
v_mfma_f32_16x16x32_bf16 v[36:39], a[124:127], v[216:219], v[36:39]
v_add_f32 v69, v69, v129
v_add_f32 v70, v70, v130
v_mfma_f32_16x16x32_bf16 v[40:43], a[128:131], v[216:219], v[40:43]
v_add_f32 v71, v71, v131
v_mfma_f32_16x16x32_bf16 v[44:47], a[132:135], v[216:219], v[44:47]
ds_write_b128 v4, v[52:55] offset:0
v_mfma_f32_16x16x32_bf16 v[48:51], a[136:139], v[216:219], v[48:51]
s_waitcnt vmcnt(7)
v_mfma_f32_16x16x32_bf16 v[32:35], a[140:143], v[220:223], v[32:35]
v_mfma_f32_16x16x32_bf16 v[36:39], a[144:147], v[220:223], v[36:39]
ds_write_b128 v4, v[56:59] offset:1024
v_mfma_f32_16x16x32_bf16 v[40:43], a[148:151], v[220:223], v[40:43]
v_mfma_f32_16x16x32_bf16 v[44:47], a[152:155], v[220:223], v[44:47]
ds_write_b128 v4, v[60:63] offset:2048
v_mfma_f32_16x16x32_bf16 v[48:51], a[156:159], v[220:223], v[48:51]
s_waitcnt vmcnt(6)
v_mfma_f32_16x16x32_bf16 v[32:35], a[160:163], v[176:179], v[32:35]
v_mfma_f32_16x16x32_bf16 v[36:39], a[164:167], v[176:179], v[36:39]
ds_write_b128 v4, v[64:67] offset:3072
v_mfma_f32_16x16x32_bf16 v[40:43], a[168:171], v[176:179], v[40:43]
v_mfma_f32_16x16x32_bf16 v[44:47], a[172:175], v[176:179], v[44:47]
ds_write_b128 v4, v[68:71] offset:4096
v_mfma_f32_16x16x32_bf16 v[48:51], a[176:179], v[176:179], v[48:51]
s_waitcnt vmcnt(5)
v_mfma_f32_16x16x32_bf16 v[32:35], a[180:183], v[180:183], v[32:35]
v_mfma_f32_16x16x32_bf16 v[36:39], a[184:187], v[180:183], v[36:39]
v_mfma_f32_16x16x32_bf16 v[40:43], a[188:191], v[180:183], v[40:43]
v_mfma_f32_16x16x32_bf16 v[44:47], a[192:195], v[180:183], v[44:47]
v_mfma_f32_16x16x32_bf16 v[48:51], a[196:199], v[180:183], v[48:51]
s_waitcnt vmcnt(4)
v_mfma_f32_16x16x32_bf16 v[32:35], a[200:203], v[200:203], v[32:35]
v_mfma_f32_16x16x32_bf16 v[36:39], a[204:207], v[200:203], v[36:39]
v_mfma_f32_16x16x32_bf16 v[40:43], a[208:211], v[200:203], v[40:43]
v_mfma_f32_16x16x32_bf16 v[44:47], a[212:215], v[200:203], v[44:47]
v_mfma_f32_16x16x32_bf16 v[48:51], a[216:219], v[200:203], v[48:51]
s_waitcnt vmcnt(3)
v_mfma_f32_16x16x32_bf16 v[32:35], a[220:223], v[204:207], v[32:35]
v_mfma_f32_16x16x32_bf16 v[36:39], a[224:227], v[204:207], v[36:39]
v_mfma_f32_16x16x32_bf16 v[40:43], a[228:231], v[204:207], v[40:43]
v_mfma_f32_16x16x32_bf16 v[44:47], a[232:235], v[204:207], v[44:47]
s_waitcnt lgkmcnt(0)
s_barrier
v_mfma_f32_16x16x32_bf16 v[48:51], a[236:239], v[204:207], v[48:51]
ds_read_b128 v[112:115], v5 offset:0
s_waitcnt vmcnt(2)
v_mfma_f32_16x16x32_bf16 v[32:35], a[240:243], v[208:211], v[32:35]
ds_read_b128 v[116:119], v5 offset:1024
ds_read_b128 v[120:123], v5 offset:2048
v_mfma_f32_16x16x32_bf16 v[36:39], a[244:247], v[208:211], v[36:39]
ds_read_b128 v[124:127], v5 offset:3072
ds_read_b128 v[128:131], v5 offset:4096
v_mfma_f32_16x16x32_bf16 v[40:43], a[248:251], v[208:211], v[40:43]
v_mfma_f32_16x16x32_bf16 v[44:47], a[252:255], v[208:211], v[44:47]
v_mfma_f32_16x16x32_bf16 v[48:51], v[232:235], v[208:211], v[48:51]
s_waitcnt vmcnt(1)
v_mfma_f32_16x16x32_bf16 v[32:35], v[236:239], v[212:215], v[32:35]
v_mfma_f32_16x16x32_bf16 v[36:39], v[240:243], v[212:215], v[36:39]
v_mfma_f32_16x16x32_bf16 v[40:43], v[244:247], v[212:215], v[40:43]
v_mfma_f32_16x16x32_bf16 v[44:47], v[248:251], v[212:215], v[44:47]
v_mfma_f32_16x16x32_bf16 v[48:51], v[252:255], v[212:215], v[48:51]
s_waitcnt lgkmcnt(0)
v_pk_add_f32 v[152:153], v[152:153], v[112:113]
v_pk_add_f32 v[154:155], v[154:155], v[114:115]
v_pk_add_f32 v[156:157], v[156:157], v[116:117]
v_pk_add_f32 v[158:159], v[158:159], v[118:119]
v_pk_add_f32 v[160:161], v[160:161], v[120:121]
v_pk_add_f32 v[162:163], v[162:163], v[122:123]
v_pk_add_f32 v[164:165], v[164:165], v[124:125]
v_pk_add_f32 v[166:167], v[166:167], v[126:127]
v_pk_add_f32 v[168:169], v[168:169], v[128:129]
v_pk_add_f32 v[170:171], v[170:171], v[130:131]
v_pk_add_f32 v[152:153], v[152:153], v[32:33]
v_pk_add_f32 v[154:155], v[154:155], v[34:35]
v_pk_add_f32 v[156:157], v[156:157], v[36:37]
v_pk_add_f32 v[158:159], v[158:159], v[38:39]
v_pk_add_f32 v[160:161], v[160:161], v[40:41]
v_pk_add_f32 v[162:163], v[162:163], v[42:43]
v_pk_add_f32 v[164:165], v[164:165], v[44:45]
v_pk_add_f32 v[166:167], v[166:167], v[46:47]
v_pk_add_f32 v[168:169], v[168:169], v[48:49]
v_pk_add_f32 v[170:171], v[170:171], v[50:51]
v_cvt_pk_bf16_f32 v32, v152, v153
v_cvt_pk_bf16_f32 v33, v154, v155
v_cvt_pk_bf16_f32 v34, v156, v157
v_cvt_pk_bf16_f32 v35, v158, v159
v_cvt_pk_bf16_f32 v36, v160, v161
v_cvt_pk_bf16_f32 v37, v162, v163
v_cvt_pk_bf16_f32 v38, v164, v165
v_cvt_pk_bf16_f32 v39, v166, v167
v_cvt_pk_bf16_f32 v40, v168, v169
v_cvt_pk_bf16_f32 v41, v170, v171
s_mov_b32 s60, s38
s_mov_b32 s61, s39
s_mov_b32 s62, 0x280000
s_mov_b32 s63, 0x20000
v_and_b32 v4, 15, v1
v_mul_u32_u24 v4, 2560, v4
v_and_b32 v5, 48, v1
v_add_u32 v6, v4, v5
v_lshrrev_b32 v5, 1, v5
v_add_u32 v7, v4, v5
s_lshl_b32 s8, s64, 1
s_add_u32 s8, s8, s66
s_lshl_b32 s8, s8, 1
s_lshr_b32 s9, s5, 1
s_add_u32 s8, s8, s9
s_lshl_b32 s8, s8, 5
s_and_b32 s9, s5, 1
s_add_u32 s8, s8, s9
s_mul_i32 s8, s8, 1280
s_mul_i32 s9, s67, 160
s_add_u32 s8, s8, s9
buffer_store_dwordx4 v[32:35], v6, s[60:63], s8 offen nt
buffer_store_dwordx4 v[36:39], v6, s[60:63], s8 offen offset:64 nt
buffer_store_dwordx2 v[40:41], v7, s[60:63], s8 offen offset:128 nt
s_or_b32 s8, s2, s5
s_cmp_lg_u32 s8, 0
s_cbranch_scc1 L_fe
s_mov_b64 exec, 1
buffer_store_dword v2, off, s[44:47], 0 sc1
L_fe:
s_endpgm
qfc_19:
buffer_store_dword v2, off, s[44:47], s8 sc1
s_branch qfb_20
qfc_35:
buffer_store_dword v2, off, s[44:47], s8 sc1
s_branch qfb_36
qfc_49:
buffer_store_dword v2, off, s[44:47], s8 sc1
s_branch qfb_50
c1c_53:
poll_100:
s_sleep 4
buffer_load_dwordx4 v[60:63], v12, s[44:47], s30 offen sc1
buffer_load_dword v23, v22, s[44:47], s12 offen sc1
s_waitcnt vmcnt(0)
v_cmp_eq_u32 vcc, s6, v60
v_cmp_eq_u32 s[10:11], s6, v61
s_nop 3
s_and_b64 vcc, vcc, s[10:11]
v_cmp_eq_u32 s[10:11], s6, v62
s_nop 3
s_and_b64 vcc, vcc, s[10:11]
v_cmp_eq_u32 s[10:11], s6, v63
s_nop 3
s_and_b64 vcc, vcc, s[10:11]
v_cmp_eq_u32 s[10:11], s6, v23
s_nop 3
s_and_b64 vcc, vcc, s[10:11]
s_cmp_eq_u64 vcc, -1
s_cbranch_scc1 pollok_101
s_sub_u32 s98, s98, 1
s_cbranch_scc0 poll_100
s_mov_b32 s98, 0
pollok_101:
s_cmp_eq_u32 s7, 0
s_cbranch_scc1 noinv_102
buffer_inv sc1
s_waitcnt vmcnt(0)
noinv_102:
s_branch c1b_54
postc_57:
buffer_wbl2 sc1
s_waitcnt vmcnt(0)
buffer_store_dword v2, off, s[44:47], s13 offset:0 sc1
s_branch postb_58
flc_59:
poll_103:
buffer_load_dwordx4 v[216:219], v18, s[44:47], s101 offen sc1
buffer_load_dwordx4 v[220:223], v19, s[44:47], s31 offen sc1
s_waitcnt vmcnt(0)
v_cmp_eq_u32 vcc, s6, v216
v_cmp_eq_u32 s[10:11], s6, v217
s_nop 3
s_and_b64 vcc, vcc, s[10:11]
v_cmp_eq_u32 s[10:11], s6, v218
s_nop 3
s_and_b64 vcc, vcc, s[10:11]
v_cmp_eq_u32 s[10:11], s6, v219
s_nop 3
s_and_b64 vcc, vcc, s[10:11]
v_cmp_eq_u32 s[10:11], s6, v220
s_nop 3
s_and_b64 vcc, vcc, s[10:11]
v_cmp_eq_u32 s[10:11], s6, v221
s_nop 3
s_and_b64 vcc, vcc, s[10:11]
v_cmp_eq_u32 s[10:11], s6, v222
s_nop 3
s_and_b64 vcc, vcc, s[10:11]
v_cmp_eq_u32 s[10:11], s6, v223
s_nop 3
s_and_b64 vcc, vcc, s[10:11]
s_cmp_eq_u64 vcc, -1
s_cbranch_scc1 pollok_104
s_sub_u32 s98, s98, 1
s_cbranch_scc0 poll_103
s_mov_b32 s98, 0
pollok_104:
s_branch flb_60
chkc_62:
poll_105:
buffer_load_dword v30, v31, s[44:47], s12 offen offset:0 sc1
s_waitcnt vmcnt(0)
v_cmp_eq_u32 vcc, s6, v30
s_nop 3
s_cmp_eq_u64 vcc, -1
s_cbranch_scc1 pollok_106
s_sub_u32 s98, s98, 1
s_cbranch_scc0 poll_105
s_mov_b32 s98, 0
pollok_106:
s_cmp_eq_u32 s7, 0
s_cbranch_scc1 noinv_107
buffer_inv sc1
s_waitcnt vmcnt(0)
noinv_107:
s_branch chkb_63
postc_64:
buffer_wbl2 sc1
s_waitcnt vmcnt(0)
buffer_store_dword v2, off, s[44:47], s13 offset:256 sc1
s_branch postb_65
postc_66:
buffer_wbl2 sc1
s_waitcnt vmcnt(0)
buffer_store_dword v2, off, s[44:47], s13 offset:512 sc1
s_branch postb_67
chkc_68:
poll_108:
buffer_load_dword v7, v31, s[44:47], s12 offen offset:256 sc1
s_waitcnt vmcnt(0)
v_cmp_eq_u32 vcc, s6, v7
s_nop 3
s_cmp_eq_u64 vcc, -1
s_cbranch_scc1 pollok_109
s_sub_u32 s98, s98, 1
s_cbranch_scc0 poll_108
s_mov_b32 s98, 0
pollok_109:
s_cmp_eq_u32 s7, 0
s_cbranch_scc1 noinv_110
buffer_inv sc1
s_waitcnt vmcnt(0)
noinv_110:
s_branch chkb_69
chkc_70:
poll_111:
buffer_load_dword v30, v31, s[44:47], s12 offen offset:512 sc1
s_waitcnt vmcnt(0)
v_cmp_eq_u32 vcc, s6, v30
s_nop 3
s_cmp_eq_u64 vcc, -1
s_cbranch_scc1 pollok_112
s_sub_u32 s98, s98, 1
s_cbranch_scc0 poll_111
s_mov_b32 s98, 0
pollok_112:
s_cmp_eq_u32 s7, 0
s_cbranch_scc1 noinv_113
buffer_inv sc1
s_waitcnt vmcnt(0)
noinv_113:
s_branch chkb_71
gstc_81:
buffer_store_dwordx4 v[92:95], v21, s[44:47], s35 offen sc1
s_branch gstb_82
gsc_83:
poll_114:
buffer_load_dwordx4 v[216:219], v30, s[44:47], s34 offen offset:0 sc1
buffer_load_dwordx4 v[220:223], v30, s[44:47], s34 offen offset:256 sc1
buffer_load_dwordx4 v[224:227], v30, s[44:47], s34 offen offset:512 sc1
buffer_load_dwordx4 v[228:231], v30, s[44:47], s34 offen offset:768 sc1
s_waitcnt vmcnt(0)
v_cmp_eq_u32 vcc, s6, v218
v_cmp_eq_u32 s[10:11], s6, v222
s_nop 3
s_and_b64 vcc, vcc, s[10:11]
v_cmp_eq_u32 s[10:11], s6, v226
s_nop 3
s_and_b64 vcc, vcc, s[10:11]
v_cmp_eq_u32 s[10:11], s6, v230
s_nop 3
s_and_b64 vcc, vcc, s[10:11]
s_cmp_eq_u64 vcc, -1
s_cbranch_scc1 pollok_115
s_sub_u32 s98, s98, 1
s_cbranch_scc0 poll_114
s_mov_b32 s98, 0
pollok_115:
s_branch gsb_84
postc_85:
buffer_wbl2 sc1
s_waitcnt vmcnt(0)
buffer_store_dword v2, off, s[44:47], s13 offset:0 sc1
s_branch postb_86
chkc_88:
poll_116:
buffer_load_dword v30, v31, s[44:47], s12 offen offset:0 sc1
s_waitcnt vmcnt(0)
v_cmp_eq_u32 vcc, s6, v30
s_nop 3
s_cmp_eq_u64 vcc, -1
s_cbranch_scc1 pollok_117
s_sub_u32 s98, s98, 1
s_cbranch_scc0 poll_116
s_mov_b32 s98, 0
pollok_117:
s_cmp_eq_u32 s7, 0
s_cbranch_scc1 noinv_118
buffer_inv sc1
s_waitcnt vmcnt(0)
noinv_118:
s_branch chkb_89
postc_90:
buffer_wbl2 sc1
s_waitcnt vmcnt(0)
buffer_store_dword v2, off, s[44:47], s13 offset:256 sc1
s_branch postb_91
postc_92:
buffer_wbl2 sc1
s_waitcnt vmcnt(0)
buffer_store_dword v2, off, s[44:47], s13 offset:512 sc1
s_branch postb_93
chkc_94:
poll_119:
buffer_load_dword v7, v31, s[44:47], s12 offen offset:256 sc1
s_waitcnt vmcnt(0)
v_cmp_eq_u32 vcc, s6, v7
s_nop 3
s_cmp_eq_u64 vcc, -1
s_cbranch_scc1 pollok_120
s_sub_u32 s98, s98, 1
s_cbranch_scc0 poll_119
s_mov_b32 s98, 0
pollok_120:
s_cmp_eq_u32 s7, 0
s_cbranch_scc1 noinv_121
buffer_inv sc1
s_waitcnt vmcnt(0)
noinv_121:
s_branch chkb_95
chkc_96:
poll_122:
buffer_load_dword v30, v31, s[44:47], s12 offen offset:512 sc1
s_waitcnt vmcnt(0)
v_cmp_eq_u32 vcc, s6, v30
s_nop 3
s_cmp_eq_u64 vcc, -1
s_cbranch_scc1 pollok_123
s_sub_u32 s98, s98, 1
s_cbranch_scc0 poll_122
s_mov_b32 s98, 0
pollok_123:
s_cmp_eq_u32 s7, 0
s_cbranch_scc1 noinv_124
buffer_inv sc1
s_waitcnt vmcnt(0)
noinv_124:
s_branch chkb_97
L_FIN:
s_or_b32 s8, s2, s5
s_cmp_lg_u32 s8, 0
s_cbranch_scc1 L_noep
s_mov_b64 exec, 1
buffer_store_dword v2, off, s[44:47], 0 sc1
s_mov_b64 exec, -1
L_noep:
L_END:
s_endpgm
.section .rodata,"a"
.p2align 6
.amdhsa_kernel interleave_layers__ssm_conv_h3__mixer_channel_mlp__prompt_kernel
  .amdhsa_next_free_vgpr 512
  .amdhsa_next_free_sgpr 102
  .amdhsa_accum_offset 256
  .amdhsa_group_segment_fixed_size 0
  .amdhsa_kernarg_size 112
  .amdhsa_user_sgpr_count 2
  .amdhsa_user_sgpr_kernarg_segment_ptr 1
  .amdhsa_system_sgpr_workgroup_id_x 1
.end_amdhsa_kernel
```
